```python
import torch

def _softmax(x, axis=-1):
    return torch.softmax(x, dim=axis)
def _gelu(x):
    return torch.nn.functional.gelu(x, approximate="tanh")
def _silu(x):
    return torch.nn.functional.silu(x)
def _sigmoid(x):
    return torch.sigmoid(x)
def _layernorm(x, axis=-1, eps=1e-5):
    m = x.mean(dim=axis, keepdim=True)
    v = x.var(dim=axis, keepdim=True, unbiased=False)
    return (x - m) / torch.sqrt(v + eps)
def _scatter_add(tgt, idx, src, axis=0):
    return tgt.clone().index_add_(axis, idx, src)
def _segment_sum(src, seg, n):
    out = torch.zeros((n,) + src.shape[1:], dtype=src.dtype)
    return out.index_add_(0, seg, src)
def _pad(x, pw):
    flat = tuple(v for pair in reversed(pw) for v in pair)
    return torch.nn.functional.pad(x, flat)

kernel_name = 'sequential_preLN__grouped_kv_mqa__dense_activation_silu__prompt'

def setup_inputs():

    _w = (lambda a: (lambda t: t.to(torch.bfloat16) if t.is_floating_point() else t)(torch.as_tensor(a)))
    def _A_setup():
        B, S, D, H = 1, 2048, 576, 32
        Dh = D // H
        return {
            "x": _w((lambda *s: torch.randn(*s, dtype=torch.bfloat16) * 0.05)(B, S, D)),
            "wq": _w((lambda *s: torch.randn(*s, dtype=torch.bfloat16) * 0.05)(D, H * Dh)),
            "wk": _w((lambda *s: torch.randn(*s, dtype=torch.bfloat16) * 0.05)(D, Dh)),
            "wv": _w((lambda *s: torch.randn(*s, dtype=torch.bfloat16) * 0.05)(D, Dh)),
            "wo": _w((lambda *s: torch.randn(*s, dtype=torch.bfloat16) * 0.05)(H * Dh, D)),
        }
    _A_in = _A_setup()

    def _B_setup():
        B, S, D, F = 1, 2048, 576, 4608
        return {
            "x": _w((lambda *s: torch.randn(*s, dtype=torch.bfloat16) * 0.05)(B, S, D)),
            "w1": _w((lambda *s: torch.randn(*s, dtype=torch.bfloat16) * 1.6)(D, F) * (D ** -0.5)),
            "w2": _w((lambda *s: torch.randn(*s, dtype=torch.bfloat16) * 0.2)(F, D) * (F ** -0.5)),
        }
    _B_in = _B_setup()

    return {
        "A_x": _A_in["x"],
        "A_wq": _A_in["wq"],
        "A_wk": _A_in["wk"],
        "A_wv": _A_in["wv"],
        "A_wo": _A_in["wo"],
        "B_x": _B_in["x"],
        "B_w1": _B_in["w1"],
        "B_w2": _B_in["w2"],
    }

def reference(A_x, A_wq, A_wk, A_wv, A_wo, B_x, B_w1, B_w2):
    def _A_ref(x, wq, wk, wv, wo):
        B, S, D = x.shape
        H = 32
        Dh = D // H
        q = (lambda x, *d: x.permute(*d))((x @ wq).reshape(B, S, H, Dh), 0, 2, 1, 3)
        k = x @ wk
        v = x @ wv
        scores = torch.einsum("bhqd,bkd->bhqk", q, k) * (Dh ** -0.5)
        p = _softmax(scores, axis=-1)
        o = torch.einsum("bhqk,bkd->bhqd", p, v)
        return (lambda x, *d: x.permute(*d))(o, 0, 2, 1, 3).reshape(B, S, H * Dh) @ wo

    def _B_ref(x, w1, w2):
        h = torch.einsum("bsd,df->bsf", x, w1)
        h = _silu(h)
        out = torch.einsum("bsf,fd->bsd", h, w2)
        return out

    x = A_x
    h = x + _A_ref(_layernorm(x, axis=-1), A_wq, A_wk, A_wv, A_wo)
    h2 = h + _B_ref(_layernorm(h, axis=-1), B_w1, B_w2)
    return h2
```

```asm
; @launch kernel=k3_kernel grid=(256,1,1) block=(256,1,1) lds=163840
.amdgcn_target "amdgcn-amd-amdhsa--gfx950"
.text
.globl k3_kernel
.p2align 12
.p2align 8
.type k3_kernel,@function
k3_kernel:
    s_cmp_ge_u32 s2, 256
    s_cbranch_scc1 L_end_k3_kernel
    s_load_dwordx2 s[8:9], s[0:1], 80
    s_load_dwordx2 s[4:5], s[0:1], 0
    s_load_dwordx2 s[12:13], s[0:1], 8
    s_load_dwordx2 s[24:25], s[0:1], 32
    s_load_dwordx4 s[20:23], s[0:1], 48
    s_load_dwordx4 s[64:67], s[0:1], 16
    s_load_dwordx2 s[60:61], s[0:1], 72
    s_load_dwordx2 s[70:71], s[0:1], 64
    s_mov_b32 s10, 0x10000000
    s_mov_b32 s11, 0x00020000
    v_lshrrev_b32 v4, 6, v0
    v_and_b32 v1, 63, v0
    v_readfirstlane_b32 s32, v4
    s_and_b32 s35, s2, 7
    s_lshl_b32 s30, s35, 2
    s_lshr_b32 s35, s2, 6
    s_add_u32 s30, s30, s35
    s_bfe_u32 s31, s2, 0x30003
    v_lshlrev_b32 v2, 4, v1
    v_and_b32 v5, 15, v1
    v_bfe_u32 v6, v1, 4, 1
    v_lshrrev_b32 v7, 5, v1
    s_mov_b32 s6, 0x00240000
    s_mov_b32 s7, 0x00020000
    v_lshrrev_b32 v8, 3, v1
    v_xor_b32 v9, v8, v1
    v_and_b32 v9, 7, v9
    v_mul_u32_u24 v8, 1152, v8
    v_lshl_add_u32 v201, v9, 4, v8
    v_add_u32 v202, 9216, v201
    s_lshl_b32 s26, s30, 2
    s_add_u32 s26, s26, s32
    s_mul_i32 s33, s26, 18432
    s_mul_i32 s34, s32, 18432
    s_and_b32 s42, s30, 3
    s_lshl_b32 s42, s42, 1
    s_add_u32 s42, s42, s31
    s_cmp_ge_u32 s42, 9
    s_cselect_b32 s35, 9, 0
    s_sub_u32 s42, s42, s35
    s_lshl_b32 s40, s42, 7
    s_add_u32 s40, s40, s33
    s_add_u32 s41, s33, 1152
    v_mov_b32 v164, 0
    v_lshrrev_b32 v8, 5, v1
    v_mul_u32_u24 v8, 3968, v8
    v_lshl_add_u32 v8, v1, 2, v8
    s_lshl_b32 s45, s30, 7
    s_add_u32 s45, s45, 0x007b4000
    s_lshl_b32 s38, s31, 2
    s_add_u32 s38, s38, s32
    s_mov_b32 m0, s34
    s_cmp_lt_u32 s31, 3
    s_waitcnt lgkmcnt(0)
    s_cselect_b32 s56, s64, s66
    s_cselect_b32 s57, s65, s67
    s_cmp_lg_u32 s38, 28
    s_cbranch_scc1 L_p1_nz
    buffer_store_dword v164, v8, s[8:11], s45 offen sc1
L_p1_nz:
    buffer_load_dwordx4 v201, s[4:7], s40 offen lds
    s_add_u32 m0, m0, 1024
    s_nop 0
    buffer_load_dwordx4 v202, s[4:7], s40 offen lds
    s_add_u32 m0, m0, 1024
    s_add_u32 s40, s40, 128
    s_cmp_eq_u32 s40, s41
    s_cselect_b32 s40, s33, s40
    buffer_load_dwordx4 v201, s[4:7], s40 offen lds
    s_add_u32 m0, m0, 1024
    s_nop 0
    buffer_load_dwordx4 v202, s[4:7], s40 offen lds
    s_add_u32 m0, m0, 1024
    s_add_u32 s40, s40, 128
    s_cmp_eq_u32 s40, s41
    s_cselect_b32 s40, s33, s40
    buffer_load_dwordx4 v201, s[4:7], s40 offen lds
    s_add_u32 m0, m0, 1024
    s_nop 0
    buffer_load_dwordx4 v202, s[4:7], s40 offen lds
    s_add_u32 m0, m0, 1024
    s_add_u32 s40, s40, 128
    s_cmp_eq_u32 s40, s41
    s_cselect_b32 s40, s33, s40
    buffer_load_dwordx4 v201, s[4:7], s40 offen lds
    s_add_u32 m0, m0, 1024
    s_nop 0
    buffer_load_dwordx4 v202, s[4:7], s40 offen lds
    s_add_u32 m0, m0, 1024
    s_add_u32 s40, s40, 128
    s_cmp_eq_u32 s40, s41
    s_cselect_b32 s40, s33, s40
    buffer_load_dwordx4 v201, s[4:7], s40 offen lds
    s_add_u32 m0, m0, 1024
    s_nop 0
    buffer_load_dwordx4 v202, s[4:7], s40 offen lds
    s_add_u32 m0, m0, 1024
    s_add_u32 s40, s40, 128
    s_cmp_eq_u32 s40, s41
    s_cselect_b32 s40, s33, s40
    buffer_load_dwordx4 v201, s[4:7], s40 offen lds
    s_add_u32 m0, m0, 1024
    s_nop 0
    buffer_load_dwordx4 v202, s[4:7], s40 offen lds
    s_add_u32 m0, m0, 1024
    s_add_u32 s40, s40, 128
    s_cmp_eq_u32 s40, s41
    s_cselect_b32 s40, s33, s40
    v_mul_u32_u24 v208, 36, v1
    s_cmp_lt_u32 s31, 3
    s_cselect_b32 s35, 0, 3
    s_sub_u32 s35, s31, s35
    s_lshl_b32 s36, s35, 4
    s_min_u32 s36, s36, 20
    s_cmp_gt_u32 s31, 5
    s_cselect_b32 s36, 0x40000000, s36
    s_add_u32 s35, s42, s32
    s_cmp_ge_u32 s35, 9
    s_cselect_b32 s48, 9, 0
    s_sub_u32 s35, s35, s48
    s_mul_i32 s48, s35, 2304
    s_add_u32 s48, s48, s36
    s_add_u32 s35, s35, 4
    s_cmp_ge_u32 s35, 9
    s_cselect_b32 s43, 9, 0
    s_sub_u32 s35, s35, s43
    s_mul_i32 s43, s35, 2304
    s_add_u32 s43, s43, s36
    s_add_u32 s35, s35, 4
    s_cmp_ge_u32 s35, 9
    s_cselect_b32 s44, 9, 0
    s_sub_u32 s35, s35, s44
    s_mul_i32 s44, s35, 2304
    s_add_u32 s44, s44, s36
    s_cmp_eq_u32 s32, 0
    s_cselect_b32 s44, s44, 0x40000000
    s_lshl_b32 s47, s32, 10
    s_add_u32 s47, s47, 135168
    s_mov_b32 s14, 0x000a2000
    s_mov_b32 s15, 0x00020000
    s_mov_b32 s58, 0x00005100
    s_mov_b32 s59, 0x00020000
    s_mov_b32 s62, 0x00000100
    s_mov_b32 s63, 0x00020000
    s_mul_i32 s29, s32, 5120
    s_add_u32 s29, s29, 53248
    v_lshrrev_b32 v200, 4, v1
    v_and_b32 v8, 7, v5
    v_xor_b32 v9, v200, v8
    v_lshlrev_b32 v9, 4, v9
    v_lshl_add_u32 v9, v5, 7, v9
    s_and_b32 s46, s32, 1
    s_lshl_b32 s35, s46, 6
    v_xor_b32 v9, s35, v9
    v_add_u32 v212, s34, v9
    v_xor_b32 v219, 64, v212
    s_xor_b32 s36, s32, 1
    s_mul_i32 s35, s36, 18432
    v_add_u32 v231, s35, v9
    s_lshl_b32 s35, s32, 10
    v_add_u32 v232, s35, v2
    v_xor_b32 v233, 1024, v232
    v_lshlrev_b32 v8, 2, v200
    v_and_b32 v8, 4, v8
    v_xor_b32 v8, v8, v5
    v_and_b32 v8, 7, v8
    buffer_load_dwordx4 v201, s[4:7], s40 offen lds
    s_add_u32 m0, m0, 1024
    v_lshlrev_b32 v8, 4, v8
    v_lshl_add_u32 v8, v5, 7, v8
    s_sub_u32 s35, s31, s42
    s_cselect_b32 s36, 9, 0
    s_add_u32 s35, s35, s36
    s_lshl_b32 s35, s35, 11
    s_add_u32 s35, s35, s34
    v_add_u32 v240, s35, v8
    v_xor_b32 v241, 16, v240
    v_xor_b32 v242, 32, v240
    v_xor_b32 v243, 48, v240
    s_and_b32 s35, s31, 1
    s_lshl_b32 s35, s35, 5
    v_xor_b32 v8, s35, v8
    s_sub_u32 s35, 8, s42
    s_lshl_b32 s35, s35, 11
    s_add_u32 s35, s35, s34
    s_lshr_b32 s36, s31, 1
    s_lshl2_add_u32 s35, s36, s35
    v_add_u32 v244, s35, v8
    buffer_load_dwordx4 v202, s[4:7], s40 offen lds
    s_add_u32 m0, m0, 1024
    s_add_u32 s40, s40, 128
    s_cmp_eq_u32 s40, s41
    s_cselect_b32 s40, s33, s40
    v_xor_b32 v245, 16, v244
    v_mov_b32 v160, 0x3f803f80
    v_mov_b32 v161, 0x3f803f80
    v_mov_b32 v162, 0x3f803f80
    v_mov_b32 v163, 0x3f803f80
    v_bfe_u32 v8, v1, 2, 2
    v_lshl_add_u32 v8, v200, 3, v8
    v_and_b32 v9, 1, v200
    v_lshlrev_b32 v9, 2, v9
    v_xor_b32 v10, v8, v9
    v_xor_b32 v11, 4, v10
    v_and_b32 v9, 3, v1
    v_lshlrev_b32 v9, 3, v9
    v_and_b32 v13, 8, v9
    s_mul_i32 s35, s46, 5120
    s_add_u32 s35, s35, 73728
    v_add_u32 v9, s35, v9
    v_mul_u32_u24 v209, 160, v10
    v_add_u32 v209, v209, v9
    v_mul_u32_u24 v210, 160, v11
    buffer_load_dwordx4 v201, s[4:7], s40 offen lds
    s_add_u32 m0, m0, 1024
    v_add_u32 v210, v210, v9
    v_lshl_add_u32 v211, v8, 4, v13
    s_lshl_b32 s35, s46, 9
    s_add_u32 s35, s35, 135168
    v_add_u32 v211, s35, v211
    v_xor_b32 v230, 512, v211
    v_mov_b32 v11, 0x40000000
    v_add_u32 v8, 0, v1
    v_mul_u32_u24 v9, 6554, v8
    v_lshrrev_b32 v9, 16, v9
    v_mul_u32_u24 v10, 10, v9
    v_sub_u32 v10, v8, v10
    v_lshrrev_b32 v13, 1, v9
    v_and_b32 v13, 4, v13
    v_xor_b32 v9, v9, v13
    v_cmp_eq_u32 vcc, 9, v10
    v_mul_u32_u24 v9, 1152, v9
    v_lshl_add_u32 v9, v10, 4, v9
    v_cndmask_b32 v203, v9, v11, vcc
    v_add_u32 v8, 64, v1
    buffer_load_dwordx4 v202, s[4:7], s40 offen lds
    s_add_u32 m0, m0, 1024
    s_add_u32 s40, s40, 128
    s_cmp_eq_u32 s40, s41
    s_cselect_b32 s40, s33, s40
    v_mul_u32_u24 v9, 6554, v8
    v_lshrrev_b32 v9, 16, v9
    v_mul_u32_u24 v10, 10, v9
    v_sub_u32 v10, v8, v10
    v_lshrrev_b32 v13, 1, v9
    v_and_b32 v13, 4, v13
    v_xor_b32 v9, v9, v13
    v_cmp_eq_u32 vcc, 9, v10
    v_mul_u32_u24 v9, 1152, v9
    v_lshl_add_u32 v9, v10, 4, v9
    v_cndmask_b32 v204, v9, v11, vcc
    v_add_u32 v8, 128, v1
    v_mul_u32_u24 v9, 6554, v8
    v_lshrrev_b32 v9, 16, v9
    v_mul_u32_u24 v10, 10, v9
    v_sub_u32 v10, v8, v10
    v_lshrrev_b32 v13, 1, v9
    v_and_b32 v13, 4, v13
    v_xor_b32 v9, v9, v13
    v_cmp_eq_u32 vcc, 9, v10
    buffer_load_dwordx4 v201, s[4:7], s40 offen lds
    v_mul_u32_u24 v9, 1152, v9
    v_lshl_add_u32 v9, v10, 4, v9
    v_cndmask_b32 v205, v9, v11, vcc
    v_add_u32 v8, 192, v1
    v_mul_u32_u24 v9, 6554, v8
    v_lshrrev_b32 v9, 16, v9
    v_mul_u32_u24 v10, 10, v9
    v_sub_u32 v10, v8, v10
    v_lshrrev_b32 v13, 1, v9
    v_and_b32 v13, 4, v13
    v_xor_b32 v9, v9, v13
    v_cmp_eq_u32 vcc, 9, v10
    v_mul_u32_u24 v9, 1152, v9
    v_lshl_add_u32 v9, v10, 4, v9
    v_cndmask_b32 v206, v9, v11, vcc
    v_add_u32 v8, 256, v1
    v_mul_u32_u24 v9, 6554, v8
    v_lshrrev_b32 v9, 16, v9
    v_mul_u32_u24 v10, 10, v9
    v_sub_u32 v10, v8, v10
    s_add_u32 m0, s47, 0
    s_nop 0
    buffer_load_dwordx4 v208, s[56:59], s48 offen lds
    s_add_u32 m0, s47, 4096
    s_nop 0
    buffer_load_dwordx4 v208, s[56:59], s43 offen lds
    s_add_u32 m0, s47, 8192
    s_nop 0
    buffer_load_dwordx4 v208, s[56:59], s44 offen lds
    s_add_u32 m0, s34, 17408
    s_nop 0
    buffer_load_dwordx4 v202, s[4:7], s40 offen lds
    s_add_u32 m0, s29, 20480
    v_lshrrev_b32 v13, 1, v9
    v_and_b32 v13, 4, v13
    v_xor_b32 v9, v9, v13
    v_cmp_eq_u32 vcc, 9, v10
    v_mul_u32_u24 v9, 1152, v9
    v_lshl_add_u32 v9, v10, 4, v9
    v_cndmask_b32 v207, v9, v11, vcc
    s_lshl_b32 s35, s42, 1
    s_add_u32 s35, s35, s32
    s_mul_i32 s35, s35, 36864
    s_mul_i32 s28, s31, 144
    s_add_u32 s28, s28, s35
    s_cmp_ge_u32 s28, 663552
    s_cselect_b32 s36, 663552, 0
    s_sub_u32 s28, s28, s36
    v_mov_b32 v165, 0
    v_mov_b32 v168, 0
    v_mov_b32 v169, 0
    v_and_b32 v8, 1, v1
    v_lshlrev_b32 v8, 4, v8
    v_mov_b32 v9, 0x3f80
    v_lshlrev_b32 v8, v8, v9
    s_mov_b32 s66, 0x00300003
    s_mov_b32 s67, 0x30000300
    s_mov_b32 s68, 0x00c0000c
    s_mov_b32 s69, 0xc0000c00
    v_cndmask_b32 v166, 0, v8, s[66:67]
    v_cndmask_b32 v167, 0, v8, s[68:69]
    s_mov_b32 s66, 0xaaaaaaaa
    s_mov_b32 s67, 0xaaaaaaaa
    s_mov_b32 s68, 0xcccccccc
    s_mov_b32 s69, 0xcccccccc
    s_lshr_b32 s35, s26, 3
    s_mul_i32 s37, s35, 9472
    s_add_u32 s37, s37, 0x00240000
    v_and_b32 v9, 1, v200
    s_cmp_gt_u32 s31, 2
    s_cbranch_scc1 L_p1_av
    s_and_b32 s35, s26, 1
    s_lshl_b32 s35, s35, 8
    s_add_u32 s37, s37, s35
    s_bfe_u32 s36, s26, 0x20001
    s_lshl_b32 s35, s31, 9
    s_cmp_eq_u32 s31, 2
    s_cselect_b32 s35, 4088, s35
    s_cselect_b32 s27, 2, 10
    s_lshl_b32 s36, s36, s27
    s_add_u32 s37, s37, s36
    s_add_u32 s37, s37, s35
    v_lshlrev_b32 v215, 4, v5
    v_lshl_add_u32 v215, v9, 3, v215
    s_branch L_p1_ad
L_p1_av:
    s_and_b32 s35, s26, 7
    s_mul_i32 s35, s35, 608
    s_add_u32 s37, s37, s35
    s_add_u32 s37, s37, 4608
    s_cmp_eq_u32 s31, 4
    s_cselect_b32 s35, 64, 0
    s_add_u32 s37, s37, s35
    v_bfe_u32 v215, v5, 2, 1
    v_mul_u32_u24 v215, 288, v215
    v_lshl_add_u32 v215, v9, 7, v215
    v_and_b32 v9, 8, v5
    v_add_u32 v215, v215, v9
    v_and_b32 v9, 3, v5
    v_lshl_add_u32 v215, v9, 1, v215
L_p1_ad:
    v_lshlrev_b32 v216, 3, v1
    v_and_b32 v216, 0xff, v216
    v_lshrrev_b32 v214, 2, v5
    v_lshl_add_u32 v213, v214, 4, v5
    v_lshlrev_b32 v213, 2, v213
    v_mov_b32 v214, 0x3727c5ac
    v_lshrrev_b32 v218, 1, v1
    v_mul_u32_u24 v218, 96, v218
    v_add_u32 v218, v218, v2
    s_mul_i32 s35, s32, 2304
    s_add_u32 s35, s35, 73728
    v_lshlrev_b32 v217, 3, v1
    v_add_u32 v217, s35, v217
    s_lshl_b32 s27, s30, 5
    s_add_u32 s27, s27, s31
    s_lshl_b32 s27, s27, 2
    s_add_u32 s27, s27, 0x007b5000
    s_mov_b64 exec, 0
    s_bitcmp1_b32 s32, 0
    s_cbranch_scc1 L_tqna1
    s_bitcmp1_b32 s32, 1
    s_cbranch_scc1 L_tqra
    s_branch L_tqa1000
L_tqna1:
    s_bitcmp1_b32 s32, 1
    s_cbranch_scc1 L_tqra
    s_branch L_tqa2000
L_tqra:
    s_mov_b64 exec, -1
    s_waitcnt vmcnt(19)
    ds_read_b128 v[32:35], v212 offset:0
    ds_read_b128 v[36:39], v219 offset:0
    buffer_load_dwordx4 v203, s[12:15], s28 offen lds
    s_add_u32 m0, s29, 21504
    s_nop 0
    buffer_load_dwordx4 v204, s[12:15], s28 offen lds
    s_add_u32 m0, s29, 22528
    s_waitcnt lgkmcnt(1)
    v_mfma_f32_16x16x32_bf16 v[156:159], v[32:35], v[32:35], 0
    s_waitcnt vmcnt(19)
    ds_read_b128 v[40:43], v212 offset:2048
    ds_read_b128 v[44:47], v219 offset:2048
    v_mfma_f32_16x16x32_bf16 v[152:155], v[160:163], v[32:35], 0
    s_waitcnt lgkmcnt(2)
    buffer_load_dwordx4 v205, s[12:15], s28 offen lds
    v_mfma_f32_16x16x32_bf16 v[156:159], v[36:39], v[36:39], v[156:159]
    s_add_u32 m0, s29, 23552
    v_mfma_f32_16x16x32_bf16 v[152:155], v[160:163], v[36:39], v[152:155]
    buffer_load_dwordx4 v206, s[12:15], s28 offen lds
    s_add_u32 m0, s29, 24576
    s_waitcnt vmcnt(5)
    s_cmp_lg_u32 s38, 28
    s_cbranch_scc1 L_p1_nd
    s_lshl_b32 s35, s30, 3
    s_mov_b64 exec, 1
    buffer_store_dword v160, v164, s[60:63], s35 offen sc1
    s_mov_b64 exec, -1
L_p1_nd:
    s_barrier
    s_mov_b32 s38, 65536
    s_waitcnt lgkmcnt(1)
    v_mfma_f32_16x16x32_bf16 v[156:159], v[40:43], v[40:43], v[156:159]
    ds_read_b64_tr_b16 a[16:17], v211 offset:0
    ds_read_b64_tr_b16 a[18:19], v211 offset:64
    v_mfma_f32_16x16x32_bf16 v[152:155], v[160:163], v[40:43], v[152:155]
    s_waitcnt lgkmcnt(2)
    ds_read_b64_tr_b16 a[20:21], v230 offset:0
    ds_read_b64_tr_b16 a[22:23], v230 offset:64
    v_mfma_f32_16x16x32_bf16 v[156:159], v[44:47], v[44:47], v[156:159]
    ds_read_b64_tr_b16 a[24:25], v211 offset:1024
    ds_read_b64_tr_b16 a[26:27], v211 offset:1088
    v_mfma_f32_16x16x32_bf16 v[152:155], v[160:163], v[44:47], v[152:155]
    ds_read_b64_tr_b16 a[28:29], v230 offset:1024
    ds_read_b64_tr_b16 a[30:31], v230 offset:1088
    ds_read_b128 v[48:51], v212 offset:4096
    ds_read_b128 v[52:55], v219 offset:4096
    buffer_load_dwordx4 v207, s[12:15], s28 offen lds
    s_add_u32 m0, s29, 40960
    s_add_u32 s28, s28, 147456
    s_cmp_ge_u32 s28, 663552
    s_cselect_b32 s36, 663552, 0
    s_sub_u32 s28, s28, s36
    buffer_load_dwordx4 v203, s[12:15], s28 offen lds
    s_add_u32 m0, s29, 41984
    s_waitcnt lgkmcnt(8)
    v_mfma_f32_16x16x32_bf16 v[176:179], a[16:19], v[160:163], 0
    ds_read_b64_tr_b16 a[32:33], v211 offset:2048
    ds_read_b64_tr_b16 a[34:35], v211 offset:2112
    v_mfma_f32_16x16x32_bf16 v[172:175], a[16:19], v[32:35], 0
    s_waitcnt lgkmcnt(3)
    ds_read_b64_tr_b16 a[36:37], v230 offset:2048
    ds_read_b64_tr_b16 a[38:39], v230 offset:2112
    v_mfma_f32_16x16x32_bf16 v[156:159], v[48:51], v[48:51], v[156:159]
    ds_read_b64_tr_b16 a[40:41], v211 offset:3072
    ds_read_b64_tr_b16 a[42:43], v211 offset:3136
    v_mfma_f32_16x16x32_bf16 v[152:155], v[160:163], v[48:51], v[152:155]
    ds_read_b64_tr_b16 a[44:45], v230 offset:3072
    ds_read_b64_tr_b16 a[46:47], v230 offset:3136
    v_mfma_f32_16x16x32_bf16 v[176:179], a[20:23], v[160:163], v[176:179]
    ds_read_b128 v[56:59], v212 offset:6144
    ds_read_b128 v[60:63], v219 offset:6144
    v_mfma_f32_16x16x32_bf16 v[172:175], a[20:23], v[36:39], v[172:175]
    s_waitcnt lgkmcnt(10)
    buffer_load_dwordx4 v204, s[12:15], s28 offen lds
    v_mfma_f32_16x16x32_bf16 v[156:159], v[52:55], v[52:55], v[156:159]
    s_add_u32 m0, s29, 43008
    v_mfma_f32_16x16x32_bf16 v[152:155], v[160:163], v[52:55], v[152:155]
    v_mfma_f32_16x16x32_bf16 v[176:179], a[24:27], v[160:163], v[176:179]
    v_mfma_f32_16x16x32_bf16 v[172:175], a[24:27], v[40:43], v[172:175]
    v_mfma_f32_16x16x32_bf16 v[176:179], a[28:31], v[160:163], v[176:179]
    v_mfma_f32_16x16x32_bf16 v[172:175], a[28:31], v[44:47], v[172:175]
    s_waitcnt lgkmcnt(8)
    v_mfma_f32_16x16x32_bf16 v[176:179], a[32:35], v[160:163], v[176:179]
    ds_read_b64_tr_b16 a[48:49], v211 offset:4096
    ds_read_b64_tr_b16 a[50:51], v211 offset:4160
    v_mfma_f32_16x16x32_bf16 v[172:175], a[32:35], v[48:51], v[172:175]
    s_waitcnt lgkmcnt(3)
    ds_read_b64_tr_b16 a[52:53], v230 offset:4096
    ds_read_b64_tr_b16 a[54:55], v230 offset:4160
    v_mfma_f32_16x16x32_bf16 v[156:159], v[56:59], v[56:59], v[156:159]
    ds_read_b128 v[64:67], v212 offset:8192
    ds_read_b128 v[68:71], v219 offset:8192
    v_mfma_f32_16x16x32_bf16 v[152:155], v[160:163], v[56:59], v[152:155]
    buffer_load_dwordx4 v205, s[12:15], s28 offen lds
    v_mfma_f32_16x16x32_bf16 v[176:179], a[36:39], v[160:163], v[176:179]
    s_add_u32 m0, s29, 44032
    v_mfma_f32_16x16x32_bf16 v[172:175], a[36:39], v[52:55], v[172:175]
    s_waitcnt lgkmcnt(6)
    v_mfma_f32_16x16x32_bf16 v[156:159], v[60:63], v[60:63], v[156:159]
    v_mfma_f32_16x16x32_bf16 v[152:155], v[160:163], v[60:63], v[152:155]
    v_mfma_f32_16x16x32_bf16 v[176:179], a[40:43], v[160:163], v[176:179]
    v_mfma_f32_16x16x32_bf16 v[172:175], a[40:43], v[56:59], v[172:175]
    v_mfma_f32_16x16x32_bf16 v[176:179], a[44:47], v[160:163], v[176:179]
    v_mfma_f32_16x16x32_bf16 v[172:175], a[44:47], v[60:63], v[172:175]
    s_waitcnt lgkmcnt(4)
    v_mfma_f32_16x16x32_bf16 v[176:179], a[48:51], v[160:163], v[176:179]
    s_waitcnt lgkmcnt(1)
    ds_read_b64_tr_b16 a[56:57], v211 offset:5120
    ds_read_b64_tr_b16 a[58:59], v211 offset:5184
    v_mfma_f32_16x16x32_bf16 v[172:175], a[48:51], v[64:67], v[172:175]
    ds_read_b64_tr_b16 a[60:61], v230 offset:5120
    ds_read_b64_tr_b16 a[62:63], v230 offset:5184
    v_mfma_f32_16x16x32_bf16 v[156:159], v[64:67], v[64:67], v[156:159]
    ds_read_b128 v[72:75], v212 offset:10240
    ds_read_b128 v[76:79], v219 offset:10240
    v_mfma_f32_16x16x32_bf16 v[152:155], v[160:163], v[64:67], v[152:155]
    buffer_load_dwordx4 v206, s[12:15], s28 offen lds
    v_mfma_f32_16x16x32_bf16 v[176:179], a[52:55], v[160:163], v[176:179]
    s_waitcnt lgkmcnt(6)
    s_add_u32 m0, s29, 45056
    v_mfma_f32_16x16x32_bf16 v[172:175], a[52:55], v[68:71], v[172:175]
    v_mfma_f32_16x16x32_bf16 v[156:159], v[68:71], v[68:71], v[156:159]
    v_mfma_f32_16x16x32_bf16 v[152:155], v[160:163], v[68:71], v[152:155]
    s_waitcnt lgkmcnt(4)
    v_mfma_f32_16x16x32_bf16 v[176:179], a[56:59], v[160:163], v[176:179]
    s_waitcnt lgkmcnt(1)
    ds_read_b64_tr_b16 a[64:65], v211 offset:6144
    ds_read_b64_tr_b16 a[66:67], v211 offset:6208
    v_mfma_f32_16x16x32_bf16 v[172:175], a[56:59], v[72:75], v[172:175]
    ds_read_b64_tr_b16 a[68:69], v230 offset:6144
    ds_read_b64_tr_b16 a[70:71], v230 offset:6208
    v_mfma_f32_16x16x32_bf16 v[156:159], v[72:75], v[72:75], v[156:159]
    ds_read_b128 v[80:83], v212 offset:12288
    ds_read_b128 v[84:87], v219 offset:12288
    v_mfma_f32_16x16x32_bf16 v[152:155], v[160:163], v[72:75], v[152:155]
    buffer_load_dwordx4 v207, s[12:15], s28 offen lds
    v_mfma_f32_16x16x32_bf16 v[176:179], a[60:63], v[160:163], v[176:179]
    s_waitcnt lgkmcnt(6)
    s_add_u32 m0, s29, 61440
    s_add_u32 s28, s28, 147456
    v_mfma_f32_16x16x32_bf16 v[172:175], a[60:63], v[76:79], v[172:175]
    s_cmp_ge_u32 s28, 663552
    s_cselect_b32 s36, 663552, 0
    s_sub_u32 s28, s28, s36
    v_mfma_f32_16x16x32_bf16 v[156:159], v[76:79], v[76:79], v[156:159]
    v_mfma_f32_16x16x32_bf16 v[152:155], v[160:163], v[76:79], v[152:155]
    s_waitcnt lgkmcnt(4)
    v_mfma_f32_16x16x32_bf16 v[176:179], a[64:67], v[160:163], v[176:179]
    s_waitcnt lgkmcnt(1)
    ds_read_b64_tr_b16 a[72:73], v211 offset:7168
    ds_read_b64_tr_b16 a[74:75], v211 offset:7232
    v_mfma_f32_16x16x32_bf16 v[172:175], a[64:67], v[80:83], v[172:175]
    ds_read_b64_tr_b16 a[76:77], v230 offset:7168
    ds_read_b64_tr_b16 a[78:79], v230 offset:7232
    v_mfma_f32_16x16x32_bf16 v[156:159], v[80:83], v[80:83], v[156:159]
    ds_read_b128 v[88:91], v212 offset:14336
    ds_read_b128 v[92:95], v219 offset:14336
    v_mfma_f32_16x16x32_bf16 v[152:155], v[160:163], v[80:83], v[152:155]
    v_mfma_f32_16x16x32_bf16 v[176:179], a[68:71], v[160:163], v[176:179]
    s_waitcnt lgkmcnt(6)
    v_mfma_f32_16x16x32_bf16 v[172:175], a[68:71], v[84:87], v[172:175]
    v_mfma_f32_16x16x32_bf16 v[156:159], v[84:87], v[84:87], v[156:159]
    v_mfma_f32_16x16x32_bf16 v[152:155], v[160:163], v[84:87], v[152:155]
    s_waitcnt lgkmcnt(4)
    v_mfma_f32_16x16x32_bf16 v[176:179], a[72:75], v[160:163], v[176:179]
    s_waitcnt lgkmcnt(1)
    ds_read_b64_tr_b16 a[80:81], v211 offset:8192
    ds_read_b64_tr_b16 a[82:83], v211 offset:8256
    v_mfma_f32_16x16x32_bf16 v[172:175], a[72:75], v[88:91], v[172:175]
    ds_read_b64_tr_b16 a[84:85], v230 offset:8192
    ds_read_b64_tr_b16 a[86:87], v230 offset:8256
    v_mfma_f32_16x16x32_bf16 v[156:159], v[88:91], v[88:91], v[156:159]
    s_waitcnt vmcnt(10)
    ds_read_b128 v[96:99], v212 offset:16384
    ds_read_b128 v[100:103], v219 offset:16384
    v_mfma_f32_16x16x32_bf16 v[152:155], v[160:163], v[88:91], v[152:155]
    v_mfma_f32_16x16x32_bf16 v[176:179], a[76:79], v[160:163], v[176:179]
    s_waitcnt lgkmcnt(6)
    v_mfma_f32_16x16x32_bf16 v[172:175], a[76:79], v[92:95], v[172:175]
    v_mfma_f32_16x16x32_bf16 v[156:159], v[92:95], v[92:95], v[156:159]
    v_mfma_f32_16x16x32_bf16 v[152:155], v[160:163], v[92:95], v[152:155]
    s_waitcnt lgkmcnt(4)
    v_mfma_f32_16x16x32_bf16 v[176:179], a[80:83], v[160:163], v[176:179]
    s_waitcnt lgkmcnt(1)
    v_mfma_f32_16x16x32_bf16 v[156:159], v[96:99], v[96:99], v[156:159]
    v_mfma_f32_16x16x32_bf16 v[152:155], v[160:163], v[96:99], v[152:155]
    v_mfma_f32_16x16x32_bf16 v[172:175], a[80:83], v[96:99], v[172:175]
    v_mfma_f32_16x16x32_bf16 v[176:179], a[84:87], v[160:163], v[176:179]
    s_waitcnt lgkmcnt(0)
    v_mfma_f32_16x16x32_bf16 v[156:159], v[100:103], v[100:103], v[156:159]
    v_mfma_f32_16x16x32_bf16 v[152:155], v[160:163], v[100:103], v[152:155]
    v_mfma_f32_16x16x32_bf16 v[172:175], a[84:87], v[100:103], v[172:175]
    s_nop 5
    v_cndmask_b32 v156, v156, v157, s[66:67]
    v_cndmask_b32 v158, v158, v159, s[66:67]
    v_cndmask_b32 v156, v156, v158, s[68:69]
    ds_bpermute_b32 v156, v213, v156
    v_mul_f32 v152, 0xbae38e39, v152
    v_mul_f32 v153, 0xbae38e39, v153
    v_mul_f32 v154, 0xbae38e39, v154
    v_mul_f32 v155, 0xbae38e39, v155
    v_mul_f32 v158, v152, v152
    v_sub_f32 v157, v214, v158
    v_fmac_f32 v172, v152, v176
    v_fmac_f32 v173, v152, v177
    v_fmac_f32 v174, v152, v178
    v_fmac_f32 v175, v152, v179
    v_mul_f32 v158, 0x3b800000, v158
    v_accvgpr_write_b32 a100, v152
    s_waitcnt lgkmcnt(0)
    v_fmac_f32 v157, 0x3ae38e39, v156
    v_rsq_f32 v156, v157
    v_cmp_nle_f32 vcc, v158, v157
    v_cmp_nlt_f32 s[64:65], 0, v156
    s_nop 0
    s_or_b64 vcc, vcc, s[64:65]
    s_cbranch_scc1 L_p1_sl
L_p1_st:
    s_cmp_gt_u32 s31, 5
    s_cbranch_scc1 L_p1_c
    v_mul_f32 v172, v172, v156
    v_mul_f32 v173, v173, v156
    v_mul_f32 v174, v174, v156
    v_mul_f32 v175, v175, v156
    s_bitcmp1_b32 0x00000024, s31
    v_cvt_pk_bf16_f32 v172, v172, v173
    v_cvt_pk_bf16_f32 v173, v174, v175
    s_mov_b32 exec_lo, 0
    s_cbranch_scc1 L_p1_2
    s_cmp_gt_u32 s31, 2
    s_cbranch_scc1 L_p1_v
    buffer_store_dwordx2 v[172:173], v215, s[8:11], s37 offen sc1
    s_branch L_p1_sd
L_p1_v:
    buffer_store_short v172, v215, s[8:11], s37 offen sc1
    buffer_store_short_d16_hi v172, v215, s[8:11], s37 offen offset:16 sc1
    buffer_store_short v173, v215, s[8:11], s37 offen offset:32 sc1
    buffer_store_short_d16_hi v173, v215, s[8:11], s37 offen offset:48 sc1
    s_branch L_p1_sd
L_p1_2:
    s_mov_b32 exec_hi, 0xffff0000
    s_cmp_eq_u32 s31, 5
    s_cbranch_scc1 L_p1_v2
    buffer_store_dword v173, v215, s[8:11], s37 offen sc1
    s_branch L_p1_sd
L_p1_v2:
    buffer_store_short v173, v215, s[8:11], s37 offen offset:128 sc1
    buffer_store_short_d16_hi v173, v215, s[8:11], s37 offen offset:144 sc1
    s_branch L_p1_sd
L_p1_dr:
    buffer_load_dword v220, v216, s[60:63], 0 offen sc1
    s_sub_u32 s38, s38, 1
    s_cmp_gt_i32 s38, 0
    s_waitcnt vmcnt(0)
    s_cbranch_scc1 L_p1_dc
    s_branch L_p1_df
L_p1_kr:
    v_cmp_eq_u32 vcc, 0, v224
    s_cbranch_vccz L_p1_k2
    buffer_load_dword v224, v216, s[60:63], 0 offen sc1
    s_waitcnt vmcnt(0)
L_p1_k2:
    buffer_load_dwordx4 v[226:229], v218, s[8:11], s37 offen sc1
    s_sub_u32 s38, s38, 1
    s_cmp_gt_i32 s38, 0
    s_waitcnt vmcnt(0)
    s_cbranch_scc1 L_p1_kc
    s_branch L_p1_kg
L_p1_c:
    s_cmp_eq_u32 s31, 7
    s_cbranch_scc1 L_p1_sd
    v_cmp_gt_u32 vcc, 4, v1
    v_lshlrev_b32 v215, 2, v1
    s_nop 0
    v_cndmask_b32 v172, 0, v160, vcc
    s_mov_b64 exec, 0xff
    buffer_store_dword v172, v215, s[8:11], s37 offen offset:576 sc1
L_p1_sd:
    s_mov_b64 exec, -1
    buffer_load_dword v220, v216, s[60:63], 0 offen sc1
    v_add_u32 v8, 155648, v232
    v_add_u32 v9, 155648, v233
    ds_write_b128 v8, v[152:155]
    v_mul_f32 v156, 0x3eae1a93, v156
    s_mov_b32 s37, 0x007b5000
    s_waitcnt vmcnt(6)
    s_waitcnt lgkmcnt(0)
    s_barrier
    ds_read_b128 v[236:239], v9
    ds_read_b128 v[36:39], v231 offset:0
    ds_read_b128 v[44:47], v231 offset:2048
    v_mfma_f32_16x16x32_bf16 v[16:19], v[166:169], v[32:35], v[152:155]
    buffer_load_dwordx4 v203, s[12:15], s28 offen lds
    v_mfma_f32_16x16x32_bf16 v[20:23], v[164:167], v[32:35], v[152:155]
    s_add_u32 m0, s29, 62464
    ds_read_b64_tr_b16 a[16:17], v209 offset:0
    ds_read_b64_tr_b16 a[18:19], v210 offset:0
    v_mfma_f32_16x16x32_bf16 v[104:107], v[166:169], v[40:43], v[152:155]
L_tqa1000:
    s_cbranch_execz L_tqra
    ds_read_b64_tr_b16 a[20:21], v209 offset:32
    ds_read_b64_tr_b16 a[22:23], v210 offset:32
    v_mfma_f32_16x16x32_bf16 v[108:111], v[164:167], v[40:43], v[152:155]
    s_waitcnt lgkmcnt(5)
    buffer_load_dwordx4 v204, s[12:15], s28 offen lds
    v_mfma_f32_16x16x32_bf16 v[24:27], v[166:169], v[36:39], v[236:239]
    s_add_u32 m0, s29, 63488
    ds_read_b64_tr_b16 a[24:25], v209 offset:64
    ds_read_b64_tr_b16 a[26:27], v210 offset:64
    v_mfma_f32_16x16x32_bf16 v[28:31], v[164:167], v[36:39], v[236:239]
    s_waitcnt lgkmcnt(6)
    v_cvt_pk_bf16_f32 v32, v16, v17
    v_cvt_pk_bf16_f32 v33, v18, v19
    v_mfma_f32_16x16x32_bf16 v[112:115], v[166:169], v[44:47], v[236:239]
    buffer_load_dwordx4 v205, s[12:15], s28 offen lds
    v_mfma_f32_16x16x32_bf16 v[116:119], v[164:167], v[44:47], v[236:239]
    s_waitcnt lgkmcnt(4)
    v_cvt_pk_bf16_f32 v34, v20, v21
    v_cvt_pk_bf16_f32 v35, v22, v23
    ds_read_b64_tr_b16 a[28:29], v209 offset:96
    ds_read_b64_tr_b16 a[30:31], v210 offset:96
    ds_read_b64_tr_b16 a[32:33], v209 offset:128
    ds_read_b64_tr_b16 a[34:35], v210 offset:128
    v_cvt_pk_bf16_f32 v36, v24, v25
    v_cvt_pk_bf16_f32 v37, v26, v27
    v_cvt_pk_bf16_f32 v38, v28, v29
    v_cvt_pk_bf16_f32 v39, v30, v31
    v_mfma_f32_16x16x32_bf16 v[132:135], a[16:19], v[32:35], 0
    s_add_u32 m0, s29, 64512
    ds_read_b128 v[52:55], v231 offset:4096
    ds_read_b128 v[60:63], v231 offset:6144
    s_mov_b32 s39, 0
    v_mfma_f32_16x16x32_bf16 v[180:183], a[16:19], v[36:39], 0
    s_waitcnt lgkmcnt(8)
    ds_read_b128 v[68:71], v231 offset:8192
    ds_read_b128 v[76:79], v231 offset:10240
    s_cmp_lt_u32 s32, 2
    s_cselect_b32 s35, 2, 3
    s_cselect_b32 s34, 6, 5
    s_cselect_b32 s42, 0, 64
    s_cselect_b32 s43, 1, 0
    v_mfma_f32_16x16x32_bf16 v[136:139], a[20:23], v[32:35], 0
    s_lshr_b32 s35, s2, s35
    ds_read_b128 v[84:87], v231 offset:12288
    ds_read_b128 v[92:95], v231 offset:14336
    s_lshl_b32 s40, s32, s34
    v_mfma_f32_16x16x32_bf16 v[184:187], a[20:23], v[36:39], 0
    s_waitcnt lgkmcnt(10)
    ds_read_b128 a[236:239], v240
    ds_read_b128 a[240:243], v241
    s_add_u32 s40, s40, s35
    v_mfma_f32_16x16x32_bf16 v[140:143], a[24:27], v[32:35], 0
    s_add_u32 s40, s40, s42
    ds_read_b128 a[244:247], v242
    ds_read_b128 a[248:251], v243
    s_lshl_b32 s41, s2, s43
    v_mfma_f32_16x16x32_bf16 v[188:191], a[24:27], v[36:39], 0
    s_and_b32 s41, s41, 7
    ds_read_b32 a252, v244
    ds_read_b32 a253, v245
    s_mov_b32 s19, 0x00020000
    v_mfma_f32_16x16x32_bf16 v[16:19], v[166:169], v[48:51], v[152:155]
    s_waitcnt lgkmcnt(14)
    ds_read_b128 v[100:103], v231 offset:16384
    ds_read_b64_tr_b16 a[36:37], v209 offset:10240
    s_mov_b32 s50, 1
    v_mfma_f32_16x16x32_bf16 v[144:147], a[28:31], v[32:35], 0
    s_cmp_ge_u32 s40, 162
    s_cselect_b32 s22, s24, s22
    s_cselect_b32 s23, s25, s23
    ds_read_b64_tr_b16 a[38:39], v210 offset:10240
    ds_read_b64_tr_b16 a[40:41], v209 offset:10272
    s_cmp_ge_u32 s40, 81
    s_cselect_b32 s16, s22, s20
    s_cselect_b32 s17, s23, s21
    s_mov_b32 s18, 5308416
    s_cselect_b32 s35, 81, 0
    s_movk_i32 s46, 0x2400
    s_cselect_b32 s51, 1152, s46
    s_cselect_b32 s52, 1, 0
    s_movk_i32 s46, 1152
    s_cselect_b32 s54, 663552, s46
    v_mfma_f32_16x16x32_bf16 v[20:23], v[164:167], v[48:51], v[152:155]
    s_sub_u32 s40, s40, s35
    ds_read_b64_tr_b16 a[42:43], v210 offset:10272
    ds_read_b64_tr_b16 a[44:45], v209 offset:10304
    s_mul_i32 s42, s40, 57
    v_mfma_f32_16x16x32_bf16 v[192:195], a[28:31], v[36:39], 0
    s_waitcnt lgkmcnt(15)
    ds_read_b64_tr_b16 a[46:47], v210 offset:10304
    ds_read_b64_tr_b16 a[48:49], v209 offset:10336
    s_lshr_b32 s42, s42, 9
    v_mfma_f32_16x16x32_bf16 v[24:27], v[166:169], v[52:55], v[236:239]
    s_mul_i32 s35, s42, 9
    ds_read_b64_tr_b16 a[50:51], v210 offset:10336
    ds_read_b64_tr_b16 a[52:53], v209 offset:10368
    s_sub_u32 s43, s40, s35
    v_mfma_f32_16x16x32_bf16 v[148:151], a[32:35], v[32:35], 0
    s_mul_i32 s44, s41, s54
    ds_read_b64_tr_b16 a[54:55], v210 offset:10368
    v_cvt_pk_bf16_f32 v40, v104, v105
    s_cmp_lt_u32 s42, 8
    s_cselect_b32 s53, s52, 0
    v_mfma_f32_16x16x32_bf16 v[28:31], v[164:167], v[52:55], v[236:239]
    s_mul_i32 s34, s53, s41
    v_cvt_pk_bf16_f32 v41, v106, v107
    v_cvt_pk_bf16_f32 v42, v108, v109
    s_xor_b32 s35, s42, s34
    v_mfma_f32_16x16x32_bf16 v[196:199], a[32:35], v[36:39], 0
    s_waitcnt lgkmcnt(8)
    v_cvt_pk_bf16_f32 v43, v110, v111
    v_cvt_pk_bf16_f32 v44, v112, v113
    s_xor_b32 s34, s35, s53
    v_cvt_pk_bf16_f32 v45, v114, v115
    v_cvt_pk_bf16_f32 v46, v116, v117
    v_cvt_pk_bf16_f32 v47, v118, v119
    v_mfma_f32_16x16x32_bf16 v[132:135], a[36:39], v[40:43], v[132:135]
    s_sub_u32 s34, s34, s35
    buffer_load_dwordx4 v206, s[12:15], s28 offen lds
    v_mfma_f32_16x16x32_bf16 v[180:183], a[36:39], v[44:47], v[180:183]
    s_waitcnt lgkmcnt(6)
    s_add_u32 m0, s29, 65536
    s_waitcnt vmcnt(5)
    s_barrier
    ds_read_b64_tr_b16 a[56:57], v209 offset:20480
    v_cvt_pk_bf16_f32 v48, v16, v17
    s_lshl_b32 s34, s34, 7
    v_mfma_f32_16x16x32_bf16 v[136:139], a[40:43], v[40:43], v[136:139]
    s_add_u32 s54, s54, s34
    ds_read_b64_tr_b16 a[58:59], v210 offset:20480
    v_cvt_pk_bf16_f32 v49, v18, v19
    s_lshl_b32 s35, s35, 7
    v_mfma_f32_16x16x32_bf16 v[184:187], a[40:43], v[44:47], v[184:187]
    s_waitcnt lgkmcnt(6)
    buffer_load_dwordx4 v207, s[12:15], s28 offen lds
    v_mfma_f32_16x16x32_bf16 v[140:143], a[44:47], v[40:43], v[140:143]
    s_add_u32 m0, s29, 81920
    ds_read_b64_tr_b16 a[60:61], v209 offset:20512
    ds_read_b64_tr_b16 a[62:63], v210 offset:20512
    v_mfma_f32_16x16x32_bf16 v[188:191], a[44:47], v[44:47], v[188:191]
    s_add_u32 s28, s28, 147456
    ds_read_b64_tr_b16 a[64:65], v209 offset:20544
    v_cvt_pk_bf16_f32 v50, v20, v21
    v_mfma_f32_16x16x32_bf16 v[104:107], v[166:169], v[56:59], v[152:155]
    s_waitcnt lgkmcnt(7)
    ds_read_b64_tr_b16 a[66:67], v210 offset:20544
    v_cvt_pk_bf16_f32 v51, v22, v23
    v_mfma_f32_16x16x32_bf16 v[144:147], a[48:51], v[40:43], v[144:147]
    s_cmp_ge_u32 s28, 663552
    ds_read_b64_tr_b16 a[68:69], v209 offset:20576
    v_cvt_pk_bf16_f32 v52, v24, v25
    v_mfma_f32_16x16x32_bf16 v[108:111], v[164:167], v[56:59], v[152:155]
    s_cselect_b32 s36, 663552, 0
    ds_read_b64_tr_b16 a[70:71], v210 offset:20576
    v_cvt_pk_bf16_f32 v53, v26, v27
    v_mfma_f32_16x16x32_bf16 v[192:195], a[48:51], v[44:47], v[192:195]
    s_sub_u32 s28, s28, s36
    ds_read_b64_tr_b16 a[72:73], v209 offset:20608
    v_cvt_pk_bf16_f32 v54, v28, v29
    s_add_u32 s44, s44, s35
    v_mfma_f32_16x16x32_bf16 v[112:115], v[166:169], v[60:63], v[236:239]
    s_waitcnt lgkmcnt(9)
    buffer_load_dwordx4 v203, s[12:15], s28 offen lds
    v_mfma_f32_16x16x32_bf16 v[148:151], a[52:55], v[40:43], v[148:151]
    s_add_u32 m0, s29, 82944
    ds_read_b64_tr_b16 a[74:75], v210 offset:20608
    v_cvt_pk_bf16_f32 v55, v30, v31
    s_mul_i32 s35, s43, s51
    v_mfma_f32_16x16x32_bf16 v[116:119], v[164:167], v[60:63], v[236:239]
    s_lshl_b32 s35, s35, 6
    s_add_u32 s44, s44, s35
    s_add_u32 s54, s54, s44
    s_lshl_b32 s45, s51, 3
    v_mfma_f32_16x16x32_bf16 v[196:199], a[52:55], v[44:47], v[196:199]
    s_waitcnt lgkmcnt(8)
    buffer_load_dwordx4 v204, s[12:15], s28 offen lds
    v_mfma_f32_16x16x32_bf16 v[132:135], a[56:59], v[48:51], v[132:135]
    s_add_u32 m0, s29, 83968
    s_waitcnt vmcnt(7)
    s_barrier
    s_cmp_lg_u32 s32, 0
    s_cbranch_scc1 L_p1_nf
L_p1_dc:
    v_cmp_eq_u32 vcc, 0, v220
    s_cbranch_vccnz L_p1_dr
L_p1_df:
    s_mov_b64 exec, 1
    buffer_store_dword v160, v164, s[8:11], s27 offen sc1
    s_mov_b64 exec, -1
L_p1_nf:
    v_mov_b32 v224, v220
    ds_read_b64_tr_b16 a[76:77], v209 offset:30720
    v_cvt_pk_bf16_f32 v56, v104, v105
    s_mov_b32 s46, s45
    v_mfma_f32_16x16x32_bf16 v[180:183], a[56:59], v[52:55], v[180:183]
    s_waitcnt lgkmcnt(7)
    ds_read_b64_tr_b16 a[78:79], v210 offset:30720
    v_cvt_pk_bf16_f32 v57, v106, v107
    s_mul_i32 s47, s51, -22
    v_mfma_f32_16x16x32_bf16 v[136:139], a[60:63], v[48:51], v[136:139]
    s_lshr_b32 s48, s42, 1
    buffer_load_dwordx4 v205, s[12:15], s28 offen lds
    v_mfma_f32_16x16x32_bf16 v[184:187], a[60:63], v[52:55], v[184:187]
    s_waitcnt lgkmcnt(6)
    ds_read_b64_tr_b16 a[80:81], v209 offset:30752
    v_cvt_pk_bf16_f32 v58, v108, v109
    v_mfma_f32_16x16x32_bf16 v[140:143], a[64:67], v[48:51], v[140:143]
    s_add_u32 m0, s29, 84992
    ds_read_b64_tr_b16 a[82:83], v210 offset:30752
    v_cvt_pk_bf16_f32 v59, v110, v111
    s_and_b32 s35, s42, 1
    v_mfma_f32_16x16x32_bf16 v[188:191], a[64:67], v[52:55], v[188:191]
    s_lshl_b32 s35, s35, 2
    buffer_load_dwordx4 v206, s[12:15], s28 offen lds
    v_mfma_f32_16x16x32_bf16 v[16:19], v[166:169], v[64:67], v[152:155]
    s_waitcnt lgkmcnt(6)
    ds_read_b64_tr_b16 a[84:85], v209 offset:30784
    ds_read_b64_tr_b16 a[86:87], v210 offset:30784
    v_mfma_f32_16x16x32_bf16 v[144:147], a[68:71], v[48:51], v[144:147]
    s_add_u32 m0, s29, 86016
    ds_read_b64_tr_b16 a[88:89], v209 offset:30816
    v_cvt_pk_bf16_f32 v60, v112, v113
    s_add_u32 s35, s35, 1
    v_mfma_f32_16x16x32_bf16 v[20:23], v[164:167], v[64:67], v[152:155]
    s_movk_i32 s49, 18432
    buffer_load_dwordx4 v207, s[12:15], s28 offen lds
    v_mfma_f32_16x16x32_bf16 v[192:195], a[68:71], v[52:55], v[192:195]
    s_add_u32 m0, s29, 0
    ds_read_b64_tr_b16 a[90:91], v210 offset:30816
    ds_read_b64_tr_b16 a[92:93], v209 offset:30848
    v_mfma_f32_16x16x32_bf16 v[24:27], v[166:169], v[68:71], v[236:239]
    s_waitcnt lgkmcnt(9)
    ds_read_b64_tr_b16 a[94:95], v210 offset:30848
    v_cvt_pk_bf16_f32 v61, v114, v115
    v_mfma_f32_16x16x32_bf16 v[148:151], a[72:75], v[48:51], v[148:151]
    s_add_u32 s28, s28, 147456
    v_cvt_pk_bf16_f32 v62, v116, v117
    v_cvt_pk_bf16_f32 v63, v118, v119
    v_mfma_f32_16x16x32_bf16 v[28:31], v[164:167], v[68:71], v[236:239]
    s_cmp_ge_u32 s28, 663552
    s_cselect_b32 s36, 663552, 0
    s_sub_u32 s28, s28, s36
    v_mfma_f32_16x16x32_bf16 v[196:199], a[72:75], v[52:55], v[196:199]
    s_waitcnt lgkmcnt(8)
    s_cmp_ge_u32 s32, 2
    s_cselect_b32 s28, 0x40000000, s28
    s_sub_u32 s53, 8, s42
    v_mfma_f32_16x16x32_bf16 v[132:135], a[76:79], v[56:59], v[132:135]
    s_lshr_b32 s34, s42, 3
    buffer_load_dwordx4 v203, s[12:15], s28 offen lds
    v_mfma_f32_16x16x32_bf16 v[180:183], a[76:79], v[60:63], v[180:183]
    s_waitcnt lgkmcnt(6)
    s_add_u32 m0, s29, 1024
    s_waitcnt vmcnt(6)
    s_barrier
    v_add_u32 v209, 40960, v209
    v_add_u32 v210, 40960, v210
    ds_read_b64_tr_b16 a[96:97], v209 offset:0
    v_cvt_pk_bf16_f32 v64, v16, v17
    s_or_b32 s34, s34, s52
    s_cselect_b32 s35, s53, s35
    s_cselect_b32 s48, 0, s48
    s_cselect_b32 s49, 331776, s49
    v_mfma_f32_16x16x32_bf16 v[136:139], a[80:83], v[56:59], v[136:139]
    s_lshl_b32 s34, s41, 2
    ds_read_b64_tr_b16 a[98:99], v210 offset:0
    v_cvt_pk_bf16_f32 v65, v18, v19
    s_add_u32 s48, s48, s34
    v_mfma_f32_16x16x32_bf16 v[184:187], a[80:83], v[60:63], v[184:187]
    s_waitcnt lgkmcnt(6)
    buffer_load_dwordx4 v204, s[12:15], s28 offen lds
    v_mfma_f32_16x16x32_bf16 v[140:143], a[84:87], v[56:59], v[140:143]
    s_add_u32 m0, s29, 2048
    ds_read_b64_tr_b16 a[104:105], v209 offset:32
    ds_read_b64_tr_b16 a[106:107], v210 offset:32
    s_mul_i32 s48, s48, 331776
    v_mfma_f32_16x16x32_bf16 v[188:191], a[84:87], v[60:63], v[188:191]
    s_add_u32 s48, s48, 0x00800000
    ds_read_b64_tr_b16 a[108:109], v209 offset:64
    v_cvt_pk_bf16_f32 v66, v20, v21
    s_mul_i32 s34, s52, 9
    v_mfma_f32_16x16x32_bf16 v[104:107], v[166:169], v[72:75], v[152:155]
    s_waitcnt lgkmcnt(7)
    buffer_load_dwordx4 v205, s[12:15], s28 offen lds
    v_mfma_f32_16x16x32_bf16 v[144:147], a[88:91], v[56:59], v[144:147]
    s_add_u32 m0, s29, 3072
    ds_read_b64_tr_b16 a[110:111], v210 offset:64
    ds_read_b64_tr_b16 a[112:113], v209 offset:96
    s_add_u32 s35, s35, s34
    v_mfma_f32_16x16x32_bf16 v[108:111], v[164:167], v[72:75], v[152:155]
    s_mul_i32 s35, s35, 18
    ds_read_b64_tr_b16 a[114:115], v210 offset:96
    v_cvt_pk_bf16_f32 v67, v22, v23
    s_lshr_b32 s34, s43, 1
    v_mfma_f32_16x16x32_bf16 v[192:195], a[88:91], v[60:63], v[192:195]
    s_mul_i32 s34, s34, s52
    buffer_load_dwordx4 v206, s[12:15], s28 offen lds
    v_mfma_f32_16x16x32_bf16 v[112:115], v[166:169], v[76:79], v[236:239]
    s_waitcnt lgkmcnt(8)
    ds_read_b64_tr_b16 a[116:117], v209 offset:128
    ds_read_b64_tr_b16 a[118:119], v210 offset:128
    v_mfma_f32_16x16x32_bf16 v[148:151], a[92:95], v[56:59], v[148:151]
    s_add_u32 m0, s29, 4096
    v_cvt_pk_bf16_f32 v68, v24, v25
    v_cvt_pk_bf16_f32 v69, v26, v27
    s_sub_u32 s35, s35, s34
    v_mfma_f32_16x16x32_bf16 v[116:119], v[164:167], v[76:79], v[236:239]
    s_lshl_b32 s34, s43, 1
    buffer_load_dwordx4 v207, s[12:15], s28 offen lds
    s_add_u32 s35, s35, s34
    v_mfma_f32_16x16x32_bf16 v[196:199], a[92:95], v[60:63], v[196:199]
    s_waitcnt lgkmcnt(8)
    v_cvt_pk_bf16_f32 v70, v28, v29
    v_cvt_pk_bf16_f32 v71, v30, v31
    s_lshl_b32 s35, s35, 10
    s_nop 0
    v_mfma_f32_16x16x32_bf16 v[180:183], a[96:99], v[68:71], v[180:183]
    s_add_u32 s48, s48, s35
    ds_read_b64_tr_b16 a[120:121], v209 offset:10240
    ds_read_b64_tr_b16 a[122:123], v210 offset:10240
    s_sub_u32 s34, 13, s43
    v_mfma_f32_16x16x32_bf16 v[16:19], v[166:169], v[80:83], v[152:155]
    s_waitcnt lgkmcnt(8)
    ds_read_b64_tr_b16 a[124:125], v209 offset:10272
    ds_read_b64_tr_b16 a[126:127], v210 offset:10272
    s_and_b32 s52, s52, s43
    s_cselect_b32 s34, s34, 1
    v_mfma_f32_16x16x32_bf16 v[184:187], a[104:107], v[68:71], v[184:187]
    s_lshl_b32 s34, s34, 10
    ds_read_b64_tr_b16 a[128:129], v209 offset:10304
    ds_read_b64_tr_b16 a[130:131], v210 offset:10304
    v_mov_b32 v4, v2
    v_mfma_f32_16x16x32_bf16 v[20:23], v[164:167], v[80:83], v[152:155]
    s_waitcnt lgkmcnt(10)
    ds_read_b64_tr_b16 a[132:133], v209 offset:10336
    ds_read_b64_tr_b16 a[134:135], v210 offset:10336
    v_mul_u32_u24 v8, 508, v7
    v_mfma_f32_16x16x32_bf16 v[188:191], a[108:111], v[68:71], v[188:191]
    ds_read_b64_tr_b16 a[136:137], v209 offset:10368
    v_cvt_pk_bf16_f32 v72, v104, v105
    v_sub_u32 v8, v4, v8
    v_mfma_f32_16x16x32_bf16 v[24:27], v[166:169], v[84:87], v[236:239]
    s_waitcnt lgkmcnt(11)
    ds_read_b64_tr_b16 a[138:139], v210 offset:10368
    v_cvt_pk_bf16_f32 v73, v106, v107
    v_add_u32 v3, 4096, v8
    v_mfma_f32_16x16x32_bf16 v[192:195], a[112:115], v[68:71], v[192:195]
    v_cvt_pk_bf16_f32 v74, v108, v109
    v_cvt_pk_bf16_f32 v75, v110, v111
    v_mov_b32 v9, 0x3f803f80
    v_mfma_f32_16x16x32_bf16 v[28:31], v[164:167], v[84:87], v[236:239]
    s_waitcnt lgkmcnt(10)
    v_cvt_pk_bf16_f32 v76, v112, v113
    v_cvt_pk_bf16_f32 v77, v114, v115
    v_accvgpr_write_b32 a5, v9
    v_mfma_f32_16x16x32_bf16 v[196:199], a[116:119], v[68:71], v[196:199]
    s_waitcnt lgkmcnt(8)
    v_cvt_pk_bf16_f32 v78, v116, v117
    v_cvt_pk_bf16_f32 v79, v118, v119
    v_accvgpr_write_b32 a7, v9
    s_nop 0
    v_mfma_f32_16x16x32_bf16 v[180:183], a[120:123], v[76:79], v[180:183]
    s_waitcnt vmcnt(5)
    s_barrier
    ds_read_b64_tr_b16 a[140:141], v209 offset:20480
    ds_read_b64_tr_b16 a[142:143], v210 offset:20480
    v_and_b32 v8, 31, v1
    v_mfma_f32_16x16x32_bf16 v[104:107], v[166:169], v[88:91], v[152:155]
    s_waitcnt lgkmcnt(8)
    ds_read_b64_tr_b16 a[144:145], v209 offset:20512
    ds_read_b64_tr_b16 a[146:147], v210 offset:20512
    v_mul_u32_u24 v9, 18, v7
    v_mfma_f32_16x16x32_bf16 v[184:187], a[124:127], v[76:79], v[184:187]
    ds_read_b64_tr_b16 a[148:149], v209 offset:20544
    ds_read_b64_tr_b16 a[150:151], v210 offset:20544
    v_add_u32 v9, v9, v8
    v_mfma_f32_16x16x32_bf16 v[108:111], v[164:167], v[88:91], v[152:155]
    s_waitcnt lgkmcnt(10)
    ds_read_b64_tr_b16 a[152:153], v209 offset:20576
    ds_read_b64_tr_b16 a[154:155], v210 offset:20576
    v_cmp_lt_u32 vcc, 17, v8
    v_mov_b32 v10, 37
    v_and_b32 v8, 27, v8
    v_cndmask_b32 v9, v9, v10, vcc
    v_mfma_f32_16x16x32_bf16 v[188:191], a[128:131], v[76:79], v[188:191]
    ds_read_b64_tr_b16 a[156:157], v209 offset:20608
    v_cvt_pk_bf16_f32 v80, v16, v17
    v_cmp_eq_u32 vcc, 18, v8
    v_mov_b32 v10, 36
    s_nop 0
    v_cndmask_b32 v9, v9, v10, vcc
    v_mfma_f32_16x16x32_bf16 v[112:115], v[166:169], v[92:95], v[236:239]
    s_waitcnt lgkmcnt(11)
    ds_read_b64_tr_b16 a[158:159], v210 offset:20608
    v_cvt_pk_bf16_f32 v81, v18, v19
    v_lshlrev_b32 v12, 4, v9
    v_mfma_f32_16x16x32_bf16 v[192:195], a[132:135], v[76:79], v[192:195]
    v_cvt_pk_bf16_f32 v82, v20, v21
    v_cvt_pk_bf16_f32 v83, v22, v23
    v_and_b32 v8, 7, v1
    v_mfma_f32_16x16x32_bf16 v[116:119], v[164:167], v[92:95], v[236:239]
    s_waitcnt lgkmcnt(10)
    v_cvt_pk_bf16_f32 v84, v24, v25
    v_cvt_pk_bf16_f32 v85, v26, v27
    v_bfe_u32 v9, v1, 3, 1
    v_mfma_f32_16x16x32_bf16 v[196:199], a[136:139], v[76:79], v[196:199]
    s_waitcnt lgkmcnt(8)
    v_cvt_pk_bf16_f32 v86, v28, v29
    v_cvt_pk_bf16_f32 v87, v30, v31
    v_lshrrev_b32 v10, 4, v1
    s_nop 0
    v_mfma_f32_16x16x32_bf16 v[180:183], a[140:143], v[84:87], v[180:183]
    ds_read_b64_tr_b16 a[160:161], v209 offset:30720
    ds_read_b64_tr_b16 a[162:163], v210 offset:30720
    v_lshlrev_b32 v250, 8, v10
    v_mfma_f32_16x16x32_bf16 v[16:19], v[166:169], v[96:99], v[152:155]
    s_waitcnt lgkmcnt(8)
    ds_read_b64_tr_b16 a[164:165], v209 offset:30752
    ds_read_b64_tr_b16 a[166:167], v210 offset:30752
    v_lshl_add_u32 v250, v8, 4, v250
    v_mfma_f32_16x16x32_bf16 v[184:187], a[144:147], v[84:87], v[184:187]
    ds_read_b64_tr_b16 a[168:169], v209 offset:30784
    ds_read_b64_tr_b16 a[170:171], v210 offset:30784
    v_mul_u32_u24 v11, s34, v9
    v_mfma_f32_16x16x32_bf16 v[20:23], v[164:167], v[96:99], v[152:155]
    s_waitcnt lgkmcnt(10)
    ds_read_b64_tr_b16 a[172:173], v209 offset:30816
    ds_read_b64_tr_b16 a[174:175], v210 offset:30816
    v_add_u32 v250, v250, v11
    v_mfma_f32_16x16x32_bf16 v[188:191], a[148:151], v[84:87], v[188:191]
    ds_read_b64_tr_b16 a[176:177], v209 offset:30848
    v_cvt_pk_bf16_f32 v88, v104, v105
    v_lshl_add_u32 v11, v9, 2, v7
    v_mfma_f32_16x16x32_bf16 v[24:27], v[166:169], v[100:103], v[236:239]
    s_waitcnt lgkmcnt(11)
    ds_read_b64_tr_b16 a[178:179], v210 offset:30848
    v_cvt_pk_bf16_f32 v89, v106, v107
    v_lshl_add_u32 v11, v6, 5, v11
    v_mfma_f32_16x16x32_bf16 v[192:195], a[152:155], v[84:87], v[192:195]
    v_cvt_pk_bf16_f32 v90, v108, v109
    v_cvt_pk_bf16_f32 v91, v110, v111
    v_mul_u32_u24 v248, s51, v11
    v_mfma_f32_16x16x32_bf16 v[28:31], v[164:167], v[100:103], v[236:239]
    s_waitcnt lgkmcnt(10)
    v_cvt_pk_bf16_f32 v92, v112, v113
    v_cvt_pk_bf16_f32 v93, v114, v115
    v_lshl_add_u32 v248, v8, 4, v248
    v_mfma_f32_16x16x32_bf16 v[196:199], a[156:159], v[84:87], v[196:199]
    s_waitcnt lgkmcnt(8)
    v_cvt_pk_bf16_f32 v94, v116, v117
    v_cvt_pk_bf16_f32 v95, v118, v119
    s_mul_i32 s35, s32, 3
    v_mfma_f32_16x16x32_bf16 v[132:135], a[160:163], v[88:91], v[132:135]
    s_sub_u32 s35, s35, 4
    s_waitcnt vmcnt(0)
    s_barrier
    v_subrev_u32 v209, 61440, v209
    v_subrev_u32 v210, 61440, v210
    ds_read_b64_tr_b16 a[180:181], v209 offset:0
    ds_read_b64_tr_b16 a[182:183], v210 offset:0
    s_max_i32 s35, s35, s32
    v_mfma_f32_16x16x32_bf16 v[180:183], a[160:163], v[92:95], v[180:183]
    s_waitcnt lgkmcnt(8)
    ds_read_b64_tr_b16 a[184:185], v209 offset:32
    ds_read_b64_tr_b16 a[186:187], v210 offset:32
    s_lshl_b32 s34, s31, 5
    v_mfma_f32_16x16x32_bf16 v[136:139], a[164:167], v[88:91], v[136:139]
    s_add_u32 s34, s34, s30
    ds_read_b64_tr_b16 a[188:189], v209 offset:64
    ds_read_b64_tr_b16 a[190:191], v210 offset:64
    s_mul_i32 s34, s34, 9
    v_mfma_f32_16x16x32_bf16 v[184:187], a[164:167], v[92:95], v[184:187]
    s_waitcnt lgkmcnt(10)
    ds_read_b64_tr_b16 a[192:193], v209 offset:96
    v_cvt_pk_bf16_f32 v96, v16, v17
    s_add_u32 s35, s35, s34
    v_mfma_f32_16x16x32_bf16 v[140:143], a[168:171], v[88:91], v[140:143]
    s_lshl_b32 s35, s35, 13
    ds_read_b64_tr_b16 a[194:195], v210 offset:96
    v_cvt_pk_bf16_f32 v97, v18, v19
    s_add_u32 s24, s35, 0x013ff800
    v_mfma_f32_16x16x32_bf16 v[188:191], a[168:171], v[92:95], v[188:191]
    s_waitcnt lgkmcnt(10)
    ds_read_b64_tr_b16 a[196:197], v209 offset:128
    v_cvt_pk_bf16_f32 v98, v20, v21
    v_lshrrev_b32 v249, 3, v1
    v_mfma_f32_16x16x32_bf16 v[144:147], a[172:175], v[88:91], v[144:147]
    ds_read_b64_tr_b16 a[198:199], v210 offset:128
    v_cvt_pk_bf16_f32 v99, v22, v23
    v_lshl_add_u32 v249, v249, 7, v2
    v_mfma_f32_16x16x32_bf16 v[192:195], a[172:175], v[92:95], v[192:195]
    s_waitcnt lgkmcnt(10)
    v_cvt_pk_bf16_f32 v100, v24, v25
    v_cvt_pk_bf16_f32 v101, v26, v27
    s_sub_u32 s35, s2, 97
    v_mfma_f32_16x16x32_bf16 v[148:151], a[176:179], v[88:91], v[148:151]
    s_cmp_lt_u32 s35, 80
    s_cselect_b32 s26, 2, 1
    v_cvt_pk_bf16_f32 v102, v28, v29
    v_cvt_pk_bf16_f32 v103, v30, v31
    s_max_i32 s35, s35, 0
    v_mfma_f32_16x16x32_bf16 v[196:199], a[176:179], v[92:95], v[196:199]
    s_waitcnt lgkmcnt(8)
    s_min_u32 s35, s35, 80
    s_add_u32 s35, s35, 256
    s_cmp_eq_u32 s32, 3
    s_cselect_b32 s26, s26, 1
    s_cselect_b32 s35, s35, 0
    v_mfma_f32_16x16x32_bf16 v[180:183], a[180:183], v[100:103], v[180:183]
    s_waitcnt lgkmcnt(6)
    s_add_u32 s23, s35, s2
    s_lshl_b32 s23, s23, 13
    s_add_u32 s23, s23, 0x025ff800
    v_mfma_f32_16x16x32_bf16 v[184:187], a[184:187], v[100:103], v[184:187]
    s_waitcnt lgkmcnt(4)
    s_and_b32 s56, s2, 3
    s_bfe_u32 s57, s2, 0x00010003
    s_lshl_b32 s56, s56, 3
    v_mfma_f32_16x16x32_bf16 v[188:191], a[188:191], v[100:103], v[188:191]
    s_waitcnt lgkmcnt(2)
    s_lshl_b32 s57, s57, 2
    s_add_u32 s56, s56, s32
    s_add_u32 s56, s56, s57
    v_mfma_f32_16x16x32_bf16 v[192:195], a[192:195], v[100:103], v[192:195]
    s_waitcnt lgkmcnt(0)
    s_mul_i32 s56, s56, 331776
    s_add_u32 s56, s56, 0x00800000
    s_mul_i32 s66, s32, -3072
    v_mfma_f32_16x16x32_bf16 v[196:199], a[196:199], v[100:103], v[196:199]
    s_add_u32 s66, s66, 16384
    v_accvgpr_write_b32 a12, 0
    v_accvgpr_write_b32 a13, 0
    v_accvgpr_write_b32 a14, 0
    v_mfma_f32_16x16x32_bf16 v[132:135], a[96:99], v[64:67], v[132:135]
    v_accvgpr_write_b32 a15, 0
    s_mov_b32 s68, 0
    s_mov_b32 s69, -1
    v_mfma_f32_16x16x32_bf16 v[136:139], a[104:107], v[64:67], v[136:139]
    ds_write_b128 v232, v[180:183] offset:24576
    v_lshl_add_u32 v8, v6, 1, v7
    v_mfma_f32_16x16x32_bf16 v[140:143], a[108:111], v[64:67], v[140:143]
    v_lshlrev_b32 v8, 8, v8
    v_lshl_add_u32 v8, v5, 3, v8
    s_mul_i32 s35, s32, 2304
    v_mfma_f32_16x16x32_bf16 v[144:147], a[112:115], v[64:67], v[144:147]
    ds_write_b128 v232, v[184:187] offset:28672
    s_add_u32 s35, s35, 73728
    v_mfma_f32_16x16x32_bf16 v[148:151], a[116:119], v[64:67], v[148:151]
    v_add_u32 v8, s35, v8
    buffer_load_dwordx4 v[220:223], v218, s[8:11], s37 offen sc1
    v_mfma_f32_16x16x32_bf16 v[132:135], a[120:123], v[72:75], v[132:135]
    ds_write_b128 v232, v[188:191] offset:32768
    v_mfma_f32_16x16x32_bf16 v[136:139], a[124:127], v[72:75], v[136:139]
    v_mfma_f32_16x16x32_bf16 v[140:143], a[128:131], v[72:75], v[140:143]
    ds_write_b128 v232, v[192:195] offset:36864
    v_mfma_f32_16x16x32_bf16 v[144:147], a[132:135], v[72:75], v[144:147]
    v_mfma_f32_16x16x32_bf16 v[148:151], a[136:139], v[72:75], v[148:151]
    ds_write_b128 v232, v[196:199] offset:40960
    v_mfma_f32_16x16x32_bf16 v[132:135], a[140:143], v[80:83], v[132:135]
    v_mfma_f32_16x16x32_bf16 v[136:139], a[144:147], v[80:83], v[136:139]
    s_waitcnt lgkmcnt(0)
    v_mfma_f32_16x16x32_bf16 v[140:143], a[148:151], v[80:83], v[140:143]
    s_barrier
    ds_read_b128 v[104:107], v233 offset:24576
    ds_read_b128 v[108:111], v233 offset:28672
    v_mfma_f32_16x16x32_bf16 v[144:147], a[152:155], v[80:83], v[144:147]
    ds_read_b128 v[112:115], v233 offset:32768
    ds_read_b128 v[116:119], v233 offset:36864
    v_mfma_f32_16x16x32_bf16 v[148:151], a[156:159], v[80:83], v[148:151]
    ds_read_b128 v[120:123], v233 offset:40960
    v_mfma_f32_16x16x32_bf16 v[132:135], a[180:183], v[96:99], v[132:135]
    v_mfma_f32_16x16x32_bf16 v[136:139], a[184:187], v[96:99], v[136:139]
    v_mfma_f32_16x16x32_bf16 v[140:143], a[188:191], v[96:99], v[140:143]
    v_mfma_f32_16x16x32_bf16 v[144:147], a[192:195], v[96:99], v[144:147]
    v_mfma_f32_16x16x32_bf16 v[148:151], a[196:199], v[96:99], v[148:151]
    s_mov_b32 s12, s70
    s_mov_b32 s13, s71
    s_waitcnt lgkmcnt(4)
    s_nop 0
    v_add_f32 v132, v132, v104
    v_add_f32 v133, v133, v105
    v_add_f32 v134, v134, v106
    v_add_f32 v135, v135, v107
    v_mul_f32 v132, v132, v156
    v_mul_f32 v133, v133, v156
    v_mul_f32 v134, v134, v156
    v_mul_f32 v135, v135, v156
    v_cvt_pk_bf16_f32 v132, v132, v133
    v_cvt_pk_bf16_f32 v133, v134, v135
    ds_write_b64 v217, v[132:133] offset:0
    s_waitcnt lgkmcnt(4)
    v_add_f32 v136, v136, v108
    v_add_f32 v137, v137, v109
    v_add_f32 v138, v138, v110
    v_add_f32 v139, v139, v111
    v_mul_f32 v136, v136, v156
    v_mul_f32 v137, v137, v156
    v_mul_f32 v138, v138, v156
    v_mul_f32 v139, v139, v156
    v_cvt_pk_bf16_f32 v136, v136, v137
    v_cvt_pk_bf16_f32 v137, v138, v139
    ds_write_b64 v217, v[136:137] offset:512
    s_waitcnt lgkmcnt(4)
    v_add_f32 v140, v140, v112
    v_add_f32 v141, v141, v113
    v_add_f32 v142, v142, v114
    v_add_f32 v143, v143, v115
    v_mul_f32 v140, v140, v156
    v_mul_f32 v141, v141, v156
    v_mul_f32 v142, v142, v156
    v_mul_f32 v143, v143, v156
    v_cvt_pk_bf16_f32 v140, v140, v141
    v_cvt_pk_bf16_f32 v141, v142, v143
    ds_write_b64 v217, v[140:141] offset:1024
    s_waitcnt lgkmcnt(4)
    v_add_f32 v144, v144, v116
    v_add_f32 v145, v145, v117
    v_add_f32 v146, v146, v118
    v_add_f32 v147, v147, v119
    v_mul_f32 v144, v144, v156
    v_mul_f32 v145, v145, v156
    v_mul_f32 v146, v146, v156
    v_mul_f32 v147, v147, v156
    v_cvt_pk_bf16_f32 v144, v144, v145
    v_cvt_pk_bf16_f32 v145, v146, v147
L_tqa2000:
    s_cbranch_execz L_tqra
    ds_write_b64 v217, v[144:145] offset:1536
    s_waitcnt lgkmcnt(4)
    v_add_f32 v148, v148, v120
    v_add_f32 v149, v149, v121
    v_add_f32 v150, v150, v122
    v_add_f32 v151, v151, v123
    v_mul_f32 v148, v148, v156
    v_mul_f32 v149, v149, v156
    v_mul_f32 v150, v150, v156
    v_mul_f32 v151, v151, v156
    v_cvt_pk_bf16_f32 v148, v148, v149
    v_cvt_pk_bf16_f32 v149, v150, v151
    s_mov_b32 exec_hi, 0
    ds_write_b64 v217, v[148:149] offset:2048
    s_mov_b32 exec_hi, -1
    buffer_load_dwordx4 v[226:229], v218, s[8:11], s37 offen sc1
    ds_read_b64 v[82:83], v8 offset:0
    ds_read_b64 v[84:85], v8 offset:128
    ds_read_b64 v[86:87], v8 offset:256
    ds_read_b64 v[98:99], v8 offset:1152
    ds_read_b64 v[100:101], v8 offset:1280
    ds_read_b64 v[102:103], v8 offset:1408
    s_waitcnt vmcnt(1)
    v_cmpx_ne_u32 vcc, 0, v224
    v_cmpx_ne_u32 vcc, 0, v220
    v_cmpx_ne_u32 vcc, 0, v221
    v_cmpx_ne_u32 vcc, 0, v222
    v_cmpx_ne_u32 vcc, 0, v223
    s_cmp_eq_u64 exec, -1
    s_mov_b64 exec, -1
    s_cbranch_scc1 L_p1_kg
    s_waitcnt vmcnt(0)
L_p1_kc:
    v_cmpx_ne_u32 vcc, 0, v224
    v_cmpx_ne_u32 vcc, 0, v226
    v_cmpx_ne_u32 vcc, 0, v227
    v_cmpx_ne_u32 vcc, 0, v228
    v_cmpx_ne_u32 vcc, 0, v229
    s_cmp_eq_u64 exec, -1
    s_mov_b64 exec, -1
    s_cbranch_scc0 L_p1_kr
L_p1_kg:
    s_lshl_b32 s35, s32, 10
    s_add_u32 s34, s35, 0x00240000
    s_mov_b32 m0, s35
    s_nop 0
    buffer_load_dwordx4 v2, s[8:11], s34 offen offset:0 lds
    s_add_u32 m0, m0, 4096
    s_add_u32 s34, s34, 4096
    buffer_load_dwordx4 v2, s[8:11], s34 offen offset:0 lds
    s_add_u32 m0, m0, 4096
    s_add_u32 s34, s34, 4096
    buffer_load_dwordx4 v2, s[8:11], s34 offen offset:0 lds
    s_add_u32 m0, m0, 4096
    s_add_u32 s34, s34, 4096
    buffer_load_dwordx4 v2, s[8:11], s34 offen offset:0 lds
    s_add_u32 m0, m0, 4096
    s_add_u32 s34, s34, 4096
    buffer_load_dwordx4 v2, s[8:11], s34 offen offset:0 lds
    s_add_u32 m0, m0, 4096
    s_add_u32 s34, s34, 4096
    buffer_load_dwordx4 v2, s[8:11], s34 offen offset:0 lds
    s_lshl_b32 s35, s32, 12
    s_add_u32 m0, s35, 24576
    s_add_u32 s34, s35, 0x00242000
    s_cmp_lt_u32 s40, 81
    s_cbranch_scc1 L_k2_tr
    v_and_b32 v8, 7, v1
    v_bfe_u32 v9, v1, 3, 1
    v_lshrrev_b32 v10, 4, v1
    v_lshlrev_b32 v250, 8, v10
    v_lshl_add_u32 v250, v8, 4, v250
    s_sub_u32 s40, s40, 81
    s_lshl_b32 s40, s40, 3
    s_add_u32 s40, s40, s41
    s_mov_b32 s18, 663552
    s_cmp_ge_u32 s40, 81
    s_cbranch_scc1 L_k2_wb
    s_mul_i32 s42, s40, 57
    s_lshr_b32 s42, s42, 9
    s_mul_i32 s35, s42, 9
    s_sub_u32 s43, s40, s35
    s_movk_i32 s45, 1152
    s_mul_i32 s44, s42, 82944
    s_cmp_eq_u32 s42, 8
    s_cselect_b32 s46, 19584, s45
    s_cselect_b32 s44, 18432, s44
    s_mov_b32 s47, s46
    s_movk_i32 s51, 288
    s_cselect_b32 s51, s51, 36
    s_movk_i32 s52, 144
    s_cselect_b32 s52, s52, 18
    s_movk_i32 s53, 72
    s_cselect_b32 s53, s53, 8
    s_lshl_b32 s35, s43, 7
    s_add_u32 s44, s44, s35
    v_mul_u32_u24 v248, s51, v9
    v_mul_u32_u24 v11, s52, v7
    v_add_u32 v248, v248, v11
    v_mul_u32_u24 v11, s53, v6
    v_add_u32 v248, v248, v11
    v_mul_u32_u24 v248, 1152, v248
    v_lshl_add_u32 v248, v8, 4, v248
    s_mul_i32 s48, s42, 9472
    s_add_u32 s48, s48, 0x00700000
    v_mul_u32_u24 v9, 4736, v9
    s_cmp_eq_u32 s43, 8
    s_cbranch_scc1 L_k2_wo8
    s_mul_i32 s35, s43, 85248
    s_add_u32 s48, s48, s35
    s_movk_i32 s49, 1024
    v_add_u32 v250, v250, v9
    s_branch L_k2_sdone
L_k2_wo8:
    s_add_u32 s48, s48, 4096
    s_mov_b32 s49, 170496
    v_lshl_add_u32 v250, v7, 8, v9
    v_lshl_add_u32 v250, v6, 6, v250
    v_bfe_u32 v11, v1, 1, 1
    v_mul_u32_u24 v11, 85248, v11
    v_add_u32 v250, v250, v11
    v_bfe_u32 v11, v1, 2, 1
    v_lshl_add_u32 v250, v11, 5, v250
    v_and_b32 v11, 1, v1
    v_lshl_add_u32 v250, v11, 4, v250
    s_branch L_k2_sdone
L_k2_wb:
    s_sub_u32 s40, s40, 81
    s_cmp_ge_u32 s40, 72
    s_cselect_b32 s50, 0, 2
    s_movk_i32 s45, 128
    s_movk_i32 s46, 128
    s_movk_i32 s47, 128
    s_lshr_b32 s35, s40, 1
    s_mul_i32 s35, s35, 18
    s_and_b32 s36, s40, 1
    s_lshl_b32 s36, s36, 3
    s_add_u32 s44, s35, s36
    s_mul_i32 s35, s40, 72
    s_sub_u32 s35, s35, 4592
    s_cmp_ge_u32 s40, 64
    s_cselect_b32 s44, s35, s44
    s_cselect_b32 s51, 8, 0
    s_mul_i32 s44, s44, 1152
    v_and_b32 v11, 6, v1
    v_mul_u32_u24 v11, s51, v11
    v_add_u32 v11, v11, v8
    v_mul_u32_u24 v248, 1152, v11
    v_lshrrev_b32 v11, 3, v1
    v_lshl_add_u32 v248, v11, 4, v248
    v_mul_u32_u24 v250, 85248, v11
    v_lshl_add_u32 v250, v8, 1, v250
    s_lshr_b32 s35, s40, 2
    s_mul_i32 s35, s35, 4736
    s_and_b32 s36, s40, 3
    s_lshl_b32 s36, s36, 4
    s_add_u32 s48, s35, s36
    s_add_u32 s48, s48, 0x00701200
    s_mov_b32 s49, 0
    s_branch L_k2_sdone
L_k2_tr:
    s_mov_b64 exec, 0
    s_bitcmp1_b32 s32, 0
    s_cbranch_scc1 L_tn1
    s_bitcmp1_b32 s2, 3
    s_cbranch_scc1 L_tn2
    s_bitcmp1_b32 s2, 4
    s_cbranch_scc1 L_tn3
    s_bitcmp1_b32 s2, 5
    s_cbranch_scc1 L_tn4
    s_bitcmp1_b32 s2, 6
    s_cbranch_scc1 L_tp16
    s_bitcmp1_b32 s2, 7
    s_cbranch_scc1 L_tp32
    s_branch L_tp0
L_tn4:
    s_bitcmp1_b32 s2, 6
    s_cbranch_scc1 L_tp24
    s_branch L_tp8
L_tn3:
    s_bitcmp1_b32 s2, 5
    s_cbranch_scc1 L_tn5
    s_bitcmp1_b32 s2, 6
    s_cbranch_scc1 L_tp20
    s_branch L_tp4
L_tn5:
    s_bitcmp1_b32 s2, 6
    s_cbranch_scc1 L_tp28
    s_branch L_tp12
L_tn2:
    s_bitcmp1_b32 s2, 4
    s_cbranch_scc1 L_tn6
    s_bitcmp1_b32 s2, 5
    s_cbranch_scc1 L_tn7
    s_bitcmp1_b32 s2, 6
    s_cbranch_scc1 L_tp18
    s_bitcmp1_b32 s2, 7
    s_cbranch_scc1 L_tp34
    s_branch L_tp2
L_tn7:
    s_bitcmp1_b32 s2, 6
    s_cbranch_scc1 L_tp26
    s_branch L_tp10
L_tn6:
    s_bitcmp1_b32 s2, 5
    s_cbranch_scc1 L_tn8
    s_bitcmp1_b32 s2, 6
    s_cbranch_scc1 L_tp22
    s_branch L_tp6
L_tn8:
    s_bitcmp1_b32 s2, 6
    s_cbranch_scc1 L_tp30
    s_branch L_tp14
L_tn1:
    s_bitcmp1_b32 s2, 3
    s_cbranch_scc1 L_tn9
    s_bitcmp1_b32 s2, 4
    s_cbranch_scc1 L_tn10
    s_bitcmp1_b32 s2, 5
    s_cbranch_scc1 L_tn11
    s_bitcmp1_b32 s2, 6
    s_cbranch_scc1 L_tp17
    s_bitcmp1_b32 s2, 7
    s_cbranch_scc1 L_tp33
    s_branch L_tp1
L_tn11:
    s_bitcmp1_b32 s2, 6
    s_cbranch_scc1 L_tp25
    s_branch L_tp9
L_tn10:
    s_bitcmp1_b32 s2, 5
    s_cbranch_scc1 L_tn12
    s_bitcmp1_b32 s2, 6
    s_cbranch_scc1 L_tp21
    s_branch L_tp5
L_tn12:
    s_bitcmp1_b32 s2, 6
    s_cbranch_scc1 L_tp29
    s_branch L_tp13
L_tn9:
    s_bitcmp1_b32 s2, 4
    s_cbranch_scc1 L_tn13
    s_bitcmp1_b32 s2, 5
    s_cbranch_scc1 L_tn14
    s_bitcmp1_b32 s2, 6
    s_cbranch_scc1 L_tp19
    s_branch L_tp3
L_tn14:
    s_bitcmp1_b32 s2, 6
    s_cbranch_scc1 L_tp27
    s_branch L_tp11
L_tn13:
    s_bitcmp1_b32 s2, 5
    s_cbranch_scc1 L_tn15
    s_bitcmp1_b32 s2, 6
    s_cbranch_scc1 L_tp23
    s_branch L_tp7
L_tn15:
    s_bitcmp1_b32 s2, 6
    s_cbranch_scc1 L_tp31
    s_branch L_tp15
L_tret:
    s_mov_b64 exec, -1
L_k2_sdone:
    s_cmp_eq_u32 s50, 2
    s_cselect_b32 s67, s44, 0x40000000
    v_cmp_eq_u32 vcc, 1, v6
    v_mov_b32 v96, 0
    v_mov_b32 v97, 0
    v_mov_b32 v69, 0
    v_mov_b32 v70, 0
    v_mfma_f32_32x32x16_bf16 v[48:63], a[12:15], a[12:15], 0
    v_mov_b32 v112, 0
    v_mov_b32 v113, 0
    v_mov_b32 v135, 0
    v_mov_b32 v136, 0
    v_mfma_f32_32x32x16_bf16 v[114:129], a[12:15], a[12:15], 0
    s_waitcnt lgkmcnt(0)
    v_cndmask_b32 v72, v82, v83, vcc
    v_cndmask_b32 v73, v83, v84, vcc
    v_cndmask_b32 v74, v84, v85, vcc
    v_cndmask_b32 v75, v85, v86, vcc
    v_cndmask_b32 v80, v86, v87, vcc
    v_mov_b32 v77, 0
    v_cndmask_b32 v80, 0, v80, s[68:69]
    v_mov_b32 v142, v80
    v_cndmask_b32 v138, v98, v99, vcc
    v_cndmask_b32 v139, v99, v100, vcc
    v_cndmask_b32 v140, v100, v101, vcc
    v_cndmask_b32 v141, v101, v102, vcc
    v_cndmask_b32 v146, v102, v103, vcc
    v_mov_b32 v143, 0
    v_cndmask_b32 v146, 0, v146, s[68:69]
    v_mov_b32 v76, v146
    s_nop 1
    v_permlane32_swap_b32 v142, v76
    s_waitcnt vmcnt(4)
    s_barrier
    ds_read_b128 a[0:3], v4
    ds_read_b32 a4, v3 offset:0
    ds_read_b32 a6, v3 offset:8
    s_waitcnt lgkmcnt(0)
    v_mfma_f32_32x32x16_bf16 v[16:31], a[0:3], v[72:75], 0
    v_mfma_f32_32x32x16_bf16 v[32:47], a[0:3], v[138:141], 0
    ds_read_b128 a[8:11], v12 offset:4608
    ds_read_b128 a[0:3], v4 offset:1024
    v_mov_b32 v68, 0
    v_mov_b32 v134, 0
    s_mov_b32 s37, 0
    s_mov_b32 s38, 2
    s_nop 4
    v_max3_f32 v81, v16, v17, v18
    v_max3_f32 v81, v81, v19, v20
    v_max3_f32 v81, v81, v21, v22
    v_max3_f32 v81, v81, v23, v24
    v_max3_f32 v81, v81, v25, v26
    v_max3_f32 v81, v81, v27, v28
    v_max3_f32 v81, v81, v29, v30
    v_max_f32 v81, v81, v31
    v_max3_f32 v147, v32, v33, v34
    v_max3_f32 v147, v147, v35, v36
    v_max3_f32 v147, v147, v37, v38
    v_max3_f32 v147, v147, v39, v40
    v_max3_f32 v147, v147, v41, v42
    v_max3_f32 v147, v147, v43, v44
    v_max3_f32 v147, v147, v45, v46
    v_max_f32 v147, v147, v47
    s_nop 1
    v_permlane32_swap_b32 v81, v147
    v_max_f32 v8, v81, v147
    v_mul_f32 v8, -1.0, v8
    v_and_b32 v9, 0xffff0000, v8
    v_sub_f32 v8, v8, v9
    v_lshrrev_b32 v9, 16, v9
    v_and_b32 v8, 0xffff0000, v8
    v_or_b32 v77, v8, v9
    s_nop 1
    v_mfma_f32_32x32x4_2b_bf16 v[16:47], a[4:5], v[76:77], v[16:47] cbsz:1 abid:0
    s_waitcnt lgkmcnt(0)
    s_waitcnt vmcnt(0)
    s_barrier
    s_mov_b32 s51, 0x05040100
    s_mov_b32 s52, 0x07060302
    s_sub_u32 s27, s48, s49
    s_add_u32 s22, s27, 1327104
    s_cmp_lt_u32 s32, 2
    s_cselect_b32 s41, 5, 7
    s_mov_b32 s20, 0x7f817f81
    s_mov_b32 s21, 0x7f817f81
    s_mov_b32 s28, s49
    s_getreg_b32 s29, hwreg(HW_REG_XCC_ID, 0, 4)
    s_or_b32 s29, s29, 16
    s_nop 5
.p2align 6
L_k2_loopa:
    v_exp_f32 v16, v16
    v_exp_f32 v32, v32
    v_cvt_pk_bf16_f32 v71, v96, v97
    v_mfma_f32_32x32x16_bf16 v[82:97], a[0:3], v[72:75], 0
    s_add_u32 s34, s34, 16384
    buffer_load_dwordx4 v2, s[8:11], s34 offen offset:0 lds
    v_cvt_pk_bf16_f32 v137, v112, v113
    v_exp_f32 v17, v17
    v_exp_f32 v33, v33
    v_exp_f32 v18, v18
L_tp0:
    s_cbranch_execz L_tret
    v_exp_f32 v34, v34
    v_cvt_pk_bf16_f32 v64, v16, v17
    v_mfma_f32_32x32x16_bf16 v[98:113], a[0:3], v[138:141], 0
    s_waitcnt lgkmcnt(1)
    ds_read_b128 a[0:3], v4 offset:2048
    v_cvt_pk_bf16_f32 v130, v32, v33
    v_exp_f32 v19, v19
    v_exp_f32 v35, v35
    v_exp_f32 v20, v20
    v_exp_f32 v36, v36
    v_cvt_pk_bf16_f32 v65, v18, v19
    v_mfma_f32_32x32x16_bf16 v[48:63], a[12:15], v[68:71], v[48:63]
    buffer_load_dwordx4 v2, s[8:11], s34 offen offset:1024 lds
    v_cvt_pk_bf16_f32 v131, v34, v35
    v_exp_f32 v21, v21
    v_exp_f32 v37, v37
    v_exp_f32 v22, v22
    v_exp_f32 v38, v38
    v_cvt_pk_bf16_f32 v66, v20, v21
    v_mfma_f32_32x32x16_bf16 v[114:129], a[12:15], v[134:137], v[114:129]
    s_waitcnt lgkmcnt(1)
    ds_read_b128 a[12:15], v12 offset:5216
    v_cvt_pk_bf16_f32 v132, v36, v37
    v_exp_f32 v23, v23
    v_exp_f32 v39, v39
    v_exp_f32 v24, v24
    v_exp_f32 v40, v40
    v_cvt_pk_bf16_f32 v67, v22, v23
    v_mfma_f32_32x32x4_2b_bf16 v[82:113], a[4:5], v[76:77], v[82:113] cbsz:1 abid:1
    buffer_load_dwordx4 v2, s[8:11], s34 offen offset:2048 lds
    buffer_load_dwordx4 v2, s[8:11], s34 offen offset:3072 lds
    v_cvt_pk_bf16_f32 v133, v38, v39
    v_exp_f32 v25, v25
    v_exp_f32 v41, v41
    v_exp_f32 v26, v26
    v_exp_f32 v42, v42
    v_cvt_pk_bf16_f32 v68, v24, v25
    v_cvt_pk_bf16_f32 v134, v40, v41
    v_exp_f32 v27, v27
    v_exp_f32 v43, v43
    v_exp_f32 v28, v28
    v_mfma_f32_32x32x16_bf16 v[48:63], a[8:11], v[64:67], v[48:63]
    s_add_u32 m0, m0, 16384
    v_exp_f32 v44, v44
    v_cvt_pk_bf16_f32 v69, v26, v27
    v_cvt_pk_bf16_f32 v135, v42, v43
    v_exp_f32 v29, v29
    v_exp_f32 v45, v45
    v_exp_f32 v30, v30
    v_exp_f32 v46, v46
    v_mfma_f32_32x32x16_bf16 v[114:129], a[8:11], v[130:133], v[114:129]
    s_waitcnt lgkmcnt(1)
    ds_read_b128 a[8:11], v12 offset:5824
    v_cvt_pk_bf16_f32 v70, v28, v29
    v_cvt_pk_bf16_f32 v136, v44, v45
    v_exp_f32 v31, v31
    v_exp_f32 v47, v47
    v_exp_f32 v82, v82
    v_exp_f32 v98, v98
    v_cvt_pk_bf16_f32 v71, v30, v31
    v_mfma_f32_32x32x16_bf16 v[16:31], a[0:3], v[72:75], 0
    s_add_u32 s34, s34, 16384
    buffer_load_dwordx4 v2, s[8:11], s34 offen offset:0 lds
    v_cvt_pk_bf16_f32 v137, v46, v47
    v_exp_f32 v83, v83
    v_exp_f32 v99, v99
    v_exp_f32 v84, v84
    v_exp_f32 v100, v100
    v_cvt_pk_bf16_f32 v64, v82, v83
    v_mfma_f32_32x32x16_bf16 v[32:47], a[0:3], v[138:141], 0
    s_waitcnt lgkmcnt(1)
    ds_read_b128 a[0:3], v4 offset:3072
    v_cvt_pk_bf16_f32 v130, v98, v99
    v_exp_f32 v85, v85
    v_exp_f32 v101, v101
    v_exp_f32 v86, v86
    v_exp_f32 v102, v102
    v_cvt_pk_bf16_f32 v65, v84, v85
    v_mfma_f32_32x32x16_bf16 v[48:63], a[12:15], v[68:71], v[48:63]
    buffer_load_dwordx4 v2, s[8:11], s34 offen offset:1024 lds
    v_cvt_pk_bf16_f32 v131, v100, v101
    v_exp_f32 v87, v87
    v_exp_f32 v103, v103
    v_exp_f32 v88, v88
    v_exp_f32 v104, v104
    v_cvt_pk_bf16_f32 v66, v86, v87
    v_mfma_f32_32x32x16_bf16 v[114:129], a[12:15], v[134:137], v[114:129]
    s_waitcnt lgkmcnt(1)
    ds_read_b128 a[12:15], v12 offset:6432
    v_cvt_pk_bf16_f32 v132, v102, v103
    v_exp_f32 v89, v89
    v_exp_f32 v105, v105
    v_exp_f32 v90, v90
    v_exp_f32 v106, v106
    v_cvt_pk_bf16_f32 v67, v88, v89
    v_mfma_f32_32x32x4_2b_bf16 v[16:47], a[6:7], v[76:77], v[16:47] cbsz:1 abid:0
    buffer_load_dwordx4 v2, s[8:11], s34 offen offset:2048 lds
    buffer_load_dwordx4 v2, s[8:11], s34 offen offset:3072 lds
    v_cvt_pk_bf16_f32 v133, v104, v105
    v_exp_f32 v91, v91
    v_exp_f32 v107, v107
    v_exp_f32 v92, v92
    v_exp_f32 v108, v108
    v_cvt_pk_bf16_f32 v68, v90, v91
    v_cvt_pk_bf16_f32 v134, v106, v107
    v_exp_f32 v93, v93
    v_exp_f32 v109, v109
    v_exp_f32 v94, v94
    v_mfma_f32_32x32x16_bf16 v[48:63], a[8:11], v[64:67], v[48:63]
    s_add_u32 m0, m0, 16384
    ds_read_b32 a4, v3 offset:9472
    v_exp_f32 v110, v110
    v_cvt_pk_bf16_f32 v69, v92, v93
    v_cvt_pk_bf16_f32 v135, v108, v109
    v_exp_f32 v95, v95
    v_exp_f32 v111, v111
    v_exp_f32 v96, v96
    v_exp_f32 v112, v112
    v_mfma_f32_32x32x16_bf16 v[114:129], a[8:11], v[130:133], v[114:129]
    s_waitcnt lgkmcnt(2)
    ds_read_b128 a[8:11], v12 offset:7040
    v_cvt_pk_bf16_f32 v70, v94, v95
    v_cvt_pk_bf16_f32 v136, v110, v111
    v_exp_f32 v97, v97
    v_exp_f32 v113, v113
    v_exp_f32 v16, v16
    v_exp_f32 v32, v32
    v_cvt_pk_bf16_f32 v71, v96, v97
    v_mfma_f32_32x32x16_bf16 v[82:97], a[0:3], v[72:75], 0
    s_add_u32 s34, s34, 16384
    buffer_load_dwordx4 v2, s[8:11], s34 offen offset:0 lds
    v_cvt_pk_bf16_f32 v137, v112, v113
    v_exp_f32 v17, v17
    v_exp_f32 v33, v33
    v_exp_f32 v18, v18
    v_exp_f32 v34, v34
    v_cvt_pk_bf16_f32 v64, v16, v17
    v_mfma_f32_32x32x16_bf16 v[98:113], a[0:3], v[138:141], 0
    s_waitcnt lgkmcnt(2)
    ds_read_b128 a[0:3], v4 offset:9472
    v_cvt_pk_bf16_f32 v130, v32, v33
    v_exp_f32 v19, v19
    v_exp_f32 v35, v35
    v_exp_f32 v20, v20
    v_exp_f32 v36, v36
    v_cvt_pk_bf16_f32 v65, v18, v19
    v_mfma_f32_32x32x16_bf16 v[48:63], a[12:15], v[68:71], v[48:63]
    buffer_load_dwordx4 v2, s[8:11], s34 offen offset:1024 lds
    v_cvt_pk_bf16_f32 v131, v34, v35
    v_exp_f32 v21, v21
    v_exp_f32 v37, v37
    v_exp_f32 v22, v22
    v_exp_f32 v38, v38
    v_cvt_pk_bf16_f32 v66, v20, v21
    v_mfma_f32_32x32x16_bf16 v[114:129], a[12:15], v[134:137], v[114:129]
    s_waitcnt lgkmcnt(1)
    ds_read_b128 a[12:15], v12 offset:7648
    v_cvt_pk_bf16_f32 v132, v36, v37
    v_exp_f32 v23, v23
    v_exp_f32 v39, v39
    v_exp_f32 v24, v24
    v_exp_f32 v40, v40
    v_cvt_pk_bf16_f32 v67, v22, v23
    v_mfma_f32_32x32x4_2b_bf16 v[82:113], a[6:7], v[76:77], v[82:113] cbsz:1 abid:1
L_tp1:
    s_cbranch_execz L_tret
    buffer_load_dwordx4 v2, s[8:11], s34 offen offset:2048 lds
    buffer_load_dwordx4 v2, s[8:11], s34 offen offset:3072 lds
    v_cvt_pk_bf16_f32 v133, v38, v39
    v_exp_f32 v25, v25
    v_exp_f32 v41, v41
    v_exp_f32 v26, v26
    v_exp_f32 v42, v42
    v_cvt_pk_bf16_f32 v68, v24, v25
    v_cvt_pk_bf16_f32 v134, v40, v41
    v_exp_f32 v27, v27
    v_exp_f32 v43, v43
    v_exp_f32 v28, v28
    v_mfma_f32_32x32x16_bf16 v[48:63], a[8:11], v[64:67], v[48:63]
    s_add_u32 m0, m0, 16384
    ds_read_b32 a6, v3 offset:9480
    v_exp_f32 v44, v44
    v_cvt_pk_bf16_f32 v69, v26, v27
    v_cvt_pk_bf16_f32 v135, v42, v43
    v_exp_f32 v29, v29
    v_exp_f32 v45, v45
    v_exp_f32 v30, v30
    v_exp_f32 v46, v46
    v_mfma_f32_32x32x16_bf16 v[114:129], a[8:11], v[130:133], v[114:129]
    s_waitcnt lgkmcnt(2)
    ds_read_b128 a[8:11], v12 offset:8256
    v_cvt_pk_bf16_f32 v70, v28, v29
    v_cvt_pk_bf16_f32 v136, v44, v45
    v_exp_f32 v31, v31
    v_exp_f32 v47, v47
    v_exp_f32 v82, v82
    v_exp_f32 v98, v98
    v_cvt_pk_bf16_f32 v71, v30, v31
    v_mfma_f32_32x32x16_bf16 v[16:31], a[0:3], v[72:75], 0
    s_add_u32 s34, s34, 16384
    buffer_load_dwordx4 v2, s[8:11], s34 offen offset:0 lds
    v_cvt_pk_bf16_f32 v137, v46, v47
    v_exp_f32 v83, v83
    v_exp_f32 v99, v99
    v_exp_f32 v84, v84
    v_exp_f32 v100, v100
    v_cvt_pk_bf16_f32 v64, v82, v83
    v_mfma_f32_32x32x16_bf16 v[32:47], a[0:3], v[138:141], 0
    s_waitcnt lgkmcnt(2)
    ds_read_b128 a[0:3], v4 offset:10496
    v_add_u32 v4, 9472, v4
    v_cvt_pk_bf16_f32 v130, v98, v99
    v_exp_f32 v85, v85
    v_exp_f32 v101, v101
    v_exp_f32 v86, v86
    v_exp_f32 v102, v102
    v_cvt_pk_bf16_f32 v65, v84, v85
    v_mfma_f32_32x32x16_bf16 v[48:63], a[12:15], v[68:71], v[48:63]
    s_add_u32 s37, s37, 1
    buffer_load_dwordx4 v2, s[8:11], s34 offen offset:1024 lds
    v_cvt_pk_bf16_f32 v131, v100, v101
    v_exp_f32 v87, v87
    v_exp_f32 v103, v103
    v_exp_f32 v88, v88
    v_exp_f32 v104, v104
    v_cvt_pk_bf16_f32 v66, v86, v87
    v_mfma_f32_32x32x16_bf16 v[114:129], a[12:15], v[134:137], v[114:129]
    s_waitcnt lgkmcnt(1)
    ds_read_b128 a[12:15], v12 offset:8864
    v_cvt_pk_bf16_f32 v132, v102, v103
    v_exp_f32 v89, v89
    v_exp_f32 v105, v105
    v_exp_f32 v90, v90
    v_exp_f32 v106, v106
    v_cvt_pk_bf16_f32 v67, v88, v89
    v_mfma_f32_32x32x4_2b_bf16 v[16:47], a[4:5], v[76:77], v[16:47] cbsz:1 abid:0
    buffer_load_dwordx4 v2, s[8:11], s34 offen offset:2048 lds
    buffer_load_dwordx4 v2, s[8:11], s34 offen offset:3072 lds
    v_cvt_pk_bf16_f32 v133, v104, v105
    v_exp_f32 v91, v91
    v_exp_f32 v107, v107
    v_exp_f32 v92, v92
    v_exp_f32 v108, v108
    v_cvt_pk_bf16_f32 v68, v90, v91
    v_cvt_pk_bf16_f32 v134, v106, v107
    v_exp_f32 v93, v93
    v_exp_f32 v109, v109
    v_exp_f32 v94, v94
    v_mfma_f32_32x32x16_bf16 v[48:63], a[8:11], v[64:67], v[48:63]
    s_add_u32 m0, m0, 16384
    s_cmp_lg_u32 s37, s38
    v_add_u32 v3, 9472, v3
    v_exp_f32 v110, v110
    v_cvt_pk_bf16_f32 v69, v92, v93
    v_cvt_pk_bf16_f32 v135, v108, v109
    v_exp_f32 v95, v95
    v_exp_f32 v111, v111
    v_exp_f32 v96, v96
    v_exp_f32 v112, v112
    v_mfma_f32_32x32x16_bf16 v[114:129], a[8:11], v[130:133], v[114:129]
    s_waitcnt lgkmcnt(1)
    ds_read_b128 a[8:11], v12 offset:14080
    v_cvt_pk_bf16_f32 v70, v94, v95
    v_cvt_pk_bf16_f32 v136, v110, v111
    v_exp_f32 v97, v97
    v_exp_f32 v113, v113
    v_add_u32 v12, 9472, v12
    s_cbranch_scc1 L_k2_loopa
    s_waitcnt vmcnt(16)
    s_barrier
    s_mov_b32 s38, 3
    s_call_b64 s[70:71], L_k2_P
    s_waitcnt vmcnt(0)
    s_barrier
    v_exp_f32 v16, v16
    v_exp_f32 v32, v32
    v_cvt_pk_bf16_f32 v71, v96, v97
    v_mfma_f32_32x32x16_bf16 v[82:97], a[0:3], v[72:75], 0
    s_lshl_b32 s55, s32, 10
    buffer_load_dwordx4 v[148:151], v248, s[16:19], s44 offen
    v_cvt_pk_bf16_f32 v137, v112, v113
    v_exp_f32 v17, v17
    v_exp_f32 v33, v33
    v_exp_f32 v18, v18
    v_exp_f32 v34, v34
    v_cvt_pk_bf16_f32 v64, v16, v17
    v_mfma_f32_32x32x16_bf16 v[98:113], a[0:3], v[138:141], 0
    s_waitcnt lgkmcnt(1)
    ds_read_b128 a[0:3], v4 offset:2048
    v_cvt_pk_bf16_f32 v130, v32, v33
    v_exp_f32 v19, v19
    v_exp_f32 v35, v35
    v_exp_f32 v20, v20
    v_exp_f32 v36, v36
    v_cvt_pk_bf16_f32 v65, v18, v19
    v_mfma_f32_32x32x16_bf16 v[48:63], a[12:15], v[68:71], v[48:63]
    s_add_u32 s44, s44, s45
    v_cvt_pk_bf16_f32 v131, v34, v35
    v_exp_f32 v21, v21
    v_exp_f32 v37, v37
    v_exp_f32 v22, v22
    v_exp_f32 v38, v38
    v_cvt_pk_bf16_f32 v66, v20, v21
    v_mfma_f32_32x32x16_bf16 v[114:129], a[12:15], v[134:137], v[114:129]
    s_waitcnt lgkmcnt(1)
    ds_read_b128 a[12:15], v12 offset:5216
    v_cvt_pk_bf16_f32 v132, v36, v37
    v_exp_f32 v23, v23
    v_exp_f32 v39, v39
    v_exp_f32 v24, v24
    v_exp_f32 v40, v40
    v_cvt_pk_bf16_f32 v67, v22, v23
    v_mfma_f32_32x32x4_2b_bf16 v[82:113], a[4:5], v[76:77], v[82:113] cbsz:1 abid:1
    s_add_u32 s55, s55, 0x007b4000
    s_lshl3_add_u32 s35, s30, s31
    buffer_load_dwordx4 v[152:155], v248, s[16:19], s44 offen
    v_cvt_pk_bf16_f32 v133, v38, v39
    v_exp_f32 v25, v25
    v_exp_f32 v41, v41
    v_exp_f32 v26, v26
    v_exp_f32 v42, v42
    v_cvt_pk_bf16_f32 v68, v24, v25
    v_cvt_pk_bf16_f32 v134, v40, v41
    v_exp_f32 v27, v27
    v_exp_f32 v43, v43
    v_exp_f32 v28, v28
    v_mfma_f32_32x32x16_bf16 v[48:63], a[8:11], v[64:67], v[48:63]
    s_add_u32 s44, s44, s46
    v_exp_f32 v44, v44
    v_cvt_pk_bf16_f32 v69, v26, v27
    v_cvt_pk_bf16_f32 v135, v42, v43
    v_exp_f32 v29, v29
    v_exp_f32 v45, v45
    v_exp_f32 v30, v30
    v_exp_f32 v46, v46
    v_mfma_f32_32x32x16_bf16 v[114:129], a[8:11], v[130:133], v[114:129]
    s_waitcnt lgkmcnt(1)
    ds_read_b128 a[8:11], v12 offset:5824
    v_cvt_pk_bf16_f32 v70, v28, v29
    v_cvt_pk_bf16_f32 v136, v44, v45
    v_exp_f32 v31, v31
    v_exp_f32 v47, v47
    v_exp_f32 v82, v82
    v_exp_f32 v98, v98
    v_cvt_pk_bf16_f32 v71, v30, v31
    v_mfma_f32_32x32x16_bf16 v[16:31], a[0:3], v[72:75], 0
    s_lshl2_add_u32 s25, s35, s55
    buffer_load_dwordx4 v[156:159], v248, s[16:19], s44 offen
    v_cvt_pk_bf16_f32 v137, v46, v47
    v_exp_f32 v83, v83
    v_exp_f32 v99, v99
L_tp2:
    s_cbranch_execz L_tret
    v_exp_f32 v84, v84
    v_exp_f32 v100, v100
    v_cvt_pk_bf16_f32 v64, v82, v83
    v_mfma_f32_32x32x16_bf16 v[32:47], a[0:3], v[138:141], 0
    s_waitcnt lgkmcnt(1)
    ds_read_b128 a[0:3], v4 offset:3072
    v_cvt_pk_bf16_f32 v130, v98, v99
    v_exp_f32 v85, v85
    v_exp_f32 v101, v101
    v_exp_f32 v86, v86
    v_exp_f32 v102, v102
    v_cvt_pk_bf16_f32 v65, v84, v85
    v_mfma_f32_32x32x16_bf16 v[48:63], a[12:15], v[68:71], v[48:63]
    s_add_u32 s44, s44, s45
    v_cvt_pk_bf16_f32 v131, v100, v101
    v_exp_f32 v87, v87
    v_exp_f32 v103, v103
    v_exp_f32 v88, v88
    v_exp_f32 v104, v104
    v_cvt_pk_bf16_f32 v66, v86, v87
    v_mfma_f32_32x32x16_bf16 v[114:129], a[12:15], v[134:137], v[114:129]
    s_waitcnt lgkmcnt(1)
    ds_read_b128 a[12:15], v12 offset:6432
    v_cvt_pk_bf16_f32 v132, v102, v103
    v_exp_f32 v89, v89
    v_exp_f32 v105, v105
    v_exp_f32 v90, v90
    v_exp_f32 v106, v106
    v_cvt_pk_bf16_f32 v67, v88, v89
    v_mfma_f32_32x32x4_2b_bf16 v[16:47], a[6:7], v[76:77], v[16:47] cbsz:1 abid:0
    s_mul_i32 s58, s31, 85248
    s_lshl_b32 s59, s32, 12
    buffer_load_dwordx4 v[160:163], v248, s[16:19], s44 offen
    v_cvt_pk_bf16_f32 v133, v104, v105
    v_exp_f32 v91, v91
    v_exp_f32 v107, v107
    v_exp_f32 v92, v92
    v_exp_f32 v108, v108
    v_cvt_pk_bf16_f32 v68, v90, v91
    v_cvt_pk_bf16_f32 v134, v106, v107
    v_exp_f32 v93, v93
    v_exp_f32 v109, v109
    v_exp_f32 v94, v94
    v_mfma_f32_32x32x16_bf16 v[48:63], a[8:11], v[64:67], v[48:63]
    s_add_u32 s44, s44, s47
    ds_read_b32 a4, v3 offset:9472
    v_exp_f32 v110, v110
    v_cvt_pk_bf16_f32 v69, v92, v93
    v_cvt_pk_bf16_f32 v135, v108, v109
    v_exp_f32 v95, v95
    v_exp_f32 v111, v111
    v_exp_f32 v96, v96
    v_exp_f32 v112, v112
    v_mfma_f32_32x32x16_bf16 v[114:129], a[8:11], v[130:133], v[114:129]
    s_waitcnt lgkmcnt(2)
L_tp3:
    s_cbranch_execz L_tret
    ds_read_b128 a[8:11], v12 offset:7040
    v_cvt_pk_bf16_f32 v70, v94, v95
    v_cvt_pk_bf16_f32 v136, v110, v111
    v_exp_f32 v97, v97
    v_exp_f32 v113, v113
    v_exp_f32 v16, v16
    v_exp_f32 v32, v32
    v_cvt_pk_bf16_f32 v71, v96, v97
    v_mfma_f32_32x32x16_bf16 v[82:97], a[0:3], v[72:75], 0
    s_add_u32 s58, s58, s59
    buffer_load_dwordx4 v[164:167], v248, s[16:19], s44 offen
    v_cvt_pk_bf16_f32 v137, v112, v113
    v_exp_f32 v17, v17
    v_exp_f32 v33, v33
    v_exp_f32 v18, v18
    v_exp_f32 v34, v34
    v_cvt_pk_bf16_f32 v64, v16, v17
    v_mfma_f32_32x32x16_bf16 v[98:113], a[0:3], v[138:141], 0
    s_waitcnt lgkmcnt(2)
    ds_read_b128 a[0:3], v4 offset:9472
    v_cvt_pk_bf16_f32 v130, v32, v33
    v_exp_f32 v19, v19
    v_exp_f32 v35, v35
    v_exp_f32 v20, v20
    v_exp_f32 v36, v36
    v_cvt_pk_bf16_f32 v65, v18, v19
    v_mfma_f32_32x32x16_bf16 v[48:63], a[12:15], v[68:71], v[48:63]
    s_add_u32 s44, s44, s45
    v_cvt_pk_bf16_f32 v131, v34, v35
    v_exp_f32 v21, v21
    v_exp_f32 v37, v37
    v_exp_f32 v22, v22
    v_exp_f32 v38, v38
    v_cvt_pk_bf16_f32 v66, v20, v21
    v_mfma_f32_32x32x16_bf16 v[114:129], a[12:15], v[134:137], v[114:129]
    s_waitcnt lgkmcnt(1)
    ds_read_b128 a[12:15], v12 offset:7648
    v_cvt_pk_bf16_f32 v132, v36, v37
    v_exp_f32 v23, v23
    v_exp_f32 v39, v39
    v_exp_f32 v24, v24
    v_exp_f32 v40, v40
    v_cvt_pk_bf16_f32 v67, v22, v23
    v_mfma_f32_32x32x4_2b_bf16 v[82:113], a[6:7], v[76:77], v[82:113] cbsz:1 abid:1
    s_add_u32 s34, s58, 0x006fc000
    s_mov_b32 s65, 0x40000
    buffer_load_dwordx4 v[168:171], v248, s[16:19], s44 offen
    v_cvt_pk_bf16_f32 v133, v38, v39
    v_exp_f32 v25, v25
    v_exp_f32 v41, v41
    v_exp_f32 v26, v26
    v_exp_f32 v42, v42
    v_cvt_pk_bf16_f32 v68, v24, v25
    v_cvt_pk_bf16_f32 v134, v40, v41
    v_exp_f32 v27, v27
    v_exp_f32 v43, v43
    v_exp_f32 v28, v28
    v_mfma_f32_32x32x16_bf16 v[48:63], a[8:11], v[64:67], v[48:63]
    s_add_u32 s44, s44, s46
    ds_read_b32 a6, v3 offset:9480
    v_exp_f32 v44, v44
    v_cvt_pk_bf16_f32 v69, v26, v27
    v_cvt_pk_bf16_f32 v135, v42, v43
    v_exp_f32 v29, v29
    v_exp_f32 v45, v45
    v_exp_f32 v30, v30
    v_exp_f32 v46, v46
    v_mfma_f32_32x32x16_bf16 v[114:129], a[8:11], v[130:133], v[114:129]
    s_waitcnt lgkmcnt(2)
    ds_read_b128 a[8:11], v12 offset:8256
    v_cvt_pk_bf16_f32 v70, v28, v29
    v_cvt_pk_bf16_f32 v136, v44, v45
    v_exp_f32 v31, v31
    v_exp_f32 v47, v47
    v_exp_f32 v82, v82
    v_exp_f32 v98, v98
    v_cvt_pk_bf16_f32 v71, v30, v31
    v_mfma_f32_32x32x16_bf16 v[16:31], a[0:3], v[72:75], 0
    s_mov_b32 m0, s59
    buffer_load_dwordx4 v[172:175], v248, s[16:19], s44 offen
    v_cvt_pk_bf16_f32 v137, v46, v47
    v_exp_f32 v83, v83
    v_exp_f32 v99, v99
    v_exp_f32 v84, v84
    v_exp_f32 v100, v100
    v_cvt_pk_bf16_f32 v64, v82, v83
    v_mfma_f32_32x32x16_bf16 v[32:47], a[0:3], v[138:141], 0
    s_waitcnt lgkmcnt(2)
    ds_read_b128 a[0:3], v4 offset:10496
    v_add_u32 v4, 9472, v4
    v_cvt_pk_bf16_f32 v130, v98, v99
    v_exp_f32 v85, v85
    v_exp_f32 v101, v101
    v_exp_f32 v86, v86
    v_exp_f32 v102, v102
    v_cvt_pk_bf16_f32 v65, v84, v85
    v_mfma_f32_32x32x16_bf16 v[48:63], a[12:15], v[68:71], v[48:63]
    s_add_u32 s37, s37, 1
    v_cvt_pk_bf16_f32 v131, v100, v101
    v_exp_f32 v87, v87
    v_exp_f32 v103, v103
    v_exp_f32 v88, v88
    v_exp_f32 v104, v104
    v_cvt_pk_bf16_f32 v66, v86, v87
    v_mfma_f32_32x32x16_bf16 v[114:129], a[12:15], v[134:137], v[114:129]
    s_waitcnt lgkmcnt(1)
    ds_read_b128 a[12:15], v12 offset:8864
    v_cvt_pk_bf16_f32 v132, v102, v103
    v_exp_f32 v89, v89
    v_exp_f32 v105, v105
    v_exp_f32 v90, v90
    v_exp_f32 v106, v106
    v_cvt_pk_bf16_f32 v67, v88, v89
    v_mfma_f32_32x32x4_2b_bf16 v[16:47], a[4:5], v[76:77], v[16:47] cbsz:1 abid:0
    s_add_u32 s44, s44, s45
    buffer_load_dwordx4 v[176:179], v248, s[16:19], s44 offen
    v_cvt_pk_bf16_f32 v133, v104, v105
    v_exp_f32 v91, v91
    v_exp_f32 v107, v107
    v_exp_f32 v92, v92
    v_exp_f32 v108, v108
    v_cvt_pk_bf16_f32 v68, v90, v91
    v_cvt_pk_bf16_f32 v134, v106, v107
    v_exp_f32 v93, v93
    v_exp_f32 v109, v109
    v_exp_f32 v94, v94
    v_mfma_f32_32x32x16_bf16 v[48:63], a[8:11], v[64:67], v[48:63]
    buffer_load_dwordx4 v[180:183], v248, s[16:19], s67 offen offset:1024
    v_add_u32 v3, 9472, v3
    v_exp_f32 v110, v110
    v_cvt_pk_bf16_f32 v69, v92, v93
    v_cvt_pk_bf16_f32 v135, v108, v109
    v_exp_f32 v95, v95
    v_exp_f32 v111, v111
    v_exp_f32 v96, v96
    v_exp_f32 v112, v112
    v_mfma_f32_32x32x16_bf16 v[114:129], a[8:11], v[130:133], v[114:129]
    s_waitcnt lgkmcnt(1)
    ds_read_b128 a[8:11], v12 offset:14080
    v_cvt_pk_bf16_f32 v70, v94, v95
    v_cvt_pk_bf16_f32 v136, v110, v111
    v_exp_f32 v97, v97
    v_exp_f32 v113, v113
    v_add_u32 v12, 9472, v12
    s_mov_b32 s38, s41
    s_call_b64 s[70:71], L_k2_P
    s_cmp_ge_u32 s32, 2
    s_cbranch_scc1 L_k2_j
    v_exp_f32 v16, v16
    v_exp_f32 v32, v32
    v_cvt_pk_bf16_f32 v71, v96, v97
    v_mfma_f32_32x32x16_bf16 v[82:97], a[0:3], v[72:75], 0
    buffer_load_dwordx4 v[184:187], v248, s[16:19], s54 offen
    v_cvt_pk_bf16_f32 v137, v112, v113
    v_exp_f32 v17, v17
    v_exp_f32 v33, v33
    v_exp_f32 v18, v18
    v_exp_f32 v34, v34
    v_cvt_pk_bf16_f32 v64, v16, v17
    v_mfma_f32_32x32x16_bf16 v[98:113], a[0:3], v[138:141], 0
    s_waitcnt lgkmcnt(1)
    ds_read_b128 a[0:3], v4 offset:2048
    v_cvt_pk_bf16_f32 v130, v32, v33
    v_exp_f32 v19, v19
    v_exp_f32 v35, v35
    v_exp_f32 v20, v20
    v_exp_f32 v36, v36
    v_cvt_pk_bf16_f32 v65, v18, v19
    v_mfma_f32_32x32x16_bf16 v[48:63], a[12:15], v[68:71], v[48:63]
    s_add_u32 s54, s54, s45
    v_cvt_pk_bf16_f32 v131, v34, v35
    v_exp_f32 v21, v21
    v_exp_f32 v37, v37
    v_exp_f32 v22, v22
    v_exp_f32 v38, v38
    v_cvt_pk_bf16_f32 v66, v20, v21
    v_mfma_f32_32x32x16_bf16 v[114:129], a[12:15], v[134:137], v[114:129]
L_tp4:
    s_cbranch_execz L_tret
    s_waitcnt lgkmcnt(1)
    ds_read_b128 a[12:15], v12 offset:5216
    v_cvt_pk_bf16_f32 v132, v36, v37
    v_exp_f32 v23, v23
    v_exp_f32 v39, v39
    v_exp_f32 v24, v24
    v_exp_f32 v40, v40
    v_cvt_pk_bf16_f32 v67, v22, v23
    v_mfma_f32_32x32x4_2b_bf16 v[82:113], a[4:5], v[76:77], v[82:113] cbsz:1 abid:1
    buffer_load_dwordx4 v[188:191], v248, s[16:19], s54 offen
    v_cvt_pk_bf16_f32 v133, v38, v39
    v_exp_f32 v25, v25
    v_exp_f32 v41, v41
    v_exp_f32 v26, v26
    v_exp_f32 v42, v42
    v_cvt_pk_bf16_f32 v68, v24, v25
    v_cvt_pk_bf16_f32 v134, v40, v41
    v_exp_f32 v27, v27
    v_exp_f32 v43, v43
    v_exp_f32 v28, v28
    v_mfma_f32_32x32x16_bf16 v[48:63], a[8:11], v[64:67], v[48:63]
    s_add_u32 s54, s54, s46
    v_exp_f32 v44, v44
    v_cvt_pk_bf16_f32 v69, v26, v27
    v_cvt_pk_bf16_f32 v135, v42, v43
    v_exp_f32 v29, v29
    v_exp_f32 v45, v45
    v_exp_f32 v30, v30
    v_exp_f32 v46, v46
    v_mfma_f32_32x32x16_bf16 v[114:129], a[8:11], v[130:133], v[114:129]
    s_waitcnt lgkmcnt(1)
    ds_read_b128 a[8:11], v12 offset:5824
    v_cvt_pk_bf16_f32 v70, v28, v29
    v_cvt_pk_bf16_f32 v136, v44, v45
    v_exp_f32 v31, v31
    v_exp_f32 v47, v47
    v_exp_f32 v82, v82
    v_exp_f32 v98, v98
    v_cvt_pk_bf16_f32 v71, v30, v31
    v_mfma_f32_32x32x16_bf16 v[16:31], a[0:3], v[72:75], 0
    buffer_load_dwordx4 v[192:195], v248, s[16:19], s54 offen
    v_cvt_pk_bf16_f32 v137, v46, v47
    v_exp_f32 v83, v83
    v_exp_f32 v99, v99
    v_exp_f32 v84, v84
    v_exp_f32 v100, v100
    v_cvt_pk_bf16_f32 v64, v82, v83
    v_mfma_f32_32x32x16_bf16 v[32:47], a[0:3], v[138:141], 0
    s_waitcnt lgkmcnt(1)
    ds_read_b128 a[0:3], v4 offset:3072
    v_cvt_pk_bf16_f32 v130, v98, v99
    v_exp_f32 v85, v85
    v_exp_f32 v101, v101
    v_exp_f32 v86, v86
    v_exp_f32 v102, v102
    v_cvt_pk_bf16_f32 v65, v84, v85
    v_mfma_f32_32x32x16_bf16 v[48:63], a[12:15], v[68:71], v[48:63]
    s_add_u32 s54, s54, s45
    v_cvt_pk_bf16_f32 v131, v100, v101
    v_exp_f32 v87, v87
    v_exp_f32 v103, v103
    v_exp_f32 v88, v88
    v_exp_f32 v104, v104
    v_cvt_pk_bf16_f32 v66, v86, v87
    v_mfma_f32_32x32x16_bf16 v[114:129], a[12:15], v[134:137], v[114:129]
    s_waitcnt lgkmcnt(1)
    ds_read_b128 a[12:15], v12 offset:6432
    v_cvt_pk_bf16_f32 v132, v102, v103
    v_exp_f32 v89, v89
    v_exp_f32 v105, v105
    v_exp_f32 v90, v90
    v_exp_f32 v106, v106
    v_cvt_pk_bf16_f32 v67, v88, v89
    v_mfma_f32_32x32x4_2b_bf16 v[16:47], a[6:7], v[76:77], v[16:47] cbsz:1 abid:0
    buffer_load_dwordx4 v[196:199], v248, s[16:19], s54 offen
    v_cvt_pk_bf16_f32 v133, v104, v105
    v_exp_f32 v91, v91
    v_exp_f32 v107, v107
    v_exp_f32 v92, v92
    v_exp_f32 v108, v108
    v_cvt_pk_bf16_f32 v68, v90, v91
    v_cvt_pk_bf16_f32 v134, v106, v107
    v_exp_f32 v93, v93
    v_exp_f32 v109, v109
    v_exp_f32 v94, v94
    v_mfma_f32_32x32x16_bf16 v[48:63], a[8:11], v[64:67], v[48:63]
    s_add_u32 s54, s54, s47
    ds_read_b32 a4, v3 offset:9472
    v_exp_f32 v110, v110
    v_cvt_pk_bf16_f32 v69, v92, v93
    v_cvt_pk_bf16_f32 v135, v108, v109
    v_exp_f32 v95, v95
    v_exp_f32 v111, v111
    v_exp_f32 v96, v96
    v_exp_f32 v112, v112
    v_mfma_f32_32x32x16_bf16 v[114:129], a[8:11], v[130:133], v[114:129]
    s_waitcnt lgkmcnt(2)
    ds_read_b128 a[8:11], v12 offset:7040
    v_cvt_pk_bf16_f32 v70, v94, v95
    v_cvt_pk_bf16_f32 v136, v110, v111
    v_exp_f32 v97, v97
    v_exp_f32 v113, v113
    v_exp_f32 v16, v16
    v_exp_f32 v32, v32
    v_cvt_pk_bf16_f32 v71, v96, v97
    v_mfma_f32_32x32x16_bf16 v[82:97], a[0:3], v[72:75], 0
    buffer_load_dwordx4 v[200:203], v248, s[16:19], s54 offen
    v_cvt_pk_bf16_f32 v137, v112, v113
    v_exp_f32 v17, v17
    v_exp_f32 v33, v33
    v_exp_f32 v18, v18
    v_exp_f32 v34, v34
    v_cvt_pk_bf16_f32 v64, v16, v17
    v_mfma_f32_32x32x16_bf16 v[98:113], a[0:3], v[138:141], 0
    s_waitcnt lgkmcnt(2)
    ds_read_b128 a[0:3], v4 offset:9472
    v_cvt_pk_bf16_f32 v130, v32, v33
    v_exp_f32 v19, v19
    v_exp_f32 v35, v35
    v_exp_f32 v20, v20
    v_exp_f32 v36, v36
    v_cvt_pk_bf16_f32 v65, v18, v19
    v_mfma_f32_32x32x16_bf16 v[48:63], a[12:15], v[68:71], v[48:63]
    s_add_u32 s54, s54, s45
    v_cvt_pk_bf16_f32 v131, v34, v35
    v_exp_f32 v21, v21
    v_exp_f32 v37, v37
    v_exp_f32 v22, v22
    v_exp_f32 v38, v38
    v_cvt_pk_bf16_f32 v66, v20, v21
    v_mfma_f32_32x32x16_bf16 v[114:129], a[12:15], v[134:137], v[114:129]
    s_waitcnt lgkmcnt(1)
    ds_read_b128 a[12:15], v12 offset:7648
    v_cvt_pk_bf16_f32 v132, v36, v37
    v_exp_f32 v23, v23
    v_exp_f32 v39, v39
    v_exp_f32 v24, v24
    v_exp_f32 v40, v40
    v_cvt_pk_bf16_f32 v67, v22, v23
    v_mfma_f32_32x32x4_2b_bf16 v[82:113], a[6:7], v[76:77], v[82:113] cbsz:1 abid:1
    buffer_load_dwordx4 v[204:207], v248, s[16:19], s54 offen
    v_cvt_pk_bf16_f32 v133, v38, v39
    v_exp_f32 v25, v25
    v_exp_f32 v41, v41
    v_exp_f32 v26, v26
    v_exp_f32 v42, v42
    v_cvt_pk_bf16_f32 v68, v24, v25
    v_cvt_pk_bf16_f32 v134, v40, v41
    v_exp_f32 v27, v27
    v_exp_f32 v43, v43
    v_exp_f32 v28, v28
    v_mfma_f32_32x32x16_bf16 v[48:63], a[8:11], v[64:67], v[48:63]
    s_add_u32 s54, s54, s46
    ds_read_b32 a6, v3 offset:9480
    v_exp_f32 v44, v44
    v_cvt_pk_bf16_f32 v69, v26, v27
    v_cvt_pk_bf16_f32 v135, v42, v43
    v_exp_f32 v29, v29
    v_exp_f32 v45, v45
    v_exp_f32 v30, v30
    v_exp_f32 v46, v46
    v_mfma_f32_32x32x16_bf16 v[114:129], a[8:11], v[130:133], v[114:129]
    s_waitcnt lgkmcnt(2)
    ds_read_b128 a[8:11], v12 offset:8256
    v_cvt_pk_bf16_f32 v70, v28, v29
    v_cvt_pk_bf16_f32 v136, v44, v45
    v_exp_f32 v31, v31
    v_exp_f32 v47, v47
    v_exp_f32 v82, v82
    v_exp_f32 v98, v98
    v_cvt_pk_bf16_f32 v71, v30, v31
    v_mfma_f32_32x32x16_bf16 v[16:31], a[0:3], v[72:75], 0
L_tp5:
    s_cbranch_execz L_tret
    buffer_load_dwordx4 v[208:211], v248, s[16:19], s54 offen
    v_cvt_pk_bf16_f32 v137, v46, v47
    v_exp_f32 v83, v83
    v_exp_f32 v99, v99
    v_exp_f32 v84, v84
    v_exp_f32 v100, v100
    v_cvt_pk_bf16_f32 v64, v82, v83
    v_mfma_f32_32x32x16_bf16 v[32:47], a[0:3], v[138:141], 0
    s_waitcnt lgkmcnt(2)
    ds_read_b128 a[0:3], v4 offset:10496
    v_add_u32 v4, 9472, v4
    v_cvt_pk_bf16_f32 v130, v98, v99
    v_exp_f32 v85, v85
    v_exp_f32 v101, v101
    v_exp_f32 v86, v86
    v_exp_f32 v102, v102
    v_cvt_pk_bf16_f32 v65, v84, v85
    v_mfma_f32_32x32x16_bf16 v[48:63], a[12:15], v[68:71], v[48:63]
    s_add_u32 s37, s37, 1
    v_cvt_pk_bf16_f32 v131, v100, v101
    v_exp_f32 v87, v87
    v_exp_f32 v103, v103
    v_exp_f32 v88, v88
    v_exp_f32 v104, v104
    v_cvt_pk_bf16_f32 v66, v86, v87
    v_mfma_f32_32x32x16_bf16 v[114:129], a[12:15], v[134:137], v[114:129]
    s_waitcnt lgkmcnt(1)
    ds_read_b128 a[12:15], v12 offset:8864
    v_cvt_pk_bf16_f32 v132, v102, v103
    v_exp_f32 v89, v89
    v_exp_f32 v105, v105
    v_exp_f32 v90, v90
    v_exp_f32 v106, v106
    v_cvt_pk_bf16_f32 v67, v88, v89
    v_mfma_f32_32x32x4_2b_bf16 v[16:47], a[4:5], v[76:77], v[16:47] cbsz:1 abid:0
    s_add_u32 s54, s54, s45
    buffer_load_dwordx4 v[212:215], v248, s[16:19], s54 offen
    v_cvt_pk_bf16_f32 v133, v104, v105
    v_exp_f32 v91, v91
    v_exp_f32 v107, v107
    v_exp_f32 v92, v92
    v_exp_f32 v108, v108
    v_cvt_pk_bf16_f32 v68, v90, v91
    v_cvt_pk_bf16_f32 v134, v106, v107
    v_exp_f32 v93, v93
    v_exp_f32 v109, v109
    v_exp_f32 v94, v94
    v_mfma_f32_32x32x16_bf16 v[48:63], a[8:11], v[64:67], v[48:63]
    v_add_u32 v3, 9472, v3
    v_exp_f32 v110, v110
    v_cvt_pk_bf16_f32 v69, v92, v93
    v_cvt_pk_bf16_f32 v135, v108, v109
    v_exp_f32 v95, v95
    v_exp_f32 v111, v111
    v_exp_f32 v96, v96
    v_exp_f32 v112, v112
    v_mfma_f32_32x32x16_bf16 v[114:129], a[8:11], v[130:133], v[114:129]
    s_waitcnt lgkmcnt(1)
    ds_read_b128 a[8:11], v12 offset:14080
    v_cvt_pk_bf16_f32 v70, v94, v95
    v_cvt_pk_bf16_f32 v136, v110, v111
    v_exp_f32 v97, v97
    v_exp_f32 v113, v113
    v_add_u32 v12, 9472, v12
    s_mov_b32 s38, 8
    s_call_b64 s[70:71], L_k2_P
L_k2_j:
    s_waitcnt vmcnt(0)
    s_cmp_lg_u32 s50, 1
    s_cbranch_scc1 L_k2_wbar
    v_perm_b32 v216, v152, v148, s51
    v_perm_b32 v217, v160, v156, s51
    v_perm_b32 v218, v168, v164, s51
    v_perm_b32 v219, v176, v172, s51
    v_perm_b32 v220, v152, v148, s52
    v_perm_b32 v221, v160, v156, s52
    v_perm_b32 v222, v168, v164, s52
    v_perm_b32 v223, v176, v172, s52
    v_perm_b32 v224, v153, v149, s51
    v_perm_b32 v225, v161, v157, s51
    v_perm_b32 v226, v169, v165, s51
    v_perm_b32 v227, v177, v173, s51
    v_perm_b32 v228, v153, v149, s52
    v_perm_b32 v229, v161, v157, s52
    v_perm_b32 v230, v169, v165, s52
    v_perm_b32 v231, v177, v173, s52
    v_perm_b32 v232, v154, v150, s51
    v_perm_b32 v233, v162, v158, s51
    v_perm_b32 v234, v170, v166, s51
    v_perm_b32 v235, v178, v174, s51
    v_perm_b32 v236, v154, v150, s52
    v_perm_b32 v237, v162, v158, s52
    v_perm_b32 v238, v170, v166, s52
    v_perm_b32 v239, v178, v174, s52
    v_perm_b32 v240, v155, v151, s51
    v_perm_b32 v241, v163, v159, s51
    v_perm_b32 v242, v171, v167, s51
    v_perm_b32 v243, v179, v175, s51
    v_perm_b32 v244, v155, v151, s52
    v_perm_b32 v245, v163, v159, s52
    v_perm_b32 v246, v171, v167, s52
    v_perm_b32 v247, v179, v175, s52
    s_add_u32 s38, s37, 1
    s_call_b64 s[70:71], L_k2_S
    s_cmp_ge_u32 s32, 2
    s_cbranch_scc1 L_k2_sn
    v_perm_b32 v216, v188, v184, s51
    v_perm_b32 v217, v196, v192, s51
    v_perm_b32 v218, v204, v200, s51
    v_perm_b32 v219, v212, v208, s51
    v_perm_b32 v220, v188, v184, s52
    v_perm_b32 v221, v196, v192, s52
    v_perm_b32 v222, v204, v200, s52
    v_perm_b32 v223, v212, v208, s52
    v_perm_b32 v224, v189, v185, s51
    v_perm_b32 v225, v197, v193, s51
    v_perm_b32 v226, v205, v201, s51
    v_perm_b32 v227, v213, v209, s51
    v_perm_b32 v228, v189, v185, s52
    v_perm_b32 v229, v197, v193, s52
    v_perm_b32 v230, v205, v201, s52
    v_perm_b32 v231, v213, v209, s52
    v_perm_b32 v232, v190, v186, s51
    v_perm_b32 v233, v198, v194, s51
    v_perm_b32 v234, v206, v202, s51
    v_perm_b32 v235, v214, v210, s51
    v_perm_b32 v236, v190, v186, s52
    v_perm_b32 v237, v198, v194, s52
    v_perm_b32 v238, v206, v202, s52
    v_perm_b32 v239, v214, v210, s52
    v_perm_b32 v240, v191, v187, s51
    v_perm_b32 v241, v199, v195, s51
    v_perm_b32 v242, v207, v203, s51
    v_perm_b32 v243, v215, v211, s51
    v_perm_b32 v244, v191, v187, s52
    v_perm_b32 v245, v199, v195, s52
    v_perm_b32 v246, v207, v203, s52
    v_perm_b32 v247, v215, v211, s52
    s_mov_b32 s27, s22
    s_add_u32 s38, s37, 1
    s_call_b64 s[70:71], L_k2_S
L_k2_sn:
    s_mov_b32 s27, s23
    s_movk_i32 s28, 2048
    v_mov_b32 v250, v249
    v_mov_b64 v[216:217], s[20:21]
    v_mov_b64 v[218:219], s[20:21]
    v_mov_b64 v[220:221], s[20:21]
    v_mov_b64 v[222:223], s[20:21]
    v_mov_b64 v[224:225], s[20:21]
    v_mov_b64 v[226:227], s[20:21]
    v_mov_b64 v[228:229], s[20:21]
    v_mov_b64 v[230:231], s[20:21]
    v_mov_b64 v[232:233], s[20:21]
    v_mov_b64 v[234:235], s[20:21]
    v_mov_b64 v[236:237], s[20:21]
    v_mov_b64 v[238:239], s[20:21]
    v_mov_b64 v[240:241], s[20:21]
    v_mov_b64 v[242:243], s[20:21]
    v_mov_b64 v[244:245], s[20:21]
    v_mov_b64 v[246:247], s[20:21]
    s_cmp_lt_u32 s32, 2
    s_cbranch_scc1 L_k2_c2
    s_add_u32 s38, s37, s26
    s_call_b64 s[70:71], L_k2_S
L_k2_c2:
    s_mov_b32 s38, 11
    s_call_b64 s[70:71], L_k2_P
    v_mov_b32 v148, s29
    s_mov_b64 exec, 1
    s_waitcnt vmcnt(0)
    buffer_store_dword v148, v2, s[8:11], s25 offen sc1
L_tp6:
    s_cbranch_execz L_tret
    s_mov_b64 exec, -1
    s_mov_b32 s27, s24
    s_cmp_ge_u32 s32, 2
    s_cbranch_scc1 L_k2_c3
    s_mov_b32 s38, 12
    s_call_b64 s[70:71], L_k2_S
    s_mov_b32 s38, 13
    s_call_b64 s[70:71], L_k2_P
    buffer_load_dwordx4 v[148:151], v2, s[8:11], s55 offen sc1
    s_mov_b32 s38, 14
    s_call_b64 s[70:71], L_k2_P
    s_waitcnt vmcnt(0)
    s_branch L_k2_fl
L_k2_fr:
    buffer_load_dwordx4 v[148:151], v2, s[8:11], s55 offen sc1
    s_waitcnt vmcnt(0)
    s_branch L_k2_fl
L_k2_c3:
    s_mov_b32 s38, 13
    s_call_b64 s[70:71], L_k2_S
    buffer_load_dwordx4 v[148:151], v2, s[8:11], s55 offen sc1
    s_mov_b32 s38, 14
    s_call_b64 s[70:71], L_k2_S
    s_waitcnt vmcnt(8)
L_k2_fl:
    v_cmpx_ne_u32 vcc, 0, v148
    v_cmpx_ne_u32 vcc, 0, v149
    v_cmpx_ne_u32 vcc, 0, v150
    v_cmpx_ne_u32 vcc, 0, v151
    s_sub_u32 s65, s65, 1
    s_cselect_b64 exec, -1, exec
    s_cmp_eq_u64 exec, -1
    s_mov_b64 exec, -1
    s_cbranch_scc0 L_k2_fr
    v_xor_b32 v148, s29, v148
    v_xor_b32 v149, s29, v149
    v_xor_b32 v150, s29, v150
    v_xor_b32 v151, s29, v151
    v_or3_b32 v148, v148, v149, v150
    v_or_b32 v148, v148, v151
    v_cmp_ne_u32 vcc, 0, v148
    s_barrier
    v_exp_f32 v16, v16
    v_exp_f32 v32, v32
    v_cvt_pk_bf16_f32 v71, v96, v97
    v_mfma_f32_32x32x16_bf16 v[82:97], a[0:3], v[72:75], 0
    s_add_u32 s34, s34, 16384
    buffer_load_dwordx4 v2, s[8:11], s34 offen offset:0 lds
    v_cvt_pk_bf16_f32 v137, v112, v113
    v_exp_f32 v17, v17
    v_exp_f32 v33, v33
    v_exp_f32 v18, v18
    v_exp_f32 v34, v34
    v_cvt_pk_bf16_f32 v64, v16, v17
    v_mfma_f32_32x32x16_bf16 v[98:113], a[0:3], v[138:141], 0
    s_waitcnt lgkmcnt(1)
    ds_read_b128 a[0:3], v4 offset:2048
    v_cvt_pk_bf16_f32 v130, v32, v33
    v_exp_f32 v19, v19
    v_exp_f32 v35, v35
    v_exp_f32 v20, v20
    v_exp_f32 v36, v36
    v_cvt_pk_bf16_f32 v65, v18, v19
    v_mfma_f32_32x32x16_bf16 v[48:63], a[12:15], v[68:71], v[48:63]
    s_lshl_b32 s35, s30, 1
    buffer_load_dwordx4 v2, s[8:11], s34 offen offset:1024 lds
    v_cvt_pk_bf16_f32 v131, v34, v35
    v_exp_f32 v21, v21
    v_exp_f32 v37, v37
    v_exp_f32 v22, v22
    v_exp_f32 v38, v38
    v_cvt_pk_bf16_f32 v66, v20, v21
    v_mfma_f32_32x32x16_bf16 v[114:129], a[12:15], v[134:137], v[114:129]
    s_waitcnt lgkmcnt(1)
    ds_read_b128 a[12:15], v12 offset:5216
    s_add_u32 s57, s56, 0
    buffer_load_dwordx4 a[188:191], v2, s[8:11], s57 offen offset:0
    v_cvt_pk_bf16_f32 v132, v36, v37
    v_exp_f32 v23, v23
    v_exp_f32 v39, v39
    v_exp_f32 v24, v24
    v_exp_f32 v40, v40
    v_cvt_pk_bf16_f32 v67, v22, v23
    v_mfma_f32_32x32x4_2b_bf16 v[82:113], a[4:5], v[76:77], v[82:113] cbsz:1 abid:1
    s_lshr_b64 vcc, vcc, s35
    buffer_load_dwordx4 v2, s[8:11], s34 offen offset:2048 lds
    s_and_b32 s29, vcc_lo, 3
    buffer_load_dwordx4 v2, s[8:11], s34 offen offset:3072 lds
    v_cvt_pk_bf16_f32 v133, v38, v39
    v_exp_f32 v25, v25
    v_exp_f32 v41, v41
    v_exp_f32 v26, v26
    v_exp_f32 v42, v42
    v_cvt_pk_bf16_f32 v68, v24, v25
    v_cvt_pk_bf16_f32 v134, v40, v41
    v_exp_f32 v27, v27
    v_exp_f32 v43, v43
    v_exp_f32 v28, v28
    v_mfma_f32_32x32x16_bf16 v[48:63], a[8:11], v[64:67], v[48:63]
    buffer_load_dwordx4 a[192:195], v2, s[8:11], s57 offen offset:1024
    s_add_u32 m0, m0, 16384
    v_exp_f32 v44, v44
    v_cvt_pk_bf16_f32 v69, v26, v27
    v_cvt_pk_bf16_f32 v135, v42, v43
    v_exp_f32 v29, v29
    v_exp_f32 v45, v45
    v_exp_f32 v30, v30
    v_exp_f32 v46, v46
    v_mfma_f32_32x32x16_bf16 v[114:129], a[8:11], v[130:133], v[114:129]
    s_waitcnt lgkmcnt(1)
    ds_read_b128 a[8:11], v12 offset:5824
    buffer_load_dwordx4 a[196:199], v2, s[8:11], s57 offen offset:2048
    v_cvt_pk_bf16_f32 v70, v28, v29
    v_cvt_pk_bf16_f32 v136, v44, v45
    v_exp_f32 v31, v31
    v_exp_f32 v47, v47
    v_exp_f32 v82, v82
    v_exp_f32 v98, v98
    v_cvt_pk_bf16_f32 v71, v30, v31
    v_mfma_f32_32x32x16_bf16 v[16:31], a[0:3], v[72:75], 0
    s_add_u32 s34, s34, 16384
    buffer_load_dwordx4 v2, s[8:11], s34 offen offset:0 lds
    v_cvt_pk_bf16_f32 v137, v46, v47
    v_exp_f32 v83, v83
    v_exp_f32 v99, v99
    v_exp_f32 v84, v84
    v_exp_f32 v100, v100
    v_cvt_pk_bf16_f32 v64, v82, v83
    v_mfma_f32_32x32x16_bf16 v[32:47], a[0:3], v[138:141], 0
    s_waitcnt lgkmcnt(1)
    ds_read_b128 a[0:3], v4 offset:3072
    v_cvt_pk_bf16_f32 v130, v98, v99
    v_exp_f32 v85, v85
    v_exp_f32 v101, v101
    v_exp_f32 v86, v86
    v_exp_f32 v102, v102
    v_cvt_pk_bf16_f32 v65, v84, v85
    v_mfma_f32_32x32x16_bf16 v[48:63], a[12:15], v[68:71], v[48:63]
    buffer_load_dwordx4 v2, s[8:11], s34 offen offset:1024 lds
    v_cvt_pk_bf16_f32 v131, v100, v101
    v_exp_f32 v87, v87
    v_exp_f32 v103, v103
    v_exp_f32 v88, v88
    v_exp_f32 v104, v104
    v_cvt_pk_bf16_f32 v66, v86, v87
    v_mfma_f32_32x32x16_bf16 v[114:129], a[12:15], v[134:137], v[114:129]
    s_waitcnt lgkmcnt(1)
    ds_read_b128 a[12:15], v12 offset:6432
    buffer_load_dwordx4 a[200:203], v2, s[8:11], s57 offen offset:3072
    v_cvt_pk_bf16_f32 v132, v102, v103
    v_exp_f32 v89, v89
    v_exp_f32 v105, v105
    v_exp_f32 v90, v90
    v_exp_f32 v106, v106
    v_cvt_pk_bf16_f32 v67, v88, v89
    v_mfma_f32_32x32x4_2b_bf16 v[16:47], a[6:7], v[76:77], v[16:47] cbsz:1 abid:0
    buffer_load_dwordx4 v2, s[8:11], s34 offen offset:2048 lds
    buffer_load_dwordx4 v2, s[8:11], s34 offen offset:3072 lds
    v_cvt_pk_bf16_f32 v133, v104, v105
    v_exp_f32 v91, v91
    v_exp_f32 v107, v107
    v_exp_f32 v92, v92
    v_exp_f32 v108, v108
    v_cvt_pk_bf16_f32 v68, v90, v91
    v_cvt_pk_bf16_f32 v134, v106, v107
    v_exp_f32 v93, v93
    v_exp_f32 v109, v109
    v_exp_f32 v94, v94
    v_mfma_f32_32x32x16_bf16 v[48:63], a[8:11], v[64:67], v[48:63]
    s_add_u32 s57, s56, 4096
    buffer_load_dwordx4 a[204:207], v2, s[8:11], s57 offen offset:0
    s_add_u32 m0, m0, 16384
    ds_read_b32 a4, v3 offset:9472
    v_exp_f32 v110, v110
    v_cvt_pk_bf16_f32 v69, v92, v93
    v_cvt_pk_bf16_f32 v135, v108, v109
    v_exp_f32 v95, v95
    v_exp_f32 v111, v111
    v_exp_f32 v96, v96
    v_exp_f32 v112, v112
    v_mfma_f32_32x32x16_bf16 v[114:129], a[8:11], v[130:133], v[114:129]
    s_waitcnt lgkmcnt(2)
    ds_read_b128 a[8:11], v12 offset:7040
    buffer_load_dwordx4 a[208:211], v2, s[8:11], s57 offen offset:1024
L_tp7:
    s_cbranch_execz L_tret
    v_cvt_pk_bf16_f32 v70, v94, v95
    v_cvt_pk_bf16_f32 v136, v110, v111
    v_exp_f32 v97, v97
    v_exp_f32 v113, v113
    v_exp_f32 v16, v16
    v_exp_f32 v32, v32
    v_cvt_pk_bf16_f32 v71, v96, v97
    v_mfma_f32_32x32x16_bf16 v[82:97], a[0:3], v[72:75], 0
    s_add_u32 s34, s34, 16384
    buffer_load_dwordx4 v2, s[8:11], s34 offen offset:0 lds
    v_cvt_pk_bf16_f32 v137, v112, v113
    v_exp_f32 v17, v17
    v_exp_f32 v33, v33
    v_exp_f32 v18, v18
    v_exp_f32 v34, v34
    v_cvt_pk_bf16_f32 v64, v16, v17
    v_mfma_f32_32x32x16_bf16 v[98:113], a[0:3], v[138:141], 0
    s_waitcnt lgkmcnt(2)
    ds_read_b128 a[0:3], v4 offset:9472
    v_cvt_pk_bf16_f32 v130, v32, v33
    v_exp_f32 v19, v19
    v_exp_f32 v35, v35
    v_exp_f32 v20, v20
    v_exp_f32 v36, v36
    v_cvt_pk_bf16_f32 v65, v18, v19
    v_mfma_f32_32x32x16_bf16 v[48:63], a[12:15], v[68:71], v[48:63]
    buffer_load_dwordx4 v2, s[8:11], s34 offen offset:1024 lds
    v_cvt_pk_bf16_f32 v131, v34, v35
    v_exp_f32 v21, v21
    v_exp_f32 v37, v37
    v_exp_f32 v22, v22
    v_exp_f32 v38, v38
    v_cvt_pk_bf16_f32 v66, v20, v21
    v_mfma_f32_32x32x16_bf16 v[114:129], a[12:15], v[134:137], v[114:129]
    s_waitcnt lgkmcnt(1)
    ds_read_b128 a[12:15], v12 offset:7648
    buffer_load_dwordx4 a[212:215], v2, s[8:11], s57 offen offset:2048
    v_cvt_pk_bf16_f32 v132, v36, v37
    v_exp_f32 v23, v23
    v_exp_f32 v39, v39
    v_exp_f32 v24, v24
    v_exp_f32 v40, v40
    v_cvt_pk_bf16_f32 v67, v22, v23
    v_mfma_f32_32x32x4_2b_bf16 v[82:113], a[6:7], v[76:77], v[82:113] cbsz:1 abid:1
    buffer_load_dwordx4 v2, s[8:11], s34 offen offset:2048 lds
    buffer_load_dwordx4 v2, s[8:11], s34 offen offset:3072 lds
    v_cvt_pk_bf16_f32 v133, v38, v39
    v_exp_f32 v25, v25
    v_exp_f32 v41, v41
    v_exp_f32 v26, v26
    v_exp_f32 v42, v42
    v_cvt_pk_bf16_f32 v68, v24, v25
    v_cvt_pk_bf16_f32 v134, v40, v41
    v_exp_f32 v27, v27
    v_exp_f32 v43, v43
    v_exp_f32 v28, v28
    v_mfma_f32_32x32x16_bf16 v[48:63], a[8:11], v[64:67], v[48:63]
    buffer_load_dwordx4 a[216:219], v2, s[8:11], s57 offen offset:3072
    s_add_u32 m0, m0, 16384
    ds_read_b32 a6, v3 offset:9480
    v_exp_f32 v44, v44
    v_cvt_pk_bf16_f32 v69, v26, v27
    v_cvt_pk_bf16_f32 v135, v42, v43
    v_exp_f32 v29, v29
    v_exp_f32 v45, v45
    v_exp_f32 v30, v30
    v_exp_f32 v46, v46
    v_mfma_f32_32x32x16_bf16 v[114:129], a[8:11], v[130:133], v[114:129]
    s_waitcnt lgkmcnt(2)
    ds_read_b128 a[8:11], v12 offset:8256
    s_add_u32 s57, s56, 8192
    buffer_load_dwordx4 a[220:223], v2, s[8:11], s57 offen offset:0
    v_cvt_pk_bf16_f32 v70, v28, v29
    v_cvt_pk_bf16_f32 v136, v44, v45
    v_exp_f32 v31, v31
    v_exp_f32 v47, v47
    v_exp_f32 v82, v82
    v_exp_f32 v98, v98
    v_cvt_pk_bf16_f32 v71, v30, v31
    v_mfma_f32_32x32x16_bf16 v[16:31], a[0:3], v[72:75], 0
    s_add_u32 s34, s34, 16384
    buffer_load_dwordx4 v2, s[8:11], s34 offen offset:0 lds
    v_cvt_pk_bf16_f32 v137, v46, v47
    v_exp_f32 v83, v83
    v_exp_f32 v99, v99
    v_exp_f32 v84, v84
    v_exp_f32 v100, v100
    v_cvt_pk_bf16_f32 v64, v82, v83
    v_mfma_f32_32x32x16_bf16 v[32:47], a[0:3], v[138:141], 0
    s_waitcnt lgkmcnt(2)
    ds_read_b128 a[0:3], v4 offset:10496
    v_add_u32 v4, 9472, v4
    v_cvt_pk_bf16_f32 v130, v98, v99
    v_exp_f32 v85, v85
    v_exp_f32 v101, v101
    v_exp_f32 v86, v86
    v_exp_f32 v102, v102
    v_cvt_pk_bf16_f32 v65, v84, v85
    v_mfma_f32_32x32x16_bf16 v[48:63], a[12:15], v[68:71], v[48:63]
    s_add_u32 s37, s37, 1
    buffer_load_dwordx4 v2, s[8:11], s34 offen offset:1024 lds
    v_cvt_pk_bf16_f32 v131, v100, v101
    v_exp_f32 v87, v87
    v_exp_f32 v103, v103
    v_exp_f32 v88, v88
    v_exp_f32 v104, v104
    v_cvt_pk_bf16_f32 v66, v86, v87
    v_mfma_f32_32x32x16_bf16 v[114:129], a[12:15], v[134:137], v[114:129]
    s_waitcnt lgkmcnt(1)
    ds_read_b128 a[12:15], v12 offset:8864
    buffer_load_dwordx4 a[224:227], v2, s[8:11], s57 offen offset:1024
    v_cvt_pk_bf16_f32 v132, v102, v103
    v_exp_f32 v89, v89
    v_exp_f32 v105, v105
    v_exp_f32 v90, v90
    v_exp_f32 v106, v106
    v_cvt_pk_bf16_f32 v67, v88, v89
    v_mfma_f32_32x32x4_2b_bf16 v[16:47], a[4:5], v[76:77], v[16:47] cbsz:1 abid:0
    buffer_load_dwordx4 v2, s[8:11], s34 offen offset:2048 lds
    buffer_load_dwordx4 v2, s[8:11], s34 offen offset:3072 lds
    v_cvt_pk_bf16_f32 v133, v104, v105
    v_exp_f32 v91, v91
    v_exp_f32 v107, v107
    v_exp_f32 v92, v92
    v_exp_f32 v108, v108
    v_cvt_pk_bf16_f32 v68, v90, v91
    v_cvt_pk_bf16_f32 v134, v106, v107
    v_exp_f32 v93, v93
    v_exp_f32 v109, v109
    v_exp_f32 v94, v94
    v_mfma_f32_32x32x16_bf16 v[48:63], a[8:11], v[64:67], v[48:63]
    buffer_load_dwordx4 a[228:231], v2, s[8:11], s57 offen offset:2048
    s_add_u32 m0, m0, 16384
    v_add_u32 v3, 9472, v3
    v_exp_f32 v110, v110
    v_cvt_pk_bf16_f32 v69, v92, v93
    v_cvt_pk_bf16_f32 v135, v108, v109
    v_exp_f32 v95, v95
    v_exp_f32 v111, v111
    v_exp_f32 v96, v96
    v_exp_f32 v112, v112
    v_mfma_f32_32x32x16_bf16 v[114:129], a[8:11], v[130:133], v[114:129]
    s_waitcnt lgkmcnt(1)
    ds_read_b128 a[8:11], v12 offset:14080
    buffer_load_dwordx4 a[232:235], v2, s[8:11], s57 offen offset:3072
    v_cvt_pk_bf16_f32 v70, v94, v95
    v_cvt_pk_bf16_f32 v136, v110, v111
    v_exp_f32 v97, v97
    v_exp_f32 v113, v113
    v_add_u32 v12, 9472, v12
    v_exp_f32 v16, v16
    v_exp_f32 v32, v32
    v_cvt_pk_bf16_f32 v71, v96, v97
    v_mfma_f32_32x32x16_bf16 v[82:97], a[0:3], v[72:75], 0
    s_add_u32 s34, s34, 16384
    buffer_load_dwordx4 v2, s[8:11], s34 offen offset:0 lds
    v_cvt_pk_bf16_f32 v137, v112, v113
    v_exp_f32 v17, v17
    v_exp_f32 v33, v33
    v_exp_f32 v18, v18
    v_exp_f32 v34, v34
    v_cvt_pk_bf16_f32 v64, v16, v17
    v_mfma_f32_32x32x16_bf16 v[98:113], a[0:3], v[138:141], 0
    s_waitcnt lgkmcnt(1)
    ds_read_b128 a[0:3], v4 offset:2048
    v_cvt_pk_bf16_f32 v130, v32, v33
    v_exp_f32 v19, v19
    v_exp_f32 v35, v35
    v_exp_f32 v20, v20
L_tp8:
    s_cbranch_execz L_tret
    v_exp_f32 v36, v36
    v_cvt_pk_bf16_f32 v65, v18, v19
    v_mfma_f32_32x32x16_bf16 v[48:63], a[12:15], v[68:71], v[48:63]
    buffer_load_dwordx4 v2, s[8:11], s34 offen offset:1024 lds
    v_cvt_pk_bf16_f32 v131, v34, v35
    v_exp_f32 v21, v21
    v_exp_f32 v37, v37
    v_exp_f32 v22, v22
    v_exp_f32 v38, v38
    v_cvt_pk_bf16_f32 v66, v20, v21
    v_mfma_f32_32x32x16_bf16 v[114:129], a[12:15], v[134:137], v[114:129]
    s_waitcnt lgkmcnt(1)
    ds_read_b128 a[12:15], v12 offset:5216
    v_cvt_pk_bf16_f32 v132, v36, v37
    v_exp_f32 v23, v23
    v_exp_f32 v39, v39
    v_exp_f32 v24, v24
    v_exp_f32 v40, v40
    v_cvt_pk_bf16_f32 v67, v22, v23
    v_mfma_f32_32x32x4_2b_bf16 v[82:113], a[4:5], v[76:77], v[82:113] cbsz:1 abid:1
    buffer_load_dwordx4 v2, s[8:11], s34 offen offset:2048 lds
    buffer_load_dwordx4 v2, s[8:11], s34 offen offset:3072 lds
    v_cvt_pk_bf16_f32 v133, v38, v39
    v_exp_f32 v25, v25
    v_exp_f32 v41, v41
    v_exp_f32 v26, v26
    v_exp_f32 v42, v42
    v_cvt_pk_bf16_f32 v68, v24, v25
    v_cvt_pk_bf16_f32 v134, v40, v41
    v_exp_f32 v27, v27
    v_exp_f32 v43, v43
    v_exp_f32 v28, v28
    v_mfma_f32_32x32x16_bf16 v[48:63], a[8:11], v[64:67], v[48:63]
    s_add_u32 m0, m0, s66
    v_exp_f32 v44, v44
    v_cvt_pk_bf16_f32 v69, v26, v27
    v_cvt_pk_bf16_f32 v135, v42, v43
    v_exp_f32 v29, v29
    v_exp_f32 v45, v45
    v_exp_f32 v30, v30
    v_exp_f32 v46, v46
    v_mfma_f32_32x32x16_bf16 v[114:129], a[8:11], v[130:133], v[114:129]
    s_waitcnt lgkmcnt(1)
    ds_read_b128 a[8:11], v12 offset:5824
    v_cvt_pk_bf16_f32 v70, v28, v29
    v_cvt_pk_bf16_f32 v136, v44, v45
    v_exp_f32 v31, v31
    v_exp_f32 v47, v47
    v_exp_f32 v82, v82
    v_exp_f32 v98, v98
    v_cvt_pk_bf16_f32 v71, v30, v31
    v_mfma_f32_32x32x16_bf16 v[16:31], a[0:3], v[72:75], 0
    s_add_u32 s34, s34, s66
    buffer_load_dwordx4 v2, s[8:11], s34 offen offset:0 lds
    v_cvt_pk_bf16_f32 v137, v46, v47
    v_exp_f32 v83, v83
    v_exp_f32 v99, v99
    v_exp_f32 v84, v84
    v_exp_f32 v100, v100
    v_cvt_pk_bf16_f32 v64, v82, v83
    v_mfma_f32_32x32x16_bf16 v[32:47], a[0:3], v[138:141], 0
    s_waitcnt lgkmcnt(1)
    ds_read_b128 a[0:3], v4 offset:3072
    v_cvt_pk_bf16_f32 v130, v98, v99
    v_exp_f32 v85, v85
    v_exp_f32 v101, v101
    v_exp_f32 v86, v86
    v_exp_f32 v102, v102
    v_cvt_pk_bf16_f32 v65, v84, v85
    v_mfma_f32_32x32x16_bf16 v[48:63], a[12:15], v[68:71], v[48:63]
    s_add_u32 s57, s56, 16384
    buffer_load_dwordx4 v[148:151], v2, s[8:11], s57 offen offset:1024
    v_cvt_pk_bf16_f32 v131, v100, v101
    v_exp_f32 v87, v87
    v_exp_f32 v103, v103
    v_exp_f32 v88, v88
    v_exp_f32 v104, v104
    v_cvt_pk_bf16_f32 v66, v86, v87
    v_mfma_f32_32x32x16_bf16 v[114:129], a[12:15], v[134:137], v[114:129]
    s_waitcnt lgkmcnt(1)
    ds_read_b128 a[12:15], v12 offset:6432
    buffer_load_dwordx4 v[152:155], v2, s[8:11], s57 offen offset:2048
    v_cvt_pk_bf16_f32 v132, v102, v103
    v_exp_f32 v89, v89
    v_exp_f32 v105, v105
    v_exp_f32 v90, v90
    v_exp_f32 v106, v106
    v_cvt_pk_bf16_f32 v67, v88, v89
    v_mfma_f32_32x32x4_2b_bf16 v[16:47], a[6:7], v[76:77], v[16:47] cbsz:1 abid:0
    buffer_load_dwordx4 v[156:159], v2, s[8:11], s57 offen offset:3072
    s_add_u32 s57, s56, 20480
    buffer_load_dwordx4 v[160:163], v2, s[8:11], s57 offen offset:0
    v_cvt_pk_bf16_f32 v133, v104, v105
    v_exp_f32 v91, v91
    v_exp_f32 v107, v107
    v_exp_f32 v92, v92
    v_exp_f32 v108, v108
    v_cvt_pk_bf16_f32 v68, v90, v91
    v_cvt_pk_bf16_f32 v134, v106, v107
    v_exp_f32 v93, v93
    v_exp_f32 v109, v109
    v_exp_f32 v94, v94
    v_mfma_f32_32x32x16_bf16 v[48:63], a[8:11], v[64:67], v[48:63]
    buffer_load_dwordx4 v[164:167], v2, s[8:11], s57 offen offset:1024
    ds_read_b32 a4, v3 offset:9472
    v_exp_f32 v110, v110
    v_cvt_pk_bf16_f32 v69, v92, v93
    v_cvt_pk_bf16_f32 v135, v108, v109
    v_exp_f32 v95, v95
    v_exp_f32 v111, v111
    v_exp_f32 v96, v96
    v_exp_f32 v112, v112
    v_mfma_f32_32x32x16_bf16 v[114:129], a[8:11], v[130:133], v[114:129]
    s_waitcnt lgkmcnt(2)
    ds_read_b128 a[8:11], v12 offset:7040
    buffer_load_dwordx4 v[168:171], v2, s[8:11], s57 offen offset:2048
    v_cvt_pk_bf16_f32 v70, v94, v95
    v_cvt_pk_bf16_f32 v136, v110, v111
    v_exp_f32 v97, v97
    v_exp_f32 v113, v113
    v_exp_f32 v16, v16
    v_exp_f32 v32, v32
    v_cvt_pk_bf16_f32 v71, v96, v97
    v_mfma_f32_32x32x16_bf16 v[82:97], a[0:3], v[72:75], 0
    buffer_load_dwordx4 v[172:175], v2, s[8:11], s57 offen offset:3072
    v_cvt_pk_bf16_f32 v137, v112, v113
    v_exp_f32 v17, v17
    v_exp_f32 v33, v33
    v_exp_f32 v18, v18
    v_exp_f32 v34, v34
    v_cvt_pk_bf16_f32 v64, v16, v17
    v_mfma_f32_32x32x16_bf16 v[98:113], a[0:3], v[138:141], 0
    s_waitcnt lgkmcnt(2)
    ds_read_b128 a[0:3], v4 offset:9472
    v_cvt_pk_bf16_f32 v130, v32, v33
    v_exp_f32 v19, v19
    v_exp_f32 v35, v35
    v_exp_f32 v20, v20
    v_exp_f32 v36, v36
    v_cvt_pk_bf16_f32 v65, v18, v19
    v_mfma_f32_32x32x16_bf16 v[48:63], a[12:15], v[68:71], v[48:63]
    s_add_u32 s57, s56, 24576
    buffer_load_dwordx4 v[176:179], v2, s[8:11], s57 offen offset:0
    v_cvt_pk_bf16_f32 v131, v34, v35
    v_exp_f32 v21, v21
    v_exp_f32 v37, v37
    v_exp_f32 v22, v22
    v_exp_f32 v38, v38
    v_cvt_pk_bf16_f32 v66, v20, v21
    v_mfma_f32_32x32x16_bf16 v[114:129], a[12:15], v[134:137], v[114:129]
    s_waitcnt lgkmcnt(1)
    ds_read_b128 a[12:15], v12 offset:7648
    s_add_u32 m0, s59, 86016
    s_add_u32 s57, s56, 313344
    buffer_load_dwordx4 v2, s[8:11], s57 offen offset:0 lds
    v_cvt_pk_bf16_f32 v132, v36, v37
    v_exp_f32 v23, v23
    v_exp_f32 v39, v39
    v_exp_f32 v24, v24
    v_exp_f32 v40, v40
    v_cvt_pk_bf16_f32 v67, v22, v23
    v_mfma_f32_32x32x4_2b_bf16 v[82:113], a[6:7], v[76:77], v[82:113] cbsz:1 abid:1
L_tp9:
    s_cbranch_execz L_tret
    buffer_load_dwordx4 v2, s[8:11], s57 offen offset:1024 lds
    buffer_load_dwordx4 v2, s[8:11], s57 offen offset:2048 lds
    v_cvt_pk_bf16_f32 v133, v38, v39
    v_exp_f32 v25, v25
    v_exp_f32 v41, v41
    v_exp_f32 v26, v26
    v_exp_f32 v42, v42
    v_cvt_pk_bf16_f32 v68, v24, v25
    v_cvt_pk_bf16_f32 v134, v40, v41
    v_exp_f32 v27, v27
    v_exp_f32 v43, v43
    v_exp_f32 v28, v28
    v_mfma_f32_32x32x16_bf16 v[48:63], a[8:11], v[64:67], v[48:63]
    buffer_load_dwordx4 v2, s[8:11], s57 offen offset:3072 lds
    ds_read_b32 a6, v3 offset:9480
    v_exp_f32 v44, v44
    v_cvt_pk_bf16_f32 v69, v26, v27
    v_cvt_pk_bf16_f32 v135, v42, v43
    v_exp_f32 v29, v29
    v_exp_f32 v45, v45
    v_exp_f32 v30, v30
    v_exp_f32 v46, v46
    v_mfma_f32_32x32x16_bf16 v[114:129], a[8:11], v[130:133], v[114:129]
    s_waitcnt lgkmcnt(2)
    ds_read_b128 a[8:11], v12 offset:8256
    s_add_u32 m0, m0, 16384
    s_add_u32 s57, s56, 317440
    buffer_load_dwordx4 v2, s[8:11], s57 offen offset:0 lds
    v_cvt_pk_bf16_f32 v70, v28, v29
    v_cvt_pk_bf16_f32 v136, v44, v45
    v_exp_f32 v31, v31
    v_exp_f32 v47, v47
    v_exp_f32 v82, v82
    v_exp_f32 v98, v98
    v_cvt_pk_bf16_f32 v71, v30, v31
    v_mfma_f32_32x32x16_bf16 v[16:31], a[0:3], v[72:75], 0
    buffer_load_dwordx4 v2, s[8:11], s57 offen offset:1024 lds
    v_cvt_pk_bf16_f32 v137, v46, v47
    v_exp_f32 v83, v83
    v_exp_f32 v99, v99
    v_exp_f32 v84, v84
    v_exp_f32 v100, v100
    v_cvt_pk_bf16_f32 v64, v82, v83
    v_mfma_f32_32x32x16_bf16 v[32:47], a[0:3], v[138:141], 0
    s_waitcnt lgkmcnt(2)
    ds_read_b128 a[0:3], v4 offset:10496
    v_add_u32 v4, 9472, v4
    v_cvt_pk_bf16_f32 v130, v98, v99
    v_exp_f32 v85, v85
    v_exp_f32 v101, v101
    v_exp_f32 v86, v86
    v_exp_f32 v102, v102
    v_cvt_pk_bf16_f32 v65, v84, v85
    v_mfma_f32_32x32x16_bf16 v[48:63], a[12:15], v[68:71], v[48:63]
    s_add_u32 s37, s37, 1
    buffer_load_dwordx4 v2, s[8:11], s57 offen offset:2048 lds
    v_cvt_pk_bf16_f32 v131, v100, v101
    v_exp_f32 v87, v87
    v_exp_f32 v103, v103
    v_exp_f32 v88, v88
    v_exp_f32 v104, v104
    v_cvt_pk_bf16_f32 v66, v86, v87
    v_mfma_f32_32x32x16_bf16 v[114:129], a[12:15], v[134:137], v[114:129]
    s_waitcnt lgkmcnt(1)
    ds_read_b128 a[12:15], v12 offset:8864
    buffer_load_dwordx4 v2, s[8:11], s57 offen offset:3072 lds
    v_cvt_pk_bf16_f32 v132, v102, v103
    v_exp_f32 v89, v89
    v_exp_f32 v105, v105
    v_exp_f32 v90, v90
    v_exp_f32 v106, v106
    v_cvt_pk_bf16_f32 v67, v88, v89
    v_mfma_f32_32x32x4_2b_bf16 v[16:47], a[4:5], v[76:77], v[16:47] cbsz:1 abid:0
    s_sub_u32 m0, 135168, s66
    s_add_u32 s57, s56, 325632
    buffer_load_dwordx4 v2, s[8:11], s57 offen offset:0 lds
    buffer_load_dwordx4 v2, s[8:11], s57 offen offset:1024 lds
    v_cvt_pk_bf16_f32 v133, v104, v105
    v_exp_f32 v91, v91
    v_exp_f32 v107, v107
    v_exp_f32 v92, v92
    v_exp_f32 v108, v108
    v_cvt_pk_bf16_f32 v68, v90, v91
    v_cvt_pk_bf16_f32 v134, v106, v107
    v_exp_f32 v93, v93
    v_exp_f32 v109, v109
    v_exp_f32 v94, v94
    v_mfma_f32_32x32x16_bf16 v[48:63], a[8:11], v[64:67], v[48:63]
    buffer_load_dwordx4 v2, s[8:11], s57 offen offset:2048 lds
    v_add_u32 v3, 9472, v3
    v_exp_f32 v110, v110
    v_cvt_pk_bf16_f32 v69, v92, v93
    v_cvt_pk_bf16_f32 v135, v108, v109
    v_exp_f32 v95, v95
    v_exp_f32 v111, v111
    v_exp_f32 v96, v96
    v_exp_f32 v112, v112
    v_mfma_f32_32x32x16_bf16 v[114:129], a[8:11], v[130:133], v[114:129]
    s_waitcnt lgkmcnt(1)
    ds_read_b128 a[8:11], v12 offset:14080
    s_add_u32 m0, m0, 32768
    s_add_u32 s57, s56, 328704
    buffer_load_dwordx4 v2, s[8:11], s57 offen offset:0 lds
    v_cvt_pk_bf16_f32 v70, v94, v95
    v_cvt_pk_bf16_f32 v136, v110, v111
    v_exp_f32 v97, v97
    v_exp_f32 v113, v113
    v_add_u32 v12, 9472, v12
L_k2_e16:
    v_cvt_pk_bf16_f32 v71, v96, v97
    v_cvt_pk_bf16_f32 v137, v112, v113
    s_waitcnt lgkmcnt(0)
    v_mfma_f32_32x32x16_bf16 v[48:63], a[12:15], v[68:71], v[48:63]
    v_mfma_f32_32x32x16_bf16 v[114:129], a[12:15], v[134:137], v[114:129]
L_tp10:
    s_cbranch_execz L_tret
    buffer_load_dwordx4 v2, s[8:11], s57 offen offset:1024 lds
    buffer_load_dwordx4 v2, s[8:11], s57 offen offset:2048 lds
L_k2_e17:
    v_lshl_add_u32 v254, v6, 1, v7
    v_lshl_add_u32 v254, v254, 4, v5
    v_lshlrev_b32 v254, 4, v254
    v_lshlrev_b32 v255, 4, v5
    v_lshl_add_u32 v255, v6, 2, v255
    s_lshl_b32 s26, s31, 11
    s_add_u32 s26, s26, s33
    s_add_u32 s26, s26, 0x02860000
    s_lshl_b32 s27, s31, 8
    s_add_u32 s27, s27, s33
    s_add_u32 s27, s27, 0x02864000
    v_mov_b32 v13, 0x53800000
    v_mov_b32 v14, 0x207
    v_rcp_f32 v60, v58
    v_pk_add_f32 v[16:17], v[48:49], v[50:51]
    v_pk_add_f32 v[16:17], v[16:17], v[52:53]
    v_pk_add_f32 v[16:17], v[16:17], v[54:55]
    v_pk_add_f32 v[16:17], v[16:17], v[56:57]
    v_max_f32 v59, v58, v60
    v_add_f32 v16, v16, v17
    v_cmp_nle_f32 s[40:41], v59, v13
    v_cmp_class_f32 s[42:43], v16, v14
    v_rcp_f32 v126, v124
    v_pk_add_f32 v[32:33], v[114:115], v[116:117]
    v_pk_add_f32 v[32:33], v[32:33], v[118:119]
    v_pk_add_f32 v[32:33], v[32:33], v[120:121]
    v_pk_add_f32 v[32:33], v[32:33], v[122:123]
    v_max_f32 v125, v124, v126
    v_add_f32 v32, v32, v33
    v_cmp_nle_f32 s[44:45], v125, v13
    v_cmp_class_f32 s[46:47], v32, v14
    v_pk_mul_f32 v[82:83], v[48:49], v[60:61] op_sel_hi:[1,0]
    v_pk_mul_f32 v[84:85], v[50:51], v[60:61] op_sel_hi:[1,0]
    v_pk_mul_f32 v[86:87], v[52:53], v[60:61] op_sel_hi:[1,0]
    v_pk_mul_f32 v[88:89], v[54:55], v[60:61] op_sel_hi:[1,0]
    v_pk_mul_f32 v[90:91], v[56:57], v[60:61] op_sel_hi:[1,0]
    s_or_b64 s[40:41], s[40:41], s[42:43]
    s_or_b64 s[44:45], s[44:45], s[46:47]
    s_or_b64 s[40:41], s[40:41], s[44:45]
    s_cbranch_scc1 L_k2_fb
L_k2_out:
    v_pk_mul_f32 v[98:99], v[114:115], v[126:127] op_sel_hi:[1,0]
    v_pk_mul_f32 v[100:101], v[116:117], v[126:127] op_sel_hi:[1,0]
    v_pk_mul_f32 v[102:103], v[118:119], v[126:127] op_sel_hi:[1,0]
    v_pk_mul_f32 v[104:105], v[120:121], v[126:127] op_sel_hi:[1,0]
    v_pk_mul_f32 v[106:107], v[122:123], v[126:127] op_sel_hi:[1,0]
    s_cmp_lg_u32 s29, 0
    s_cbranch_scc1 L_k2_far
    v_cvt_pk_bf16_f32 v244, v82, v83
    v_cvt_pk_bf16_f32 v245, v84, v85
    v_cvt_pk_bf16_f32 v246, v86, v87
    v_cvt_pk_bf16_f32 v247, v88, v89
    v_cvt_pk_bf16_f32 v252, v90, v91
    buffer_store_dwordx4 v[244:247], v254, s[8:11], s26 offen offset:0
    v_cvt_pk_bf16_f32 v248, v98, v99
    v_cvt_pk_bf16_f32 v249, v100, v101
    v_cvt_pk_bf16_f32 v250, v102, v103
    v_cvt_pk_bf16_f32 v251, v104, v105
    v_cvt_pk_bf16_f32 v253, v106, v107
    buffer_store_dwordx4 v[248:251], v254, s[8:11], s26 offen offset:1024
    s_mov_b32 exec_hi, 0
    buffer_store_dword v252, v255, s[8:11], s27 offen offset:0
    buffer_store_dword v253, v255, s[8:11], s27 offen offset:8
    s_mov_b32 exec_hi, -1
L_k2_end:
    s_add_u32 s63, s33, 0x02864000
    buffer_load_dwordx4 v[108:111], v2, s[8:11], s63 offen offset:0 sc1
    buffer_load_dwordx4 v[112:115], v2, s[8:11], s63 offen offset:1024 sc1
    s_and_b32 s59, s2, 7
    s_lshl_b32 s56, s59, 2
    s_lshr_b32 s59, s2, 6
    s_add_u32 s56, s56, s59
    s_bfe_u32 s57, s2, 0x30003
    s_lshl_b32 s66, s56, 2
    s_add_u32 s66, s66, s32
    s_mul_i32 s58, s66, 18432
    s_add_u32 s61, s58, 0x02860000
    v_lshrrev_b32 v8, 4, v1
    v_accvgpr_read_b32 v106, a100
    v_accvgpr_read_b32 v88, a236
    v_accvgpr_read_b32 v89, a237
    v_accvgpr_read_b32 v90, a238
    v_accvgpr_read_b32 v91, a239
    v_accvgpr_read_b32 v92, a240
    v_accvgpr_read_b32 v93, a241
    v_accvgpr_read_b32 v94, a242
    v_accvgpr_read_b32 v95, a243
    v_accvgpr_read_b32 v96, a244
    v_accvgpr_read_b32 v97, a245
    v_accvgpr_read_b32 v98, a246
    v_accvgpr_read_b32 v99, a247
    v_accvgpr_read_b32 v100, a248
    v_accvgpr_read_b32 v101, a249
    v_accvgpr_read_b32 v102, a250
    v_accvgpr_read_b32 v103, a251
    v_accvgpr_read_b32 v104, a252
    v_accvgpr_read_b32 v105, a253
    v_and_b32 v4, 1, v8
    v_cmp_gt_u32 vcc, 32, v1
    v_mov_b32 v5, 0x3f800000
    v_mov_b32 v6, 0x3f80
    v_cndmask_b32 v107, v5, v6, vcc
    v_dot2_f32_bf16 v224, v88, v107, 0
    v_dot2_f32_bf16 v225, v92, v107, 0
    v_dot2_f32_bf16 v226, v96, v107, 0
    v_dot2_f32_bf16 v227, v100, v107, 0
    v_dot2_f32_bf16 v228, v89, v107, 0
    v_dot2_f32_bf16 v229, v93, v107, 0
    v_dot2_f32_bf16 v230, v97, v107, 0
    v_dot2_f32_bf16 v231, v101, v107, 0
    v_dot2_f32_bf16 v232, v90, v107, 0
    v_dot2_f32_bf16 v233, v94, v107, 0
    v_dot2_f32_bf16 v234, v98, v107, 0
    v_dot2_f32_bf16 v235, v102, v107, 0
    v_dot2_f32_bf16 v236, v91, v107, 0
    v_dot2_f32_bf16 v237, v95, v107, 0
    v_dot2_f32_bf16 v238, v99, v107, 0
    v_dot2_f32_bf16 v239, v103, v107, 0
    v_dot2_f32_bf16 v240, v104, v107, 0
    v_dot2_f32_bf16 v241, v105, v107, 0
    v_mov_b64 v[242:243], 0
    v_lshrrev_b32 v5, 5, v1
    v_lshlrev_b32 v5, 8, v5
    v_lshl_add_u32 v5, v4, 6, v5
    v_bfe_u32 v6, v1, 3, 1
    v_lshl_add_u32 v5, v6, 7, v5
    v_bfe_u32 v6, v1, 2, 1
    v_lshl_add_u32 v5, v6, 5, v5
    v_and_b32 v6, 1, v1
    v_lshl_add_u32 v5, v6, 4, v5
    v_lshlrev_b32 v6, 6, v6
    v_lshl_add_u32 v6, v8, 4, v6
    v_add_u32 v6, 512, v6
    s_mov_b32 s68, 0xcccccccc
    s_mov_b32 s69, 0xcccccccc
    v_cndmask_b32 v11, v5, v6, s[68:69]
    v_add_u32 v12, 42624, v2
    v_add_u32 v13, 42624, v11
    s_and_b32 s31, s2, 3
    s_lshr_b32 s30, s2, 4
    s_lshl_b32 s31, s31, 1
    s_bfe_u32 s33, s2, 0x00010003
    s_add_u32 s31, s31, s33
    s_bfe_u32 s33, s2, 0x00010002
    s_lshl_b32 s33, s33, 4
    s_add_u32 s30, s30, s33
    v_add_u32 v3, 4096, v2
    v_add_u32 v4, 8192, v2
    v_add_u32 v5, 12288, v2
    v_add_u32 v6, 16384, v2
    v_lshlrev_b32 v7, 2, v1
    s_lshl_b32 s33, s30, 2
    s_add_u32 s33, s33, s32
    s_mul_i32 s35, s33, 18432
    s_add_u32 s35, s35, 0x02600000
    s_lshl_b32 s42, s33, 10
    s_add_u32 s42, s42, 0x02840000
L_tp11:
    s_cbranch_execz L_tret
    s_mul_i32 s55, s32, 18432
    s_lshl_b32 s33, s31, 2
    s_add_u32 s33, s33, s32
    s_mul_i32 s36, s33, 331776
    s_add_u32 s36, s36, 0x00800000
    s_mov_b32 s51, s36
    s_add_u32 s37, s36, 18432
    s_mov_b32 s52, 65536
    s_mov_b32 s54, 0x7f817f81
    s_waitcnt vmcnt(6)
    s_barrier
    ds_read_b128 v[48:51], v12 offset:33152
    ds_read_b128 v[52:55], v12 offset:34176
    ds_read_b128 v[56:59], v12 offset:35200
    ds_read_b128 v[60:63], v12 offset:36224
    ds_read_b128 v[64:67], v13 offset:37248
    ds_read_b128 v[68:71], v12 offset:37888
    ds_read_b128 v[72:75], v12 offset:38912
    ds_read_b128 v[76:79], v12 offset:39936
    ds_read_b128 v[80:83], v12 offset:40960
    ds_read_b128 v[84:87], v13 offset:41984
    s_waitcnt vmcnt(0)
L_k3_pl:
    v_cmpx_ne_u32 vcc, s54, v108
    v_cmpx_ne_u32 vcc, s54, v109
    v_cmpx_ne_u32 vcc, s54, v110
    v_cmpx_ne_u32 vcc, s54, v111
    v_cmpx_ne_u32 vcc, s54, v112
    v_cmpx_ne_u32 vcc, s54, v113
    v_cmpx_ne_u32 vcc, s54, v114
    v_cmpx_ne_u32 vcc, s54, v115
    s_sub_u32 s52, s52, 1
    s_cmp_eq_u64 exec, -1
    s_mov_b64 exec, -1
    s_cbranch_scc1 L_k3_go
    buffer_load_dwordx4 v[108:111], v2, s[8:11], s63 offen offset:0 sc1
    buffer_load_dwordx4 v[112:115], v2, s[8:11], s63 offen offset:1024 sc1
    s_cmp_gt_i32 s52, 0
    s_waitcnt vmcnt(0)
    s_cbranch_scc1 L_k3_pl
L_k3_go:
    buffer_load_dwordx4 a[0:3], v2, s[8:11], s61 offen offset:0
    buffer_load_dwordx4 a[4:7], v2, s[8:11], s61 offen offset:1024
    buffer_load_dwordx4 a[8:11], v2, s[8:11], s61 offen offset:2048
    buffer_load_dwordx4 a[12:15], v2, s[8:11], s61 offen offset:3072
    s_add_u32 s61, s61, 4096
    buffer_load_dwordx4 a[16:19], v2, s[8:11], s61 offen offset:0
    buffer_load_dwordx4 a[20:23], v2, s[8:11], s61 offen offset:1024
    buffer_load_dwordx4 a[24:27], v2, s[8:11], s61 offen offset:2048
    buffer_load_dwordx4 a[28:31], v2, s[8:11], s61 offen offset:3072
    s_add_u32 s61, s61, 4096
    s_waitcnt lgkmcnt(9)
    v_mfma_f32_16x16x32_bf16 v[224:227], v[48:51], v[108:111], v[224:227]
L_tp12:
    s_cbranch_execz L_tret
    ds_read_b128 v[48:51], v2 offset:0
    buffer_load_dwordx4 a[32:35], v2, s[8:11], s61 offen offset:0
    s_waitcnt lgkmcnt(9)
    v_mfma_f32_16x16x32_bf16 v[228:231], v[52:55], v[108:111], v[228:231]
    ds_read_b128 v[52:55], v2 offset:1024
    s_waitcnt lgkmcnt(9)
    v_mfma_f32_16x16x32_bf16 v[232:235], v[56:59], v[108:111], v[232:235]
    ds_read_b128 v[56:59], v2 offset:2048
    s_waitcnt lgkmcnt(9)
    v_mfma_f32_16x16x32_bf16 v[236:239], v[60:63], v[108:111], v[236:239]
    ds_read_b128 v[60:63], v2 offset:3072
    s_waitcnt lgkmcnt(9)
    v_mfma_f32_16x16x32_bf16 v[240:243], v[64:67], v[108:111], v[240:243]
    ds_read_b128 v[64:67], v11 offset:4096
    buffer_load_dwordx4 a[36:39], v2, s[8:11], s61 offen offset:1024
    s_waitcnt lgkmcnt(9)
    v_mfma_f32_16x16x32_bf16 v[224:227], v[68:71], v[112:115], v[224:227]
    ds_read_b128 v[68:71], v2 offset:4736
    s_waitcnt lgkmcnt(9)
    v_mfma_f32_16x16x32_bf16 v[228:231], v[72:75], v[112:115], v[228:231]
    ds_read_b128 v[72:75], v2 offset:5760
    s_waitcnt lgkmcnt(9)
    v_mfma_f32_16x16x32_bf16 v[232:235], v[76:79], v[112:115], v[232:235]
    ds_read_b128 v[76:79], v2 offset:6784
    s_waitcnt lgkmcnt(9)
    v_mfma_f32_16x16x32_bf16 v[236:239], v[80:83], v[112:115], v[236:239]
    ds_read_b128 v[80:83], v2 offset:7808
    buffer_load_dwordx4 a[40:43], v2, s[8:11], s61 offen offset:2048
    s_waitcnt lgkmcnt(9)
    v_mfma_f32_16x16x32_bf16 v[240:243], v[84:87], v[112:115], v[240:243]
    ds_read_b128 v[84:87], v11 offset:8832
    s_waitcnt vmcnt(10) lgkmcnt(9)
    v_mfma_f32_16x16x32_bf16 v[224:227], v[48:51], a[0:3], v[224:227]
    ds_read_b128 v[48:51], v2 offset:9472
    s_waitcnt lgkmcnt(9)
    v_mfma_f32_16x16x32_bf16 v[228:231], v[52:55], a[0:3], v[228:231]
    ds_read_b128 v[52:55], v2 offset:10496
    s_waitcnt lgkmcnt(9)
    v_mfma_f32_16x16x32_bf16 v[232:235], v[56:59], a[0:3], v[232:235]
    ds_read_b128 v[56:59], v2 offset:11520
    buffer_load_dwordx4 a[44:47], v2, s[8:11], s61 offen offset:3072
    s_add_u32 s61, s61, 4096
    s_waitcnt lgkmcnt(9)
    v_mfma_f32_16x16x32_bf16 v[236:239], v[60:63], a[0:3], v[236:239]
    ds_read_b128 v[60:63], v2 offset:12544
    s_waitcnt lgkmcnt(9)
    v_mfma_f32_16x16x32_bf16 v[240:243], v[64:67], a[0:3], v[240:243]
    ds_read_b128 v[64:67], v11 offset:13568
    s_waitcnt vmcnt(10) lgkmcnt(9)
    v_mfma_f32_16x16x32_bf16 v[224:227], v[68:71], a[4:7], v[224:227]
    ds_read_b128 v[68:71], v2 offset:14208
    s_waitcnt lgkmcnt(9)
    v_mfma_f32_16x16x32_bf16 v[228:231], v[72:75], a[4:7], v[228:231]
    ds_read_b128 v[72:75], v2 offset:15232
    buffer_load_dwordx4 a[48:51], v2, s[8:11], s61 offen offset:0
    s_waitcnt lgkmcnt(9)
    v_mfma_f32_16x16x32_bf16 v[232:235], v[76:79], a[4:7], v[232:235]
    ds_read_b128 v[76:79], v2 offset:16256
    s_waitcnt lgkmcnt(9)
    v_mfma_f32_16x16x32_bf16 v[236:239], v[80:83], a[4:7], v[236:239]
    ds_read_b128 v[80:83], v2 offset:17280
    s_waitcnt lgkmcnt(9)
    v_mfma_f32_16x16x32_bf16 v[240:243], v[84:87], a[4:7], v[240:243]
    ds_read_b128 v[84:87], v11 offset:18304
    s_waitcnt vmcnt(10) lgkmcnt(9)
    v_mfma_f32_16x16x32_bf16 v[224:227], v[48:51], a[8:11], v[224:227]
    ds_read_b128 v[48:51], v2 offset:18944
    buffer_load_dwordx4 a[52:55], v2, s[8:11], s61 offen offset:1024
    s_waitcnt lgkmcnt(9)
    v_mfma_f32_16x16x32_bf16 v[228:231], v[52:55], a[8:11], v[228:231]
    ds_read_b128 v[52:55], v2 offset:19968
    s_waitcnt lgkmcnt(9)
    v_mfma_f32_16x16x32_bf16 v[232:235], v[56:59], a[8:11], v[232:235]
    ds_read_b128 v[56:59], v2 offset:20992
    s_waitcnt lgkmcnt(9)
    v_mfma_f32_16x16x32_bf16 v[236:239], v[60:63], a[8:11], v[236:239]
    ds_read_b128 v[60:63], v2 offset:22016
    s_waitcnt lgkmcnt(9)
    v_mfma_f32_16x16x32_bf16 v[240:243], v[64:67], a[8:11], v[240:243]
    ds_read_b128 v[64:67], v11 offset:23040
    buffer_load_dwordx4 a[56:59], v2, s[8:11], s61 offen offset:2048
    s_waitcnt vmcnt(11) lgkmcnt(9)
    v_mfma_f32_16x16x32_bf16 v[224:227], v[68:71], a[12:15], v[224:227]
    ds_read_b128 v[68:71], v2 offset:23680
    s_waitcnt lgkmcnt(9)
    v_mfma_f32_16x16x32_bf16 v[228:231], v[72:75], a[12:15], v[228:231]
    ds_read_b128 v[72:75], v2 offset:24704
    s_waitcnt lgkmcnt(9)
    v_mfma_f32_16x16x32_bf16 v[232:235], v[76:79], a[12:15], v[232:235]
    ds_read_b128 v[76:79], v2 offset:25728
    s_waitcnt lgkmcnt(9)
    v_mfma_f32_16x16x32_bf16 v[236:239], v[80:83], a[12:15], v[236:239]
    ds_read_b128 v[80:83], v2 offset:26752
    buffer_load_dwordx4 a[60:63], v2, s[8:11], s61 offen offset:3072
    s_add_u32 s61, s61, 4096
    s_waitcnt lgkmcnt(9)
    v_mfma_f32_16x16x32_bf16 v[240:243], v[84:87], a[12:15], v[240:243]
    ds_read_b128 v[84:87], v11 offset:27776
    s_waitcnt vmcnt(11) lgkmcnt(9)
    v_mfma_f32_16x16x32_bf16 v[224:227], v[48:51], a[16:19], v[224:227]
    ds_read_b128 v[48:51], v2 offset:28416
    s_waitcnt lgkmcnt(9)
    v_mfma_f32_16x16x32_bf16 v[228:231], v[52:55], a[16:19], v[228:231]
    ds_read_b128 v[52:55], v2 offset:29440
    s_waitcnt lgkmcnt(9)
    v_mfma_f32_16x16x32_bf16 v[232:235], v[56:59], a[16:19], v[232:235]
    ds_read_b128 v[56:59], v2 offset:30464
    s_waitcnt lgkmcnt(9)
    v_mfma_f32_16x16x32_bf16 v[236:239], v[60:63], a[16:19], v[236:239]
    ds_read_b128 v[60:63], v2 offset:31488
    s_waitcnt lgkmcnt(9)
    v_mfma_f32_16x16x32_bf16 v[240:243], v[64:67], a[16:19], v[240:243]
    ds_read_b128 v[64:67], v11 offset:32512
    s_waitcnt vmcnt(10) lgkmcnt(9)
    v_mfma_f32_16x16x32_bf16 v[224:227], v[68:71], a[20:23], v[224:227]
    ds_read_b128 v[68:71], v2 offset:33152
    s_waitcnt lgkmcnt(9)
    v_mfma_f32_16x16x32_bf16 v[228:231], v[72:75], a[20:23], v[228:231]
    ds_read_b128 v[72:75], v2 offset:34176
    s_waitcnt lgkmcnt(9)
    v_mfma_f32_16x16x32_bf16 v[232:235], v[76:79], a[20:23], v[232:235]
    ds_read_b128 v[76:79], v2 offset:35200
    s_waitcnt lgkmcnt(9)
    v_mfma_f32_16x16x32_bf16 v[236:239], v[80:83], a[20:23], v[236:239]
    ds_read_b128 v[80:83], v2 offset:36224
    buffer_load_dwordx4 a[236:239], v5, s[8:11], s36 offen offset:0
    s_waitcnt lgkmcnt(9)
    v_mfma_f32_16x16x32_bf16 v[240:243], v[84:87], a[20:23], v[240:243]
    ds_read_b128 v[84:87], v11 offset:37248
    s_waitcnt vmcnt(10) lgkmcnt(9)
    v_mfma_f32_16x16x32_bf16 v[224:227], v[48:51], a[24:27], v[224:227]
    ds_read_b128 v[48:51], v2 offset:37888
    s_waitcnt lgkmcnt(9)
    v_mfma_f32_16x16x32_bf16 v[228:231], v[52:55], a[24:27], v[228:231]
    ds_read_b128 v[52:55], v2 offset:38912
    s_waitcnt lgkmcnt(9)
    v_mfma_f32_16x16x32_bf16 v[232:235], v[56:59], a[24:27], v[232:235]
    ds_read_b128 v[56:59], v2 offset:39936
    buffer_load_dwordx4 a[240:243], v5, s[8:11], s36 offen offset:1024
    s_waitcnt lgkmcnt(9)
    v_mfma_f32_16x16x32_bf16 v[236:239], v[60:63], a[24:27], v[236:239]
    ds_read_b128 v[60:63], v2 offset:40960
    s_waitcnt lgkmcnt(9)
    v_mfma_f32_16x16x32_bf16 v[240:243], v[64:67], a[24:27], v[240:243]
    ds_read_b128 v[64:67], v11 offset:41984
    s_waitcnt vmcnt(10) lgkmcnt(9)
    v_mfma_f32_16x16x32_bf16 v[224:227], v[68:71], a[28:31], v[224:227]
    ds_read_b128 v[68:71], v12 offset:0
    s_waitcnt lgkmcnt(9)
    v_mfma_f32_16x16x32_bf16 v[228:231], v[72:75], a[28:31], v[228:231]
L_tp13:
    s_cbranch_execz L_tret
    ds_read_b128 v[72:75], v12 offset:1024
    buffer_load_dwordx4 a[244:247], v5, s[8:11], s36 offen offset:2048
    s_waitcnt lgkmcnt(9)
    v_mfma_f32_16x16x32_bf16 v[232:235], v[76:79], a[28:31], v[232:235]
    ds_read_b128 v[76:79], v12 offset:2048
    s_waitcnt lgkmcnt(9)
    v_mfma_f32_16x16x32_bf16 v[236:239], v[80:83], a[28:31], v[236:239]
    ds_read_b128 v[80:83], v12 offset:3072
    s_waitcnt lgkmcnt(9)
    v_mfma_f32_16x16x32_bf16 v[240:243], v[84:87], a[28:31], v[240:243]
    ds_read_b128 v[84:87], v13 offset:4096
    s_waitcnt vmcnt(10) lgkmcnt(9)
    v_mfma_f32_16x16x32_bf16 v[224:227], v[48:51], a[32:35], v[224:227]
    ds_read_b128 v[48:51], v12 offset:4736
    buffer_load_dwordx4 a[248:251], v5, s[8:11], s36 offen offset:3072
    s_waitcnt lgkmcnt(9)
    v_mfma_f32_16x16x32_bf16 v[228:231], v[52:55], a[32:35], v[228:231]
    ds_read_b128 v[52:55], v12 offset:5760
    s_waitcnt lgkmcnt(9)
    v_mfma_f32_16x16x32_bf16 v[232:235], v[56:59], a[32:35], v[232:235]
    ds_read_b128 v[56:59], v12 offset:6784
    s_waitcnt lgkmcnt(9)
    v_mfma_f32_16x16x32_bf16 v[236:239], v[60:63], a[32:35], v[236:239]
    ds_read_b128 v[60:63], v12 offset:7808
    s_waitcnt lgkmcnt(9)
    v_mfma_f32_16x16x32_bf16 v[240:243], v[64:67], a[32:35], v[240:243]
    ds_read_b128 v[64:67], v13 offset:8832
    buffer_load_dwordx4 a[252:255], v6, s[8:11], s36 offen offset:0
    s_add_u32 s36, s36, 36864
    s_waitcnt vmcnt(11) lgkmcnt(9)
    v_mfma_f32_16x16x32_bf16 v[224:227], v[68:71], a[36:39], v[224:227]
    ds_read_b128 v[68:71], v12 offset:9472
    s_waitcnt lgkmcnt(9)
    v_mfma_f32_16x16x32_bf16 v[228:231], v[72:75], a[36:39], v[228:231]
    ds_read_b128 v[72:75], v12 offset:10496
    s_waitcnt lgkmcnt(9)
    v_mfma_f32_16x16x32_bf16 v[232:235], v[76:79], a[36:39], v[232:235]
    ds_read_b128 v[76:79], v12 offset:11520
    s_waitcnt lgkmcnt(9)
    v_mfma_f32_16x16x32_bf16 v[236:239], v[80:83], a[36:39], v[236:239]
    ds_read_b128 v[80:83], v12 offset:12544
    buffer_load_dwordx4 v[180:183], v3, s[8:11], s37 offen offset:3072
    s_waitcnt lgkmcnt(9)
    v_mfma_f32_16x16x32_bf16 v[240:243], v[84:87], a[36:39], v[240:243]
    ds_read_b128 v[84:87], v13 offset:13568
    s_waitcnt vmcnt(11) lgkmcnt(9)
    v_mfma_f32_16x16x32_bf16 v[224:227], v[48:51], a[40:43], v[224:227]
    ds_read_b128 v[48:51], v12 offset:14208
    s_waitcnt lgkmcnt(9)
    v_mfma_f32_16x16x32_bf16 v[228:231], v[52:55], a[40:43], v[228:231]
    ds_read_b128 v[52:55], v12 offset:15232
    s_waitcnt lgkmcnt(9)
    v_mfma_f32_16x16x32_bf16 v[232:235], v[56:59], a[40:43], v[232:235]
    ds_read_b128 v[56:59], v12 offset:16256
    buffer_load_dwordx4 v[184:187], v4, s[8:11], s37 offen offset:0
    s_waitcnt lgkmcnt(9)
    v_mfma_f32_16x16x32_bf16 v[236:239], v[60:63], a[40:43], v[236:239]
    ds_read_b128 v[60:63], v12 offset:17280
    s_waitcnt lgkmcnt(9)
    v_mfma_f32_16x16x32_bf16 v[240:243], v[64:67], a[40:43], v[240:243]
    ds_read_b128 v[64:67], v13 offset:18304
    s_waitcnt vmcnt(11) lgkmcnt(9)
    v_mfma_f32_16x16x32_bf16 v[224:227], v[68:71], a[44:47], v[224:227]
    ds_read_b128 v[68:71], v12 offset:18944
    s_waitcnt lgkmcnt(9)
    v_mfma_f32_16x16x32_bf16 v[228:231], v[72:75], a[44:47], v[228:231]
    ds_read_b128 v[72:75], v12 offset:19968
    buffer_load_dwordx4 v[188:191], v4, s[8:11], s37 offen offset:1024
    s_waitcnt lgkmcnt(9)
    v_mfma_f32_16x16x32_bf16 v[232:235], v[76:79], a[44:47], v[232:235]
    ds_read_b128 v[76:79], v12 offset:20992
    s_waitcnt lgkmcnt(9)
    v_mfma_f32_16x16x32_bf16 v[236:239], v[80:83], a[44:47], v[236:239]
    ds_read_b128 v[80:83], v12 offset:22016
    s_waitcnt lgkmcnt(9)
    v_mfma_f32_16x16x32_bf16 v[240:243], v[84:87], a[44:47], v[240:243]
    ds_read_b128 v[84:87], v13 offset:23040
    s_waitcnt vmcnt(11) lgkmcnt(9)
    v_mfma_f32_16x16x32_bf16 v[224:227], v[48:51], a[48:51], v[224:227]
    ds_read_b128 v[48:51], v12 offset:23680
    s_waitcnt lgkmcnt(9)
    v_mfma_f32_16x16x32_bf16 v[228:231], v[52:55], a[48:51], v[228:231]
    ds_read_b128 v[52:55], v12 offset:24704
    s_waitcnt lgkmcnt(9)
    v_mfma_f32_16x16x32_bf16 v[232:235], v[56:59], a[48:51], v[232:235]
    ds_read_b128 v[56:59], v12 offset:25728
    s_waitcnt lgkmcnt(9)
    v_mfma_f32_16x16x32_bf16 v[236:239], v[60:63], a[48:51], v[236:239]
    ds_read_b128 v[60:63], v12 offset:26752
    s_waitcnt lgkmcnt(9)
    v_mfma_f32_16x16x32_bf16 v[240:243], v[64:67], a[48:51], v[240:243]
    ds_read_b128 v[64:67], v13 offset:27776
    s_waitcnt vmcnt(10) lgkmcnt(9)
    v_mfma_f32_16x16x32_bf16 v[224:227], v[68:71], a[52:55], v[224:227]
    ds_read_b128 v[68:71], v12 offset:28416
    s_waitcnt lgkmcnt(9)
    v_mfma_f32_16x16x32_bf16 v[228:231], v[72:75], a[52:55], v[228:231]
    ds_read_b128 v[72:75], v12 offset:29440
    s_waitcnt lgkmcnt(9)
    v_mfma_f32_16x16x32_bf16 v[232:235], v[76:79], a[52:55], v[232:235]
    ds_read_b128 v[76:79], v12 offset:30464
    s_waitcnt lgkmcnt(9)
    v_mfma_f32_16x16x32_bf16 v[236:239], v[80:83], a[52:55], v[236:239]
    ds_read_b128 v[80:83], v12 offset:31488
    s_waitcnt lgkmcnt(9)
    v_mfma_f32_16x16x32_bf16 v[240:243], v[84:87], a[52:55], v[240:243]
    ds_read_b128 v[84:87], v13 offset:32512
    s_waitcnt vmcnt(9) lgkmcnt(9)
    v_mfma_f32_16x16x32_bf16 v[224:227], v[48:51], a[56:59], v[224:227]
    s_waitcnt lgkmcnt(8)
    v_mfma_f32_16x16x32_bf16 v[228:231], v[52:55], a[56:59], v[228:231]
    s_waitcnt lgkmcnt(7)
    v_mfma_f32_16x16x32_bf16 v[232:235], v[56:59], a[56:59], v[232:235]
    s_waitcnt lgkmcnt(6)
    v_mfma_f32_16x16x32_bf16 v[236:239], v[60:63], a[56:59], v[236:239]
    s_waitcnt lgkmcnt(5)
    v_mfma_f32_16x16x32_bf16 v[240:243], v[64:67], a[56:59], v[240:243]
    s_lshl_b32 s59, s57, 11
    s_add_u32 s59, s59, s58
    s_add_u32 s59, s59, 0x02600000
    s_waitcnt vmcnt(8) lgkmcnt(4)
    v_mfma_f32_16x16x32_bf16 v[224:227], v[68:71], a[60:63], v[224:227]
    s_lshl_b32 s61, s57, 8
    s_add_u32 s61, s61, s58
    s_add_u32 s61, s61, 0x02604000
    s_waitcnt lgkmcnt(3)
    v_mfma_f32_16x16x32_bf16 v[228:231], v[72:75], a[60:63], v[228:231]
    s_waitcnt lgkmcnt(2)
    v_mfma_f32_16x16x32_bf16 v[232:235], v[76:79], a[60:63], v[232:235]
    s_lshl_b32 s62, s66, 10
    s_lshl_b32 s63, s57, 7
    s_add_u32 s62, s62, s63
    s_add_u32 s62, s62, 0x02840000
    s_waitcnt lgkmcnt(1)
    v_mfma_f32_16x16x32_bf16 v[236:239], v[80:83], a[60:63], v[236:239]
    s_mov_b32 s68, 0xffff0000
    s_waitcnt lgkmcnt(0)
    v_mfma_f32_16x16x32_bf16 v[240:243], v[84:87], a[60:63], v[240:243]
L_k3_ck:
    v_cmp_u_f32 vcc, v224, v224
    s_cbranch_vccnz L_k3_redo
L_k3_ok:
    s_nop 5
    v_sub_f32 v106, v106, v242
    v_sub_f32 v106, v106, v243
    v_pk_add_f32 v[224:225], v[224:225], v[106:107] op_sel_hi:[1,0]
    v_pk_add_f32 v[226:227], v[226:227], v[106:107] op_sel_hi:[1,0]
    v_cvt_pk_bf16_f32 v48, v224, v225
    v_pk_add_f32 v[228:229], v[228:229], v[106:107] op_sel_hi:[1,0]
    v_cvt_pk_bf16_f32 v49, v226, v227
    v_pk_add_f32 v[230:231], v[230:231], v[106:107] op_sel_hi:[1,0]
    v_cvt_pk_bf16_f32 v50, v228, v229
    v_pk_add_f32 v[232:233], v[232:233], v[106:107] op_sel_hi:[1,0]
    v_cvt_pk_bf16_f32 v51, v230, v231
    buffer_store_dwordx4 v[48:51], v2, s[8:11], s59 offen offset:0 sc1
    v_pk_add_f32 v[234:235], v[234:235], v[106:107] op_sel_hi:[1,0]
    v_cvt_pk_bf16_f32 v52, v232, v233
L_tp14:
    s_cbranch_execz L_tret
    v_pk_add_f32 v[236:237], v[236:237], v[106:107] op_sel_hi:[1,0]
    v_cvt_pk_bf16_f32 v53, v234, v235
    v_pk_add_f32 v[238:239], v[238:239], v[106:107] op_sel_hi:[1,0]
    v_cvt_pk_bf16_f32 v54, v236, v237
    v_pk_add_f32 v[240:241], v[240:241], v[106:107] op_sel_hi:[1,0]
    v_cvt_pk_bf16_f32 v55, v238, v239
    buffer_store_dwordx4 v[52:55], v2, s[8:11], s59 offen offset:1024 sc1
    v_cvt_pk_bf16_f32 v56, v240, v241
    v_pk_mul_f32 v[88:89], v[224:225], v[224:225]
    buffer_store_dword v56, v7, s[8:11], s61 offen sc1
    v_pk_mul_f32 v[90:91], v[226:227], v[226:227]
    v_pk_fma_f32 v[88:89], v[228:229], v[228:229], v[88:89]
    v_pk_fma_f32 v[90:91], v[230:231], v[230:231], v[90:91]
    v_pk_fma_f32 v[88:89], v[232:233], v[232:233], v[88:89]
    v_pk_fma_f32 v[90:91], v[234:235], v[234:235], v[90:91]
    v_pk_fma_f32 v[88:89], v[236:237], v[236:237], v[88:89]
    v_pk_fma_f32 v[90:91], v[238:239], v[238:239], v[90:91]
    v_pk_fma_f32 v[88:89], v[240:241], v[240:241], v[88:89]
    v_mul_f32 v106, -1.0, v106
    v_pk_add_f32 v[88:89], v[88:89], v[90:91]
    v_add_f32 v88, v88, v89
    v_mov_b32 v89, v88
    s_nop 1
    v_permlane32_swap_b32 v88, v89
    v_add_f32 v88, v88, v89
    v_mov_b32 v89, v88
    s_nop 1
    v_permlane16_swap_b32 v88, v89
    v_add_f32 v88, v88, v89
    v_cndmask_b32 v88, v88, v106, s[68:69]
    s_mov_b32 exec_hi, 0
    buffer_store_dword v88, v7, s[8:11], s62 offen sc1
    s_mov_b32 exec_hi, -1
    buffer_load_dwordx4 v[192:195], v4, s[8:11], s37 offen offset:2048
    buffer_load_dwordx4 v[196:199], v4, s[8:11], s37 offen offset:3072
    buffer_load_dwordx4 v[200:203], v5, s[8:11], s37 offen offset:0
    buffer_load_dwordx4 v[204:207], v5, s[8:11], s37 offen offset:1024
    buffer_load_dwordx4 v[208:211], v5, s[8:11], s37 offen offset:2048
    buffer_load_dwordx4 v[212:215], v5, s[8:11], s37 offen offset:3072
    buffer_load_dwordx4 v[216:219], v6, s[8:11], s37 offen offset:0
    buffer_load_dwordx4 v[220:223], v6, s[8:11], s37 offen offset:1024
    s_add_u32 s37, s37, 36864
    s_lshl_b32 s48, s32, 12
    s_add_u32 m0, s48, 131072
    s_add_u32 s38, s51, 321536
    s_barrier
    buffer_load_dwordx4 v[16:19], v2, s[8:11], s42 offen sc1
    buffer_load_dwordx4 v2, s[8:11], s38 offen offset:0 lds
    v_add_u32 v7, 16384, v7
    v_add_u32 v8, 0, v2
    v_add_u32 v10, 36864, v2
    v_add_u32 v40, s48, v2
    s_mul_i32 s40, s31, 2359296
    buffer_load_dwordx4 v2, s[8:11], s38 offen offset:1024 lds
    s_mul_i32 s43, s30, 73728
    s_add_u32 s43, s43, 0x01400000
    s_add_u32 s41, s40, s43
    s_lshl_b32 s33, s32, 11
    s_add_u32 s40, s41, s33
    buffer_load_dwordx4 v2, s[8:11], s38 offen offset:2048 lds
    s_add_u32 s44, s43, s33
    s_lshr_b32 s33, s32, 1
    s_lshl_b32 s33, s33, 10
    s_and_b32 s34, s32, 1
    s_lshl_b32 s34, s34, 3
    buffer_load_dwordx4 v2, s[8:11], s38 offen offset:3072 lds
    s_add_u32 m0, m0, 4096
    s_add_u32 s33, s33, s34
    s_lshl_b32 s34, s31, 11
    s_add_u32 s34, s34, s33
    v_add_u32 v38, s34, v2
    s_add_u32 s33, s33, 16384
    v_add_u32 v41, s33, v2
    s_mov_b32 s14, 0x00240000
    s_mov_b32 s15, 0x00020000
    s_lshl_b32 s33, s32, 6
    s_add_u32 s33, s33, 57344
    s_add_u32 s41, s41, s33
    v_bfe_u32 v36, v1, 1, 3
    v_lshlrev_b32 v46, 4, v36
    v_lshlrev_b32 v36, 8, v36
    v_and_b32 v37, 48, v1
    v_add_u32 v36, v36, v37
    v_lshl_add_u32 v46, v37, 4, v46
    v_and_b32 v39, 1, v1
    v_lshl_add_u32 v36, v39, 3, v36
    v_lshl_add_u32 v46, v39, 7, v46
    v_lshlrev_b32 v45, 7, v39
    s_add_u32 s33, s48, 86016
    v_add_u32 v46, s33, v46
    v_mul_u32_u24 v37, 147456, v37
    v_lshl_add_u32 v39, v39, 5, v37
    v_bfe_u32 v37, v1, 3, 1
    v_lshl_add_u32 v39, v37, 4, v39
    v_lshl_add_u32 v45, v37, 6, v45
    v_bfe_u32 v37, v1, 1, 2
    v_lshl_add_u32 v39, v37, 6, v39
    v_lshl_add_u32 v45, v37, 9, v45
    s_lshr_b32 s47, s31, 1
    s_and_b32 s34, s31, 1
    s_lshl_b32 s34, s34, 2
    s_add_u32 s34, s34, s32
    s_mul_i32 s33, s47, 18432
    s_lshl_b32 s53, s34, 3
    s_add_u32 s33, s33, s53
    s_add_u32 s33, s33, 16384
    v_add_u32 v45, s33, v45
    s_lshl_b32 s34, s34, 8
    s_lshl_b32 s33, s47, 11
    s_add_u32 s53, s43, s34
    s_add_u32 s53, s53, s33
    s_add_u32 s53, s53, 57344
    s_add_u32 s45, s53, 9437184
    s_mul_i32 s33, s32, 3072
    s_add_u32 s33, s33, 73728
    v_add_u32 v44, s33, v2
    s_xor_b32 s33, s31, 7
    s_mul_i32 s33, s33, 2359296
    s_add_u32 s56, s33, s44
    s_add_u32 s44, s44, 8192
    s_xor_b32 s33, s31, 6
    s_mul_i32 s33, s33, 2359296
    s_add_u32 s57, s33, s44
    s_add_u32 s44, s44, 8192
    s_xor_b32 s33, s31, 5
    s_mul_i32 s33, s33, 2359296
    s_add_u32 s58, s33, s44
    s_add_u32 s44, s44, 8192
    s_xor_b32 s33, s31, 4
    s_mul_i32 s33, s33, 2359296
    s_add_u32 s59, s33, s44
    s_add_u32 s44, s44, 8192
    s_xor_b32 s33, s31, 3
    s_mul_i32 s33, s33, 2359296
    s_add_u32 s60, s33, s44
    s_add_u32 s44, s44, 8192
    s_xor_b32 s33, s31, 2
    s_mul_i32 s33, s33, 2359296
    s_add_u32 s61, s33, s44
    s_add_u32 s44, s44, 8192
    s_xor_b32 s33, s31, 1
    s_mul_i32 s33, s33, 2359296
    s_add_u32 s62, s33, s44
    s_lshl_b32 s33, s30, 3
    s_add_u32 s33, s33, s31
    s_mul_i32 s50, s33, 9216
    s_mul_i32 s33, s32, 2304
    s_add_u32 s50, s50, s33
    s_lshl_b32 s33, s31, 7
    s_add_u32 s49, s35, s33
    s_sub_u32 s49, s49, 0x02600000
    s_add_u32 s46, s49, 9216
    v_and_b32 v12, 15, v1
    v_lshlrev_b32 v12, 2, v12
    v_add_u32 v12, 147456, v12
    v_mov_b32 v20, 0x3727c5ac
    v_and_b32 v21, 7, v1
    v_lshlrev_b32 v21, 4, v21
    v_bfe_u32 v22, v1, 4, 1
    v_lshl_add_u32 v21, v22, 3, v21
    v_lshrrev_b32 v22, 5, v1
    v_lshl_add_u32 v21, v22, 2, v21
    s_lshl_b32 s33, s32, 7
    s_add_u32 s33, s33, 147456
    v_add_u32 v21, s33, v21
    s_mov_b32 s68, 0x0f0f0f0f
L_tp15:
    s_cbranch_execz L_tret
    s_mov_b32 s69, 0x0f0f0f0f
    s_lshl_b32 s38, s32, 10
    s_sub_u32 s38, 32768, s38
    s_mov_b32 m0, s55
    s_waitcnt vmcnt(4)
L_k4_pl:
    v_cmpx_ne_u32 vcc, s54, v16
    v_cmpx_ne_u32 vcc, s54, v17
    v_cmpx_ne_u32 vcc, s54, v18
    v_cmpx_ne_u32 vcc, s54, v19
    s_sub_u32 s52, s52, 1
    s_cmp_eq_u64 exec, -1
    s_mov_b64 exec, -1
    s_cbranch_scc1 L_k4_go
    buffer_load_dwordx4 v[16:19], v2, s[8:11], s42 offen sc1
    s_cmp_gt_i32 s52, 0
    s_waitcnt vmcnt(0)
    s_cbranch_scc1 L_k4_pl
L_k4_go:
    buffer_load_dwordx4 v2, s[8:11], s35 offen offset:0 lds
    buffer_load_dwordx4 v2, s[8:11], s35 offen offset:1024 lds
    buffer_load_dwordx4 v2, s[8:11], s35 offen offset:2048 lds
    buffer_load_dwordx4 v2, s[8:11], s35 offen offset:3072 lds
    s_add_u32 m0, m0, 4096
    s_nop 0
    buffer_load_dwordx4 v3, s[8:11], s35 offen offset:0 lds
    buffer_load_dwordx4 v3, s[8:11], s35 offen offset:1024 lds
    buffer_load_dwordx4 v3, s[8:11], s35 offen offset:2048 lds
    buffer_load_dwordx4 v3, s[8:11], s35 offen offset:3072 lds
    s_add_u32 m0, m0, 4096
    v_permlane32_swap_b32 v16, v17
    v_permlane32_swap_b32 v18, v19
    v_add_f32 v16, v16, v17
    v_add_f32 v18, v18, v19
    s_nop 1
    v_permlane16_swap_b32 v16, v18
    v_add_f32 v16, v16, v18
    s_nop 1
    v_add_f32_dpp v16, v16, v16 row_ror:8 row_mask:0xf bank_mask:0xf
    v_fmac_f32 v20, 0x3ae38e39, v16
    v_mul_f32 v16, 0.125, v16
    v_rsq_f32 v20, v20
    s_nop 0
    v_mul_f32 v20, 0xbfb8aa3b, v20
    v_cndmask_b32 v16, v16, v20, s[68:69]
    ds_write_b32 v21, v16
    buffer_load_dwordx4 v4, s[8:11], s35 offen offset:0 lds
    buffer_load_dwordx4 v4, s[8:11], s35 offen offset:1024 lds
    buffer_load_dwordx4 v4, s[8:11], s35 offen offset:2048 lds
    buffer_load_dwordx4 v4, s[8:11], s35 offen offset:3072 lds
    s_add_u32 m0, m0, 4096
    s_waitcnt lgkmcnt(0) vmcnt(6)
    s_barrier
    ds_read_b128 a[0:3], v8 offset:0
    ds_read_b128 a[4:7], v8 offset:18432
    ds_read_b128 a[8:11], v10 offset:0
    ds_read_b128 a[12:15], v10 offset:18432
    ds_read_b128 a[16:19], v8 offset:1024
    ds_read_b128 a[20:23], v8 offset:19456
    ds_read_b128 a[24:27], v10 offset:1024
    ds_read_b128 a[28:31], v10 offset:19456
    ds_read_b128 a[32:35], v8 offset:2048
    ds_read_b128 a[36:39], v8 offset:20480
    ds_read_b128 a[40:43], v10 offset:2048
    ds_read_b128 a[44:47], v10 offset:20480
    s_waitcnt lgkmcnt(11)
    v_mfma_f32_16x16x32_bf16 v[224:227], a[188:191], a[0:3], 0
    s_waitcnt lgkmcnt(10)
    ds_read_b128 a[48:51], v8 offset:3072
    buffer_load_dwordx4 v5, s[8:11], s35 offen offset:0 lds
    v_mfma_f32_16x16x32_bf16 v[228:231], a[188:191], a[4:7], 0
    s_waitcnt lgkmcnt(10)
    ds_read_b128 a[52:55], v8 offset:21504
    buffer_load_dwordx4 v5, s[8:11], s35 offen offset:1024 lds
    v_mfma_f32_16x16x32_bf16 v[232:235], a[188:191], a[8:11], 0
    s_waitcnt lgkmcnt(10)
    ds_read_b128 a[56:59], v10 offset:3072
    buffer_load_dwordx4 v5, s[8:11], s35 offen offset:2048 lds
    v_mfma_f32_16x16x32_bf16 v[236:239], a[188:191], a[12:15], 0
    s_waitcnt lgkmcnt(10)
    ds_read_b128 a[60:63], v10 offset:21504
    buffer_load_dwordx4 v5, s[8:11], s35 offen offset:3072 lds
    s_add_u32 m0, m0, 4096
    v_mfma_f32_16x16x32_bf16 v[224:227], a[192:195], a[16:19], v[224:227]
    s_waitcnt lgkmcnt(10)
    ds_read_b128 a[64:67], v8 offset:4096
    buffer_load_dwordx4 v6, s[8:11], s35 offen offset:0 lds
    v_mfma_f32_16x16x32_bf16 v[228:231], a[192:195], a[20:23], v[228:231]
    s_waitcnt lgkmcnt(10)
    ds_read_b128 a[68:71], v8 offset:22528
    buffer_load_dwordx4 v6, s[8:11], s35 offen offset:1024 lds
    v_mfma_f32_16x16x32_bf16 v[232:235], a[192:195], a[24:27], v[232:235]
    s_waitcnt lgkmcnt(10)
    ds_read_b128 a[72:75], v10 offset:4096
    v_mfma_f32_16x16x32_bf16 v[236:239], a[192:195], a[28:31], v[236:239]
    s_waitcnt lgkmcnt(10)
    ds_read_b128 a[76:79], v10 offset:22528
    buffer_load_dwordx4 a[188:191], v2, s[8:11], s36 offen offset:0
    v_mfma_f32_16x16x32_bf16 v[224:227], a[196:199], a[32:35], v[224:227]
    s_waitcnt lgkmcnt(10)
    ds_read_b128 a[80:83], v8 offset:5120
    v_mfma_f32_16x16x32_bf16 v[228:231], a[196:199], a[36:39], v[228:231]
    s_waitcnt lgkmcnt(10)
    ds_read_b128 a[84:87], v8 offset:23552
    v_mfma_f32_16x16x32_bf16 v[232:235], a[196:199], a[40:43], v[232:235]
    s_waitcnt lgkmcnt(10)
    ds_read_b128 a[88:91], v10 offset:5120
    v_mfma_f32_16x16x32_bf16 v[236:239], a[196:199], a[44:47], v[236:239]
    s_waitcnt lgkmcnt(10)
    ds_read_b128 a[92:95], v10 offset:23552
    buffer_load_dwordx4 a[192:195], v2, s[8:11], s36 offen offset:1024
    v_mfma_f32_16x16x32_bf16 v[224:227], a[200:203], a[48:51], v[224:227]
    s_waitcnt lgkmcnt(10) vmcnt(8)
    s_barrier
    ds_read_b128 a[96:99], v8 offset:6144
    v_mfma_f32_16x16x32_bf16 v[228:231], a[200:203], a[52:55], v[228:231]
    s_waitcnt lgkmcnt(10)
    ds_read_b128 a[100:103], v8 offset:24576
    v_mfma_f32_16x16x32_bf16 v[232:235], a[200:203], a[56:59], v[232:235]
    s_waitcnt lgkmcnt(10)
    ds_read_b128 a[104:107], v10 offset:6144
    v_mfma_f32_16x16x32_bf16 v[236:239], a[200:203], a[60:63], v[236:239]
    s_waitcnt lgkmcnt(10)
    ds_read_b128 a[108:111], v10 offset:24576
    buffer_load_dwordx4 a[196:199], v2, s[8:11], s36 offen offset:2048
    v_mfma_f32_16x16x32_bf16 v[224:227], a[204:207], a[64:67], v[224:227]
    s_waitcnt lgkmcnt(10)
    ds_read_b128 a[112:115], v8 offset:7168
    v_mfma_f32_16x16x32_bf16 v[228:231], a[204:207], a[68:71], v[228:231]
    s_waitcnt lgkmcnt(10)
    ds_read_b128 a[116:119], v8 offset:25600
    v_mfma_f32_16x16x32_bf16 v[232:235], a[204:207], a[72:75], v[232:235]
    s_waitcnt lgkmcnt(10)
    ds_read_b128 a[120:123], v10 offset:7168
    v_mfma_f32_16x16x32_bf16 v[236:239], a[204:207], a[76:79], v[236:239]
    s_waitcnt lgkmcnt(10)
    ds_read_b128 a[124:127], v10 offset:25600
    buffer_load_dwordx4 a[200:203], v2, s[8:11], s36 offen offset:3072
    v_mfma_f32_16x16x32_bf16 v[224:227], a[208:211], a[80:83], v[224:227]
    s_waitcnt lgkmcnt(10)
    ds_read_b128 a[128:131], v8 offset:8192
    v_mfma_f32_16x16x32_bf16 v[228:231], a[208:211], a[84:87], v[228:231]
    s_waitcnt lgkmcnt(10)
    ds_read_b128 a[132:135], v8 offset:26624
    v_mfma_f32_16x16x32_bf16 v[232:235], a[208:211], a[88:91], v[232:235]
    s_waitcnt lgkmcnt(10)
    ds_read_b128 a[136:139], v10 offset:8192
    v_mfma_f32_16x16x32_bf16 v[236:239], a[208:211], a[92:95], v[236:239]
    s_waitcnt lgkmcnt(10)
    ds_read_b128 a[140:143], v10 offset:26624
    buffer_load_dwordx4 a[204:207], v3, s[8:11], s36 offen offset:0
    v_mfma_f32_16x16x32_bf16 v[224:227], a[212:215], a[96:99], v[224:227]
    s_waitcnt lgkmcnt(10)
    ds_read_b128 a[144:147], v8 offset:9216
    v_mfma_f32_16x16x32_bf16 v[228:231], a[212:215], a[100:103], v[228:231]
    s_waitcnt lgkmcnt(10)
    ds_read_b128 a[148:151], v8 offset:27648
L_tp16:
    s_cbranch_execz L_tret
    v_mfma_f32_16x16x32_bf16 v[232:235], a[212:215], a[104:107], v[232:235]
    s_waitcnt lgkmcnt(10)
    ds_read_b128 a[152:155], v10 offset:9216
    v_mfma_f32_16x16x32_bf16 v[236:239], a[212:215], a[108:111], v[236:239]
    s_waitcnt lgkmcnt(10)
    ds_read_b128 a[156:159], v10 offset:27648
    buffer_load_dwordx4 a[208:211], v3, s[8:11], s36 offen offset:1024
    v_mfma_f32_16x16x32_bf16 v[224:227], a[216:219], a[112:115], v[224:227]
    s_waitcnt lgkmcnt(10)
    ds_read_b128 a[160:163], v8 offset:10240
    v_mfma_f32_16x16x32_bf16 v[228:231], a[216:219], a[116:119], v[228:231]
    s_waitcnt lgkmcnt(10)
    ds_read_b128 a[164:167], v8 offset:28672
    v_mfma_f32_16x16x32_bf16 v[232:235], a[216:219], a[120:123], v[232:235]
    s_waitcnt lgkmcnt(10)
    ds_read_b128 a[168:171], v10 offset:10240
    v_mfma_f32_16x16x32_bf16 v[236:239], a[216:219], a[124:127], v[236:239]
    s_waitcnt lgkmcnt(10)
    ds_read_b128 a[172:175], v10 offset:28672
    buffer_load_dwordx4 a[212:215], v3, s[8:11], s36 offen offset:2048
    v_mfma_f32_16x16x32_bf16 v[224:227], a[220:223], a[128:131], v[224:227]
    s_waitcnt lgkmcnt(10)
    ds_read_b128 a[176:179], v8 offset:11264
    v_mfma_f32_16x16x32_bf16 v[228:231], a[220:223], a[132:135], v[228:231]
    s_waitcnt lgkmcnt(10)
    ds_read_b128 a[180:183], v8 offset:29696
    v_mfma_f32_16x16x32_bf16 v[232:235], a[220:223], a[136:139], v[232:235]
    s_waitcnt lgkmcnt(10)
    ds_read_b128 a[184:187], v10 offset:11264
    v_mfma_f32_16x16x32_bf16 v[236:239], a[220:223], a[140:143], v[236:239]
    s_waitcnt lgkmcnt(10)
    ds_read_b128 v[48:51], v10 offset:29696
    buffer_load_dwordx4 a[216:219], v3, s[8:11], s36 offen offset:3072
    v_mfma_f32_16x16x32_bf16 v[224:227], a[224:227], a[144:147], v[224:227]
    s_waitcnt lgkmcnt(10) vmcnt(8)
    s_barrier
    ds_read_b128 v[52:55], v8 offset:12288
    v_mfma_f32_16x16x32_bf16 v[228:231], a[224:227], a[148:151], v[228:231]
    s_waitcnt lgkmcnt(10)
    ds_read_b128 v[56:59], v8 offset:30720
    v_mfma_f32_16x16x32_bf16 v[232:235], a[224:227], a[152:155], v[232:235]
    s_waitcnt lgkmcnt(10)
    ds_read_b128 v[60:63], v10 offset:12288
    v_mfma_f32_16x16x32_bf16 v[236:239], a[224:227], a[156:159], v[236:239]
    s_waitcnt lgkmcnt(10)
    ds_read_b128 v[64:67], v10 offset:30720
    buffer_load_dwordx4 a[220:223], v4, s[8:11], s36 offen offset:0
    v_mfma_f32_16x16x32_bf16 v[224:227], a[228:231], a[160:163], v[224:227]
    s_waitcnt lgkmcnt(10)
    ds_read_b128 v[68:71], v8 offset:13312
    v_mfma_f32_16x16x32_bf16 v[228:231], a[228:231], a[164:167], v[228:231]
    s_waitcnt lgkmcnt(10)
    ds_read_b128 v[72:75], v8 offset:31744
    v_mfma_f32_16x16x32_bf16 v[232:235], a[228:231], a[168:171], v[232:235]
    s_waitcnt lgkmcnt(10)
    ds_read_b128 v[76:79], v10 offset:13312
    v_mfma_f32_16x16x32_bf16 v[236:239], a[228:231], a[172:175], v[236:239]
    s_waitcnt lgkmcnt(10)
    ds_read_b128 v[80:83], v10 offset:31744
    buffer_load_dwordx4 a[224:227], v4, s[8:11], s36 offen offset:1024
    v_mfma_f32_16x16x32_bf16 v[224:227], a[232:235], a[176:179], v[224:227]
    s_waitcnt lgkmcnt(10)
    ds_read_b128 v[84:87], v8 offset:14336
    v_mfma_f32_16x16x32_bf16 v[228:231], a[232:235], a[180:183], v[228:231]
    s_waitcnt lgkmcnt(10)
    ds_read_b128 v[88:91], v8 offset:32768
    v_mfma_f32_16x16x32_bf16 v[232:235], a[232:235], a[184:187], v[232:235]
    s_waitcnt lgkmcnt(10)
    ds_read_b128 v[92:95], v10 offset:14336
    v_mfma_f32_16x16x32_bf16 v[236:239], a[232:235], v[48:51], v[236:239]
    s_waitcnt lgkmcnt(10)
    ds_read_b128 v[96:99], v10 offset:32768
    buffer_load_dwordx4 a[228:231], v4, s[8:11], s36 offen offset:2048
    v_mfma_f32_16x16x32_bf16 v[224:227], a[236:239], v[52:55], v[224:227]
    s_waitcnt lgkmcnt(10)
    ds_read_b128 v[100:103], v8 offset:15360
    v_mfma_f32_16x16x32_bf16 v[228:231], a[236:239], v[56:59], v[228:231]
    s_waitcnt lgkmcnt(10)
    ds_read_b128 v[104:107], v8 offset:33792
    v_mfma_f32_16x16x32_bf16 v[232:235], a[236:239], v[60:63], v[232:235]
    s_waitcnt lgkmcnt(10)
    ds_read_b128 v[108:111], v10 offset:15360
    ds_read_b64 v[16:17], v38 offset:0
    v_mfma_f32_16x16x32_bf16 v[236:239], a[236:239], v[64:67], v[236:239]
    s_waitcnt lgkmcnt(11)
    ds_read_b128 v[112:115], v10 offset:33792
    buffer_load_dwordx4 a[232:235], v4, s[8:11], s36 offen offset:3072
    ds_read_b64 v[18:19], v38 offset:18432
    v_mfma_f32_16x16x32_bf16 v[224:227], a[240:243], v[68:71], v[224:227]
    s_waitcnt lgkmcnt(12)
    ds_read2st64_b32 v[116:117], v7 offset0:0 offset1:1
    ds_read2st64_b32 v[118:119], v7 offset0:2 offset1:3
    ds_read_b64 v[20:21], v38 offset:36864
    v_mfma_f32_16x16x32_bf16 v[228:231], a[240:243], v[72:75], v[228:231]
    s_waitcnt lgkmcnt(14)
    ds_read2st64_b32 v[120:121], v7 offset0:72 offset1:73
    ds_read2st64_b32 v[122:123], v7 offset0:74 offset1:75
    ds_read_b64 v[22:23], v38 offset:55296
    v_mfma_f32_16x16x32_bf16 v[232:235], a[240:243], v[76:79], v[232:235]
    s_waitcnt lgkmcnt(15)
    ds_read2st64_b32 v[124:125], v7 offset0:144 offset1:145
    ds_read2st64_b32 v[126:127], v7 offset0:146 offset1:147
    ds_read2_b32 v[24:25], v45 offset1:64
    v_mfma_f32_16x16x32_bf16 v[236:239], a[240:243], v[80:83], v[236:239]
    ds_read2st64_b32 v[128:129], v7 offset0:216 offset1:217
    ds_read2st64_b32 v[130:131], v7 offset0:218 offset1:219
    buffer_load_dwordx4 a[236:239], v5, s[8:11], s36 offen offset:0
    ds_read2_b32 v[26:27], v45 offset0:1 offset1:65
    v_mfma_f32_16x16x32_bf16 v[224:227], a[244:247], v[84:87], v[224:227]
    s_waitcnt lgkmcnt(15)
    ds_read2st64_b32 v[132:133], v7 offset0:4 offset1:5
    ds_read2st64_b32 v[134:135], v7 offset0:6 offset1:7
    v_mfma_f32_16x16x32_bf16 v[228:231], a[244:247], v[88:91], v[228:231]
    ds_read2st64_b32 v[136:137], v7 offset0:76 offset1:77
    ds_read2st64_b32 v[138:139], v7 offset0:78 offset1:79
    v_mfma_f32_16x16x32_bf16 v[232:235], a[244:247], v[92:95], v[232:235]
    ds_read2st64_b32 v[140:141], v7 offset0:148 offset1:149
    ds_read2st64_b32 v[142:143], v7 offset0:150 offset1:151
    v_mfma_f32_16x16x32_bf16 v[236:239], a[244:247], v[96:99], v[236:239]
    ds_read2st64_b32 v[144:145], v7 offset0:220 offset1:221
    ds_read2st64_b32 v[146:147], v7 offset0:222 offset1:223
    buffer_load_dwordx4 a[240:243], v5, s[8:11], s36 offen offset:1024
    v_mfma_f32_16x16x32_bf16 v[224:227], a[248:251], v[100:103], v[224:227]
    v_mfma_f32_16x16x32_bf16 v[228:231], a[248:251], v[104:107], v[228:231]
    ds_read2_b32 v[14:15], v12 offset0:64 offset1:96
    v_mfma_f32_16x16x32_bf16 v[232:235], a[248:251], v[108:111], v[232:235]
    s_waitcnt lgkmcnt(15)
    ds_read2_b32 v[12:13], v12 offset1:32
    v_mfma_f32_16x16x32_bf16 v[236:239], a[248:251], v[112:115], v[236:239]
    buffer_load_dwordx4 a[244:247], v5, s[8:11], s36 offen offset:2048
    v_mfma_f32_16x16x32_bf16 v[224:227], a[252:255], v[116:119], v[224:227]
    s_waitcnt lgkmcnt(10)
    ds_write_b128 v44, v[16:19] offset:0
    v_mfma_f32_16x16x32_bf16 v[228:231], a[252:255], v[120:123], v[228:231]
    v_mfma_f32_16x16x32_bf16 v[232:235], a[252:255], v[124:127], v[232:235]
    ds_write_b128 v44, v[20:23] offset:1024
    v_mfma_f32_16x16x32_bf16 v[236:239], a[252:255], v[128:131], v[236:239]
    s_waitcnt lgkmcnt(10)
    buffer_load_dwordx4 a[248:251], v5, s[8:11], s36 offen offset:3072
    v_mfma_f32_16x16x32_bf16 v[224:227], v[148:151], v[132:135], v[224:227]
    s_waitcnt lgkmcnt(8)
    ds_write_b128 v44, v[24:27] offset:2048
    v_mfma_f32_16x16x32_bf16 v[228:231], v[148:151], v[136:139], v[228:231]
    s_waitcnt lgkmcnt(7)
    v_mfma_f32_16x16x32_bf16 v[232:235], v[148:151], v[140:143], v[232:235]
    s_waitcnt lgkmcnt(5) vmcnt(63)
L_tp17:
    s_cbranch_execz L_tret
    v_mfma_f32_16x16x32_bf16 v[236:239], v[148:151], v[144:147], v[236:239]
    buffer_load_dwordx4 a[252:255], v6, s[8:11], s36 offen offset:0
    s_waitcnt lgkmcnt(3)
    s_nop 1
    v_cmp_u_f32 s[68:69], v224, v228
    s_nop 2
    v_cmp_u_f32 vcc, v232, v236
    s_nop 0
    s_or_b64 vcc, vcc, s[68:69]
    s_cbranch_vccnz L_k4_redo
L_k4_t1:
    v_mfma_f32_16x16x32_bf16 v[240:243], v[152:155], a[0:3], 0
    v_mul_f32 v224, v224, v12
    v_mul_f32 v225, v225, v12
    v_mfma_f32_16x16x32_bf16 v[244:247], v[152:155], a[4:7], 0
    v_exp_f32 v32, v224
    v_mfma_f32_16x16x32_bf16 v[248:251], v[152:155], a[8:11], 0
    v_exp_f32 v33, v225
    v_mfma_f32_16x16x32_bf16 v[252:255], v[152:155], a[12:15], 0
    buffer_load_dwordx4 v[148:151], v6, s[8:11], s36 offen offset:1024
    buffer_load_dwordx4 v[152:155], v2, s[8:11], s37 offen offset:0
    v_mfma_f32_16x16x32_bf16 v[240:243], v[156:159], a[16:19], v[240:243]
    s_add_u32 s36, s36, 36864
    v_add_f32 v32, 1.0, v32
    v_add_f32 v33, 1.0, v33
    v_mfma_f32_16x16x32_bf16 v[244:247], v[156:159], a[20:23], v[244:247]
    v_mul_f32 v226, v226, v12
    v_mul_f32 v227, v227, v12
    v_mfma_f32_16x16x32_bf16 v[248:251], v[156:159], a[24:27], v[248:251]
    s_waitcnt vmcnt(63)
    v_rcp_f32 v32, v32
    v_mfma_f32_16x16x32_bf16 v[252:255], v[156:159], a[28:31], v[252:255]
    buffer_load_dwordx4 v[156:159], v2, s[8:11], s37 offen offset:1024
    v_mfma_f32_16x16x32_bf16 v[240:243], v[160:163], a[32:35], v[240:243]
    v_exp_f32 v34, v226
    v_mfma_f32_16x16x32_bf16 v[244:247], v[160:163], a[36:39], v[244:247]
    v_rcp_f32 v33, v33
    v_mfma_f32_16x16x32_bf16 v[248:251], v[160:163], a[40:43], v[248:251]
    v_exp_f32 v35, v227
    v_mfma_f32_16x16x32_bf16 v[252:255], v[160:163], a[44:47], v[252:255]
    buffer_load_dwordx4 v[160:163], v2, s[8:11], s37 offen offset:2048
    v_mfma_f32_16x16x32_bf16 v[240:243], v[164:167], a[48:51], v[240:243]
    v_mul_f32 v224, v224, v32
    v_mul_f32 v225, v225, v33
    v_cvt_pk_bf16_f32 v16, v224, v225
    v_mfma_f32_16x16x32_bf16 v[244:247], v[164:167], a[52:55], v[244:247]
    v_add_f32 v34, 1.0, v34
    v_add_f32 v35, 1.0, v35
    v_mfma_f32_16x16x32_bf16 v[248:251], v[164:167], a[56:59], v[248:251]
    s_waitcnt vmcnt(63)
    v_mul_f32 v228, v228, v13
    v_mul_f32 v229, v229, v13
    v_mfma_f32_16x16x32_bf16 v[252:255], v[164:167], a[60:63], v[252:255]
    buffer_load_dwordx4 v[164:167], v2, s[8:11], s37 offen offset:3072
    v_mfma_f32_16x16x32_bf16 v[240:243], v[168:171], a[64:67], v[240:243]
    v_rcp_f32 v34, v34
    v_mfma_f32_16x16x32_bf16 v[244:247], v[168:171], a[68:71], v[244:247]
    v_exp_f32 v32, v228
    v_mfma_f32_16x16x32_bf16 v[248:251], v[168:171], a[72:75], v[248:251]
    v_rcp_f32 v35, v35
    v_mfma_f32_16x16x32_bf16 v[252:255], v[168:171], a[76:79], v[252:255]
    buffer_load_dwordx4 v[168:171], v3, s[8:11], s37 offen offset:0
    v_mfma_f32_16x16x32_bf16 v[240:243], v[172:175], a[80:83], v[240:243]
    v_exp_f32 v33, v229
    v_mfma_f32_16x16x32_bf16 v[244:247], v[172:175], a[84:87], v[244:247]
    v_mul_f32 v226, v226, v34
    v_mul_f32 v227, v227, v35
    v_cvt_pk_bf16_f32 v17, v226, v227
    v_mfma_f32_16x16x32_bf16 v[248:251], v[172:175], a[88:91], v[248:251]
    s_waitcnt vmcnt(60)
    s_barrier
    ds_write_b64 v41, v[16:17] offset:0
    v_add_f32 v32, 1.0, v32
    v_add_f32 v33, 1.0, v33
    v_mfma_f32_16x16x32_bf16 v[252:255], v[172:175], a[92:95], v[252:255]
    buffer_load_dwordx4 v[172:175], v3, s[8:11], s37 offen offset:1024
    v_mfma_f32_16x16x32_bf16 v[240:243], v[176:179], a[96:99], v[240:243]
    v_mul_f32 v230, v230, v13
    v_mul_f32 v231, v231, v13
    v_mfma_f32_16x16x32_bf16 v[244:247], v[176:179], a[100:103], v[244:247]
    v_rcp_f32 v32, v32
    v_mfma_f32_16x16x32_bf16 v[248:251], v[176:179], a[104:107], v[248:251]
    v_exp_f32 v34, v230
    v_mfma_f32_16x16x32_bf16 v[252:255], v[176:179], a[108:111], v[252:255]
    buffer_load_dwordx4 v[176:179], v3, s[8:11], s37 offen offset:2048
    v_mfma_f32_16x16x32_bf16 v[240:243], v[180:183], a[112:115], v[240:243]
    v_rcp_f32 v33, v33
    v_mfma_f32_16x16x32_bf16 v[244:247], v[180:183], a[116:119], v[244:247]
    v_exp_f32 v35, v231
    v_mfma_f32_16x16x32_bf16 v[248:251], v[180:183], a[120:123], v[248:251]
    s_waitcnt vmcnt(60)
    v_mul_f32 v228, v228, v32
    v_mul_f32 v229, v229, v33
    v_cvt_pk_bf16_f32 v20, v228, v229
    v_mfma_f32_16x16x32_bf16 v[252:255], v[180:183], a[124:127], v[252:255]
    buffer_load_dwordx4 v[180:183], v3, s[8:11], s37 offen offset:3072
    v_add_f32 v34, 1.0, v34
    v_add_f32 v35, 1.0, v35
    v_mfma_f32_16x16x32_bf16 v[240:243], v[184:187], a[128:131], v[240:243]
    v_mul_f32 v232, v232, v14
    v_mul_f32 v233, v233, v14
    v_mfma_f32_16x16x32_bf16 v[244:247], v[184:187], a[132:135], v[244:247]
    v_rcp_f32 v34, v34
    v_mfma_f32_16x16x32_bf16 v[248:251], v[184:187], a[136:139], v[248:251]
    v_exp_f32 v32, v232
    v_mfma_f32_16x16x32_bf16 v[252:255], v[184:187], a[140:143], v[252:255]
    buffer_load_dwordx4 v[184:187], v4, s[8:11], s37 offen offset:0
    v_mfma_f32_16x16x32_bf16 v[240:243], v[188:191], a[144:147], v[240:243]
    v_rcp_f32 v35, v35
    v_mfma_f32_16x16x32_bf16 v[244:247], v[188:191], a[148:151], v[244:247]
    v_exp_f32 v33, v233
    v_mfma_f32_16x16x32_bf16 v[248:251], v[188:191], a[152:155], v[248:251]
    s_waitcnt vmcnt(56)
    v_mul_f32 v230, v230, v34
    v_mul_f32 v231, v231, v35
    v_cvt_pk_bf16_f32 v21, v230, v231
    v_mfma_f32_16x16x32_bf16 v[252:255], v[188:191], a[156:159], v[252:255]
    buffer_load_dwordx4 v[188:191], v4, s[8:11], s37 offen offset:1024
    ds_write_b64 v41, v[20:21] offset:18432
    v_add_f32 v32, 1.0, v32
    v_add_f32 v33, 1.0, v33
    v_mfma_f32_16x16x32_bf16 v[240:243], v[192:195], a[160:163], v[240:243]
    v_mul_f32 v234, v234, v14
    v_mul_f32 v235, v235, v14
    v_mfma_f32_16x16x32_bf16 v[244:247], v[192:195], a[164:167], v[244:247]
    v_rcp_f32 v32, v32
    v_mfma_f32_16x16x32_bf16 v[248:251], v[192:195], a[168:171], v[248:251]
    v_exp_f32 v34, v234
    v_mfma_f32_16x16x32_bf16 v[252:255], v[192:195], a[172:175], v[252:255]
    buffer_load_dwordx4 v[192:195], v4, s[8:11], s37 offen offset:2048
    v_mfma_f32_16x16x32_bf16 v[240:243], v[196:199], a[176:179], v[240:243]
    v_rcp_f32 v33, v33
    v_mfma_f32_16x16x32_bf16 v[244:247], v[196:199], a[180:183], v[244:247]
    v_exp_f32 v35, v235
    v_mfma_f32_16x16x32_bf16 v[248:251], v[196:199], a[184:187], v[248:251]
    s_waitcnt vmcnt(56)
    v_mul_f32 v232, v232, v32
    v_mul_f32 v233, v233, v33
    v_cvt_pk_bf16_f32 v24, v232, v233
    v_mfma_f32_16x16x32_bf16 v[252:255], v[196:199], v[48:51], v[252:255]
    buffer_load_dwordx4 v[196:199], v4, s[8:11], s37 offen offset:3072
    v_mfma_f32_16x16x32_bf16 v[240:243], v[200:203], v[52:55], v[240:243]
    v_add_f32 v34, 1.0, v34
    v_add_f32 v35, 1.0, v35
    v_mfma_f32_16x16x32_bf16 v[244:247], v[200:203], v[56:59], v[244:247]
    v_mul_f32 v236, v236, v15
    v_mul_f32 v237, v237, v15
    v_mfma_f32_16x16x32_bf16 v[248:251], v[200:203], v[60:63], v[248:251]
    v_rcp_f32 v34, v34
    v_mfma_f32_16x16x32_bf16 v[252:255], v[200:203], v[64:67], v[252:255]
    buffer_load_dwordx4 v[200:203], v5, s[8:11], s37 offen offset:0
    v_mfma_f32_16x16x32_bf16 v[240:243], v[204:207], v[68:71], v[240:243]
    v_exp_f32 v32, v236
    v_mfma_f32_16x16x32_bf16 v[244:247], v[204:207], v[72:75], v[244:247]
    v_rcp_f32 v35, v35
    v_mfma_f32_16x16x32_bf16 v[248:251], v[204:207], v[76:79], v[248:251]
    s_waitcnt vmcnt(56)
    v_exp_f32 v33, v237
    v_mfma_f32_16x16x32_bf16 v[252:255], v[204:207], v[80:83], v[252:255]
    buffer_load_dwordx4 v[204:207], v5, s[8:11], s37 offen offset:1024
    v_mfma_f32_16x16x32_bf16 v[240:243], v[208:211], v[84:87], v[240:243]
    v_mul_f32 v234, v234, v34
    v_mul_f32 v235, v235, v35
    v_cvt_pk_bf16_f32 v25, v234, v235
    v_mfma_f32_16x16x32_bf16 v[244:247], v[208:211], v[88:91], v[244:247]
    ds_write_b64 v41, v[24:25] offset:36864
    v_add_f32 v32, 1.0, v32
    v_add_f32 v33, 1.0, v33
    v_mfma_f32_16x16x32_bf16 v[248:251], v[208:211], v[92:95], v[248:251]
L_tp18:
    s_cbranch_execz L_tret
    v_mul_f32 v238, v238, v15
    v_mul_f32 v239, v239, v15
    v_mfma_f32_16x16x32_bf16 v[252:255], v[208:211], v[96:99], v[252:255]
    buffer_load_dwordx4 v[208:211], v5, s[8:11], s37 offen offset:2048
    v_mfma_f32_16x16x32_bf16 v[240:243], v[212:215], v[100:103], v[240:243]
    v_rcp_f32 v32, v32
    v_mfma_f32_16x16x32_bf16 v[244:247], v[212:215], v[104:107], v[244:247]
    v_exp_f32 v34, v238
    v_mfma_f32_16x16x32_bf16 v[248:251], v[212:215], v[108:111], v[248:251]
    s_waitcnt vmcnt(56)
    v_rcp_f32 v33, v33
    v_mfma_f32_16x16x32_bf16 v[252:255], v[212:215], v[112:115], v[252:255]
    buffer_load_dwordx4 v[212:215], v5, s[8:11], s37 offen offset:3072
    v_mfma_f32_16x16x32_bf16 v[240:243], v[216:219], v[116:119], v[240:243]
    v_exp_f32 v35, v239
    v_mfma_f32_16x16x32_bf16 v[244:247], v[216:219], v[120:123], v[244:247]
    v_mul_f32 v236, v236, v32
    v_mul_f32 v237, v237, v33
    v_cvt_pk_bf16_f32 v28, v236, v237
    v_mfma_f32_16x16x32_bf16 v[248:251], v[216:219], v[124:127], v[248:251]
    v_add_f32 v34, 1.0, v34
    v_add_f32 v35, 1.0, v35
    v_mfma_f32_16x16x32_bf16 v[252:255], v[216:219], v[128:131], v[252:255]
    buffer_load_dwordx4 v[216:219], v6, s[8:11], s37 offen offset:0
    v_mfma_f32_16x16x32_bf16 v[240:243], v[220:223], v[132:135], v[240:243]
    v_rcp_f32 v34, v34
    v_mfma_f32_16x16x32_bf16 v[244:247], v[220:223], v[136:139], v[244:247]
    v_rcp_f32 v35, v35
    v_mfma_f32_16x16x32_bf16 v[248:251], v[220:223], v[140:143], v[248:251]
    s_waitcnt vmcnt(33)
    v_mul_f32 v238, v238, v34
    v_mul_f32 v239, v239, v35
    v_cvt_pk_bf16_f32 v29, v238, v239
    v_mfma_f32_16x16x32_bf16 v[252:255], v[220:223], v[144:147], v[252:255]
    buffer_load_dwordx4 v[220:223], v6, s[8:11], s37 offen offset:1024
    ds_write_b64 v41, v[28:29] offset:55296
    s_mov_b32 s39, 2
.p2align 6
L_k4_g1:
    v_mfma_f32_16x16x32_bf16 v[224:227], a[188:191], a[0:3], 0
    s_add_u32 s37, s37, 36864
    v_mul_f32 v240, v240, v12
    v_mul_f32 v241, v241, v12
    v_mfma_f32_16x16x32_bf16 v[228:231], a[188:191], a[4:7], 0
    v_exp_f32 v32, v240
    v_mfma_f32_16x16x32_bf16 v[232:235], a[188:191], a[8:11], 0
    v_exp_f32 v33, v241
    v_mfma_f32_16x16x32_bf16 v[236:239], a[188:191], a[12:15], 0
    buffer_load_dwordx4 a[188:191], v2, s[8:11], s36 offen offset:0
    v_mfma_f32_16x16x32_bf16 v[224:227], a[192:195], a[16:19], v[224:227]
    v_add_f32 v32, 1.0, v32
    v_add_f32 v33, 1.0, v33
    v_mfma_f32_16x16x32_bf16 v[228:231], a[192:195], a[20:23], v[228:231]
    v_mul_f32 v242, v242, v12
    v_mul_f32 v243, v243, v12
    v_mfma_f32_16x16x32_bf16 v[232:235], a[192:195], a[24:27], v[232:235]
    s_waitcnt vmcnt(33)
    v_rcp_f32 v32, v32
    v_mfma_f32_16x16x32_bf16 v[236:239], a[192:195], a[28:31], v[236:239]
    buffer_load_dwordx4 a[192:195], v2, s[8:11], s36 offen offset:1024
    v_mfma_f32_16x16x32_bf16 v[224:227], a[196:199], a[32:35], v[224:227]
    v_exp_f32 v34, v242
    v_mfma_f32_16x16x32_bf16 v[228:231], a[196:199], a[36:39], v[228:231]
    v_rcp_f32 v33, v33
    v_mfma_f32_16x16x32_bf16 v[232:235], a[196:199], a[40:43], v[232:235]
    v_exp_f32 v35, v243
    v_mfma_f32_16x16x32_bf16 v[236:239], a[196:199], a[44:47], v[236:239]
    buffer_load_dwordx4 a[196:199], v2, s[8:11], s36 offen offset:2048
    v_mfma_f32_16x16x32_bf16 v[224:227], a[200:203], a[48:51], v[224:227]
    v_mul_f32 v240, v240, v32
    v_mul_f32 v241, v241, v33
    v_cvt_pk_bf16_f32 v16, v240, v241
    v_mfma_f32_16x16x32_bf16 v[228:231], a[200:203], a[52:55], v[228:231]
    v_add_f32 v34, 1.0, v34
    v_add_f32 v35, 1.0, v35
    v_mfma_f32_16x16x32_bf16 v[232:235], a[200:203], a[56:59], v[232:235]
    s_waitcnt vmcnt(33)
    v_mul_f32 v244, v244, v13
    v_mul_f32 v245, v245, v13
    v_mfma_f32_16x16x32_bf16 v[236:239], a[200:203], a[60:63], v[236:239]
    buffer_load_dwordx4 a[200:203], v2, s[8:11], s36 offen offset:3072
    v_mfma_f32_16x16x32_bf16 v[224:227], a[204:207], a[64:67], v[224:227]
    v_rcp_f32 v34, v34
    v_mfma_f32_16x16x32_bf16 v[228:231], a[204:207], a[68:71], v[228:231]
    v_exp_f32 v32, v244
    v_mfma_f32_16x16x32_bf16 v[232:235], a[204:207], a[72:75], v[232:235]
    v_rcp_f32 v35, v35
    v_mfma_f32_16x16x32_bf16 v[236:239], a[204:207], a[76:79], v[236:239]
    buffer_load_dwordx4 a[204:207], v3, s[8:11], s36 offen offset:0
    v_mfma_f32_16x16x32_bf16 v[224:227], a[208:211], a[80:83], v[224:227]
    v_exp_f32 v33, v245
    v_mfma_f32_16x16x32_bf16 v[228:231], a[208:211], a[84:87], v[228:231]
    v_mul_f32 v242, v242, v34
    v_mul_f32 v243, v243, v35
    v_cvt_pk_bf16_f32 v17, v242, v243
    v_mfma_f32_16x16x32_bf16 v[232:235], a[208:211], a[88:91], v[232:235]
    s_waitcnt vmcnt(33)
    v_add_f32 v32, 1.0, v32
    v_add_f32 v33, 1.0, v33
    v_mfma_f32_16x16x32_bf16 v[236:239], a[208:211], a[92:95], v[236:239]
    buffer_load_dwordx4 a[208:211], v3, s[8:11], s36 offen offset:1024
    v_mfma_f32_16x16x32_bf16 v[224:227], a[212:215], a[96:99], v[224:227]
    v_mul_f32 v246, v246, v13
    v_mul_f32 v247, v247, v13
    v_mfma_f32_16x16x32_bf16 v[228:231], a[212:215], a[100:103], v[228:231]
    v_rcp_f32 v32, v32
    v_mfma_f32_16x16x32_bf16 v[232:235], a[212:215], a[104:107], v[232:235]
    v_exp_f32 v34, v246
    v_mfma_f32_16x16x32_bf16 v[236:239], a[212:215], a[108:111], v[236:239]
    buffer_load_dwordx4 a[212:215], v3, s[8:11], s36 offen offset:2048
    v_mfma_f32_16x16x32_bf16 v[224:227], a[216:219], a[112:115], v[224:227]
    v_rcp_f32 v33, v33
    v_mfma_f32_16x16x32_bf16 v[228:231], a[216:219], a[116:119], v[228:231]
    v_exp_f32 v35, v247
    v_mfma_f32_16x16x32_bf16 v[232:235], a[216:219], a[120:123], v[232:235]
    s_waitcnt vmcnt(33)
    v_mul_f32 v244, v244, v32
    v_mul_f32 v245, v245, v33
    v_cvt_pk_bf16_f32 v20, v244, v245
    v_mfma_f32_16x16x32_bf16 v[236:239], a[216:219], a[124:127], v[236:239]
    buffer_load_dwordx4 a[216:219], v3, s[8:11], s36 offen offset:3072
    v_add_f32 v34, 1.0, v34
    v_add_f32 v35, 1.0, v35
    v_mfma_f32_16x16x32_bf16 v[224:227], a[220:223], a[128:131], v[224:227]
    v_mul_f32 v248, v248, v14
    v_mul_f32 v249, v249, v14
    v_mfma_f32_16x16x32_bf16 v[228:231], a[220:223], a[132:135], v[228:231]
    v_rcp_f32 v34, v34
    v_mfma_f32_16x16x32_bf16 v[232:235], a[220:223], a[136:139], v[232:235]
    v_exp_f32 v32, v248
    v_mfma_f32_16x16x32_bf16 v[236:239], a[220:223], a[140:143], v[236:239]
    buffer_load_dwordx4 a[220:223], v4, s[8:11], s36 offen offset:0
    v_mfma_f32_16x16x32_bf16 v[224:227], a[224:227], a[144:147], v[224:227]
    v_rcp_f32 v35, v35
    v_mfma_f32_16x16x32_bf16 v[228:231], a[224:227], a[148:151], v[228:231]
    v_exp_f32 v33, v249
    v_mfma_f32_16x16x32_bf16 v[232:235], a[224:227], a[152:155], v[232:235]
    s_waitcnt vmcnt(33)
    v_mul_f32 v246, v246, v34
    v_mul_f32 v247, v247, v35
    v_cvt_pk_bf16_f32 v21, v246, v247
    v_mfma_f32_16x16x32_bf16 v[236:239], a[224:227], a[156:159], v[236:239]
    buffer_load_dwordx4 a[224:227], v4, s[8:11], s36 offen offset:1024
    v_add_f32 v32, 1.0, v32
    v_add_f32 v33, 1.0, v33
    v_mfma_f32_16x16x32_bf16 v[224:227], a[228:231], a[160:163], v[224:227]
    v_mul_f32 v250, v250, v14
    v_mul_f32 v251, v251, v14
    v_mfma_f32_16x16x32_bf16 v[228:231], a[228:231], a[164:167], v[228:231]
    v_rcp_f32 v32, v32
    v_mfma_f32_16x16x32_bf16 v[232:235], a[228:231], a[168:171], v[232:235]
    v_exp_f32 v34, v250
    v_mfma_f32_16x16x32_bf16 v[236:239], a[228:231], a[172:175], v[236:239]
    buffer_load_dwordx4 a[228:231], v4, s[8:11], s36 offen offset:2048
    v_mfma_f32_16x16x32_bf16 v[224:227], a[232:235], a[176:179], v[224:227]
    v_rcp_f32 v33, v33
    v_mfma_f32_16x16x32_bf16 v[228:231], a[232:235], a[180:183], v[228:231]
    v_exp_f32 v35, v251
    v_mfma_f32_16x16x32_bf16 v[232:235], a[232:235], a[184:187], v[232:235]
    s_waitcnt vmcnt(33)
    v_mul_f32 v248, v248, v32
    v_mul_f32 v249, v249, v33
    v_cvt_pk_bf16_f32 v24, v248, v249
    v_mfma_f32_16x16x32_bf16 v[236:239], a[232:235], v[48:51], v[236:239]
L_tp19:
    s_cbranch_execz L_tret
    buffer_load_dwordx4 a[232:235], v4, s[8:11], s36 offen offset:3072
    v_mfma_f32_16x16x32_bf16 v[224:227], a[236:239], v[52:55], v[224:227]
    v_add_f32 v34, 1.0, v34
    v_add_f32 v35, 1.0, v35
    v_mfma_f32_16x16x32_bf16 v[228:231], a[236:239], v[56:59], v[228:231]
    v_mul_f32 v252, v252, v15
    v_mul_f32 v253, v253, v15
    v_mfma_f32_16x16x32_bf16 v[232:235], a[236:239], v[60:63], v[232:235]
    v_rcp_f32 v34, v34
    v_mfma_f32_16x16x32_bf16 v[236:239], a[236:239], v[64:67], v[236:239]
    buffer_load_dwordx4 a[236:239], v5, s[8:11], s36 offen offset:0
    v_mfma_f32_16x16x32_bf16 v[224:227], a[240:243], v[68:71], v[224:227]
    v_exp_f32 v32, v252
    v_mfma_f32_16x16x32_bf16 v[228:231], a[240:243], v[72:75], v[228:231]
    v_rcp_f32 v35, v35
    v_mfma_f32_16x16x32_bf16 v[232:235], a[240:243], v[76:79], v[232:235]
    s_waitcnt vmcnt(33)
    v_exp_f32 v33, v253
    v_mfma_f32_16x16x32_bf16 v[236:239], a[240:243], v[80:83], v[236:239]
    buffer_load_dwordx4 a[240:243], v5, s[8:11], s36 offen offset:1024
    v_mfma_f32_16x16x32_bf16 v[224:227], a[244:247], v[84:87], v[224:227]
    v_mul_f32 v250, v250, v34
    v_mul_f32 v251, v251, v35
    v_cvt_pk_bf16_f32 v25, v250, v251
    v_mfma_f32_16x16x32_bf16 v[228:231], a[244:247], v[88:91], v[228:231]
    v_add_f32 v32, 1.0, v32
    v_add_f32 v33, 1.0, v33
    v_mfma_f32_16x16x32_bf16 v[232:235], a[244:247], v[92:95], v[232:235]
    v_mul_f32 v254, v254, v15
    v_mul_f32 v255, v255, v15
    v_mfma_f32_16x16x32_bf16 v[236:239], a[244:247], v[96:99], v[236:239]
    buffer_load_dwordx4 a[244:247], v5, s[8:11], s36 offen offset:2048
    v_mfma_f32_16x16x32_bf16 v[224:227], a[248:251], v[100:103], v[224:227]
    v_rcp_f32 v32, v32
    v_mfma_f32_16x16x32_bf16 v[228:231], a[248:251], v[104:107], v[228:231]
    v_exp_f32 v34, v254
    v_mfma_f32_16x16x32_bf16 v[232:235], a[248:251], v[108:111], v[232:235]
    s_waitcnt vmcnt(33)
    v_rcp_f32 v33, v33
    v_mfma_f32_16x16x32_bf16 v[236:239], a[248:251], v[112:115], v[236:239]
    buffer_load_dwordx4 a[248:251], v5, s[8:11], s36 offen offset:3072
    v_mfma_f32_16x16x32_bf16 v[224:227], a[252:255], v[116:119], v[224:227]
    v_exp_f32 v35, v255
    v_mfma_f32_16x16x32_bf16 v[228:231], a[252:255], v[120:123], v[228:231]
    v_mul_f32 v252, v252, v32
    v_mul_f32 v253, v253, v33
    v_cvt_pk_bf16_f32 v28, v252, v253
    v_mfma_f32_16x16x32_bf16 v[232:235], a[252:255], v[124:127], v[232:235]
    v_add_f32 v34, 1.0, v34
    v_add_f32 v35, 1.0, v35
    v_mfma_f32_16x16x32_bf16 v[236:239], a[252:255], v[128:131], v[236:239]
    buffer_load_dwordx4 a[252:255], v6, s[8:11], s36 offen offset:0
    v_mfma_f32_16x16x32_bf16 v[224:227], v[148:151], v[132:135], v[224:227]
    v_rcp_f32 v34, v34
    v_mfma_f32_16x16x32_bf16 v[228:231], v[148:151], v[136:139], v[228:231]
    v_rcp_f32 v35, v35
    v_mfma_f32_16x16x32_bf16 v[232:235], v[148:151], v[140:143], v[232:235]
    s_waitcnt vmcnt(33)
    v_mul_f32 v254, v254, v34
    v_mul_f32 v255, v255, v35
    v_cvt_pk_bf16_f32 v29, v254, v255
    v_mfma_f32_16x16x32_bf16 v[236:239], v[148:151], v[144:147], v[236:239]
    buffer_load_dwordx4 v[148:151], v6, s[8:11], s36 offen offset:1024
    v_mfma_f32_16x16x32_bf16 v[240:243], v[152:155], a[0:3], 0
    s_add_u32 s36, s36, 36864
    v_mul_f32 v224, v224, v12
    v_mul_f32 v225, v225, v12
    v_mfma_f32_16x16x32_bf16 v[244:247], v[152:155], a[4:7], 0
    v_exp_f32 v32, v224
    v_mfma_f32_16x16x32_bf16 v[248:251], v[152:155], a[8:11], 0
    v_exp_f32 v33, v225
    v_mfma_f32_16x16x32_bf16 v[252:255], v[152:155], a[12:15], 0
    buffer_load_dwordx4 v[152:155], v2, s[8:11], s37 offen offset:0
    v_mfma_f32_16x16x32_bf16 v[240:243], v[156:159], a[16:19], v[240:243]
    v_add_f32 v32, 1.0, v32
    v_add_f32 v33, 1.0, v33
    v_mfma_f32_16x16x32_bf16 v[244:247], v[156:159], a[20:23], v[244:247]
    v_mul_f32 v226, v226, v12
    v_mul_f32 v227, v227, v12
    v_mfma_f32_16x16x32_bf16 v[248:251], v[156:159], a[24:27], v[248:251]
    s_waitcnt vmcnt(33)
    v_rcp_f32 v32, v32
    v_mfma_f32_16x16x32_bf16 v[252:255], v[156:159], a[28:31], v[252:255]
    buffer_load_dwordx4 v[156:159], v2, s[8:11], s37 offen offset:1024
    v_mfma_f32_16x16x32_bf16 v[240:243], v[160:163], a[32:35], v[240:243]
    v_exp_f32 v34, v226
    v_mfma_f32_16x16x32_bf16 v[244:247], v[160:163], a[36:39], v[244:247]
    v_rcp_f32 v33, v33
    v_mfma_f32_16x16x32_bf16 v[248:251], v[160:163], a[40:43], v[248:251]
    v_exp_f32 v35, v227
    v_mfma_f32_16x16x32_bf16 v[252:255], v[160:163], a[44:47], v[252:255]
    buffer_load_dwordx4 v[160:163], v2, s[8:11], s37 offen offset:2048
    v_mfma_f32_16x16x32_bf16 v[240:243], v[164:167], a[48:51], v[240:243]
    v_mul_f32 v224, v224, v32
    v_mul_f32 v225, v225, v33
    v_cvt_pk_bf16_f32 v18, v224, v225
    v_mfma_f32_16x16x32_bf16 v[244:247], v[164:167], a[52:55], v[244:247]
    v_add_f32 v34, 1.0, v34
    v_add_f32 v35, 1.0, v35
    v_mfma_f32_16x16x32_bf16 v[248:251], v[164:167], a[56:59], v[248:251]
    s_waitcnt vmcnt(33)
    v_mul_f32 v228, v228, v13
    v_mul_f32 v229, v229, v13
    v_mfma_f32_16x16x32_bf16 v[252:255], v[164:167], a[60:63], v[252:255]
    buffer_load_dwordx4 v[164:167], v2, s[8:11], s37 offen offset:3072
    v_mfma_f32_16x16x32_bf16 v[240:243], v[168:171], a[64:67], v[240:243]
    v_rcp_f32 v34, v34
    v_mfma_f32_16x16x32_bf16 v[244:247], v[168:171], a[68:71], v[244:247]
    v_exp_f32 v32, v228
    v_mfma_f32_16x16x32_bf16 v[248:251], v[168:171], a[72:75], v[248:251]
    v_rcp_f32 v35, v35
    v_mfma_f32_16x16x32_bf16 v[252:255], v[168:171], a[76:79], v[252:255]
    buffer_load_dwordx4 v[168:171], v3, s[8:11], s37 offen offset:0
    v_mfma_f32_16x16x32_bf16 v[240:243], v[172:175], a[80:83], v[240:243]
    v_exp_f32 v33, v229
    v_mfma_f32_16x16x32_bf16 v[244:247], v[172:175], a[84:87], v[244:247]
    v_mul_f32 v226, v226, v34
    v_mul_f32 v227, v227, v35
    v_cvt_pk_bf16_f32 v19, v226, v227
    v_mfma_f32_16x16x32_bf16 v[248:251], v[172:175], a[88:91], v[248:251]
    s_waitcnt vmcnt(33)
    ds_write_b128 v40, v[16:19] offset:0
    v_add_f32 v32, 1.0, v32
    v_add_f32 v33, 1.0, v33
    v_mfma_f32_16x16x32_bf16 v[252:255], v[172:175], a[92:95], v[252:255]
    buffer_load_dwordx4 v[172:175], v3, s[8:11], s37 offen offset:1024
    v_mfma_f32_16x16x32_bf16 v[240:243], v[176:179], a[96:99], v[240:243]
    v_mul_f32 v230, v230, v13
    v_mul_f32 v231, v231, v13
    v_mfma_f32_16x16x32_bf16 v[244:247], v[176:179], a[100:103], v[244:247]
    v_rcp_f32 v32, v32
    v_mfma_f32_16x16x32_bf16 v[248:251], v[176:179], a[104:107], v[248:251]
    v_exp_f32 v34, v230
    v_mfma_f32_16x16x32_bf16 v[252:255], v[176:179], a[108:111], v[252:255]
    buffer_load_dwordx4 v[176:179], v3, s[8:11], s37 offen offset:2048
    v_mfma_f32_16x16x32_bf16 v[240:243], v[180:183], a[112:115], v[240:243]
    v_rcp_f32 v33, v33
    v_mfma_f32_16x16x32_bf16 v[244:247], v[180:183], a[116:119], v[244:247]
    v_exp_f32 v35, v231
    v_mfma_f32_16x16x32_bf16 v[248:251], v[180:183], a[120:123], v[248:251]
    s_waitcnt vmcnt(33)
    v_mul_f32 v228, v228, v32
    v_mul_f32 v229, v229, v33
    v_cvt_pk_bf16_f32 v22, v228, v229
    v_mfma_f32_16x16x32_bf16 v[252:255], v[180:183], a[124:127], v[252:255]
    buffer_load_dwordx4 v[180:183], v3, s[8:11], s37 offen offset:3072
    v_add_f32 v34, 1.0, v34
    v_add_f32 v35, 1.0, v35
    v_mfma_f32_16x16x32_bf16 v[240:243], v[184:187], a[128:131], v[240:243]
    v_mul_f32 v232, v232, v14
    v_mul_f32 v233, v233, v14
    v_mfma_f32_16x16x32_bf16 v[244:247], v[184:187], a[132:135], v[244:247]
    v_rcp_f32 v34, v34
    v_mfma_f32_16x16x32_bf16 v[248:251], v[184:187], a[136:139], v[248:251]
    v_exp_f32 v32, v232
    v_mfma_f32_16x16x32_bf16 v[252:255], v[184:187], a[140:143], v[252:255]
    buffer_load_dwordx4 v[184:187], v4, s[8:11], s37 offen offset:0
    v_mfma_f32_16x16x32_bf16 v[240:243], v[188:191], a[144:147], v[240:243]
    v_rcp_f32 v35, v35
    v_mfma_f32_16x16x32_bf16 v[244:247], v[188:191], a[148:151], v[244:247]
    v_exp_f32 v33, v233
    v_mfma_f32_16x16x32_bf16 v[248:251], v[188:191], a[152:155], v[248:251]
    s_waitcnt vmcnt(33)
    v_mul_f32 v230, v230, v34
    v_mul_f32 v231, v231, v35
    v_cvt_pk_bf16_f32 v23, v230, v231
    v_mfma_f32_16x16x32_bf16 v[252:255], v[188:191], a[156:159], v[252:255]
L_tp20:
    s_cbranch_execz L_tret
    buffer_load_dwordx4 v[188:191], v4, s[8:11], s37 offen offset:1024
    ds_write_b128 v40, v[20:23] offset:18432
    v_add_f32 v32, 1.0, v32
    v_add_f32 v33, 1.0, v33
    v_mfma_f32_16x16x32_bf16 v[240:243], v[192:195], a[160:163], v[240:243]
    v_mul_f32 v234, v234, v14
    v_mul_f32 v235, v235, v14
    v_mfma_f32_16x16x32_bf16 v[244:247], v[192:195], a[164:167], v[244:247]
    v_rcp_f32 v32, v32
    v_mfma_f32_16x16x32_bf16 v[248:251], v[192:195], a[168:171], v[248:251]
    v_exp_f32 v34, v234
    v_mfma_f32_16x16x32_bf16 v[252:255], v[192:195], a[172:175], v[252:255]
    buffer_load_dwordx4 v[192:195], v4, s[8:11], s37 offen offset:2048
    v_mfma_f32_16x16x32_bf16 v[240:243], v[196:199], a[176:179], v[240:243]
    v_rcp_f32 v33, v33
    v_mfma_f32_16x16x32_bf16 v[244:247], v[196:199], a[180:183], v[244:247]
    v_exp_f32 v35, v235
    v_mfma_f32_16x16x32_bf16 v[248:251], v[196:199], a[184:187], v[248:251]
    s_waitcnt vmcnt(33)
    v_mul_f32 v232, v232, v32
    v_mul_f32 v233, v233, v33
    v_cvt_pk_bf16_f32 v26, v232, v233
    v_mfma_f32_16x16x32_bf16 v[252:255], v[196:199], v[48:51], v[252:255]
    buffer_load_dwordx4 v[196:199], v4, s[8:11], s37 offen offset:3072
    v_mfma_f32_16x16x32_bf16 v[240:243], v[200:203], v[52:55], v[240:243]
    v_add_f32 v34, 1.0, v34
    v_add_f32 v35, 1.0, v35
    v_mfma_f32_16x16x32_bf16 v[244:247], v[200:203], v[56:59], v[244:247]
    v_mul_f32 v236, v236, v15
    v_mul_f32 v237, v237, v15
    v_mfma_f32_16x16x32_bf16 v[248:251], v[200:203], v[60:63], v[248:251]
    v_rcp_f32 v34, v34
    v_mfma_f32_16x16x32_bf16 v[252:255], v[200:203], v[64:67], v[252:255]
    buffer_load_dwordx4 v[200:203], v5, s[8:11], s37 offen offset:0
    v_mfma_f32_16x16x32_bf16 v[240:243], v[204:207], v[68:71], v[240:243]
    v_exp_f32 v32, v236
    v_mfma_f32_16x16x32_bf16 v[244:247], v[204:207], v[72:75], v[244:247]
    v_rcp_f32 v35, v35
    v_mfma_f32_16x16x32_bf16 v[248:251], v[204:207], v[76:79], v[248:251]
    s_waitcnt vmcnt(33)
    v_exp_f32 v33, v237
    v_mfma_f32_16x16x32_bf16 v[252:255], v[204:207], v[80:83], v[252:255]
    buffer_load_dwordx4 v[204:207], v5, s[8:11], s37 offen offset:1024
    v_mfma_f32_16x16x32_bf16 v[240:243], v[208:211], v[84:87], v[240:243]
    v_mul_f32 v234, v234, v34
    v_mul_f32 v235, v235, v35
    v_cvt_pk_bf16_f32 v27, v234, v235
    v_mfma_f32_16x16x32_bf16 v[244:247], v[208:211], v[88:91], v[244:247]
    ds_write_b128 v40, v[24:27] offset:36864
    v_add_f32 v32, 1.0, v32
    v_add_f32 v33, 1.0, v33
    v_mfma_f32_16x16x32_bf16 v[248:251], v[208:211], v[92:95], v[248:251]
    v_mul_f32 v238, v238, v15
    v_mul_f32 v239, v239, v15
    v_mfma_f32_16x16x32_bf16 v[252:255], v[208:211], v[96:99], v[252:255]
    buffer_load_dwordx4 v[208:211], v5, s[8:11], s37 offen offset:2048
    v_mfma_f32_16x16x32_bf16 v[240:243], v[212:215], v[100:103], v[240:243]
    v_rcp_f32 v32, v32
    v_mfma_f32_16x16x32_bf16 v[244:247], v[212:215], v[104:107], v[244:247]
    v_exp_f32 v34, v238
    v_mfma_f32_16x16x32_bf16 v[248:251], v[212:215], v[108:111], v[248:251]
    s_waitcnt vmcnt(33)
    v_rcp_f32 v33, v33
    v_mfma_f32_16x16x32_bf16 v[252:255], v[212:215], v[112:115], v[252:255]
    buffer_load_dwordx4 v[212:215], v5, s[8:11], s37 offen offset:3072
    v_mfma_f32_16x16x32_bf16 v[240:243], v[216:219], v[116:119], v[240:243]
    v_exp_f32 v35, v239
    v_mfma_f32_16x16x32_bf16 v[244:247], v[216:219], v[120:123], v[244:247]
    v_mul_f32 v236, v236, v32
    v_mul_f32 v237, v237, v33
    v_cvt_pk_bf16_f32 v30, v236, v237
    v_mfma_f32_16x16x32_bf16 v[248:251], v[216:219], v[124:127], v[248:251]
    v_add_f32 v34, 1.0, v34
    v_add_f32 v35, 1.0, v35
    v_mfma_f32_16x16x32_bf16 v[252:255], v[216:219], v[128:131], v[252:255]
    buffer_load_dwordx4 v[216:219], v6, s[8:11], s37 offen offset:0
    v_mfma_f32_16x16x32_bf16 v[240:243], v[220:223], v[132:135], v[240:243]
    v_rcp_f32 v34, v34
    v_mfma_f32_16x16x32_bf16 v[244:247], v[220:223], v[136:139], v[244:247]
    s_sub_u32 s39, s39, 1
    v_rcp_f32 v35, v35
    v_mfma_f32_16x16x32_bf16 v[248:251], v[220:223], v[140:143], v[248:251]
    s_waitcnt vmcnt(33)
    v_mul_f32 v238, v238, v34
    v_mul_f32 v239, v239, v35
    v_cvt_pk_bf16_f32 v31, v238, v239
    v_mfma_f32_16x16x32_bf16 v[252:255], v[220:223], v[144:147], v[252:255]
    buffer_load_dwordx4 v[220:223], v6, s[8:11], s37 offen offset:1024
    ds_write_b128 v40, v[28:31] offset:55296
    v_add_u32 v40, 1024, v40
    s_cbranch_scc0 L_k4_g1
    v_mfma_f32_16x16x32_bf16 v[224:227], a[188:191], a[0:3], 0
    s_add_u32 s37, s37, 36864
    v_mul_f32 v240, v240, v12
    v_mul_f32 v241, v241, v12
    v_mfma_f32_16x16x32_bf16 v[228:231], a[188:191], a[4:7], 0
    v_exp_f32 v32, v240
    v_mfma_f32_16x16x32_bf16 v[232:235], a[188:191], a[8:11], 0
    v_exp_f32 v33, v241
    v_mfma_f32_16x16x32_bf16 v[236:239], a[188:191], a[12:15], 0
    buffer_load_dwordx4 a[188:191], v2, s[8:11], s36 offen offset:0
    v_mfma_f32_16x16x32_bf16 v[224:227], a[192:195], a[16:19], v[224:227]
    v_add_f32 v32, 1.0, v32
    v_add_f32 v33, 1.0, v33
    v_mfma_f32_16x16x32_bf16 v[228:231], a[192:195], a[20:23], v[228:231]
    v_mul_f32 v242, v242, v12
    v_mul_f32 v243, v243, v12
    v_mfma_f32_16x16x32_bf16 v[232:235], a[192:195], a[24:27], v[232:235]
    s_waitcnt vmcnt(33)
    v_rcp_f32 v32, v32
    v_mfma_f32_16x16x32_bf16 v[236:239], a[192:195], a[28:31], v[236:239]
    buffer_load_dwordx4 a[192:195], v2, s[8:11], s36 offen offset:1024
    v_mfma_f32_16x16x32_bf16 v[224:227], a[196:199], a[32:35], v[224:227]
    v_exp_f32 v34, v242
    v_mfma_f32_16x16x32_bf16 v[228:231], a[196:199], a[36:39], v[228:231]
    v_rcp_f32 v33, v33
    v_mfma_f32_16x16x32_bf16 v[232:235], a[196:199], a[40:43], v[232:235]
    s_waitcnt lgkmcnt(0)
    s_barrier
    v_exp_f32 v35, v243
    v_mfma_f32_16x16x32_bf16 v[236:239], a[196:199], a[44:47], v[236:239]
    buffer_load_dwordx4 a[196:199], v2, s[8:11], s36 offen offset:2048
    ds_read_b128 a[0:3], v8 offset:0
    v_mfma_f32_16x16x32_bf16 v[224:227], a[200:203], a[48:51], v[224:227]
    ds_read_b128 a[4:7], v8 offset:18432
    v_mul_f32 v240, v240, v32
    v_mul_f32 v241, v241, v33
    v_cvt_pk_bf16_f32 v16, v240, v241
    v_mfma_f32_16x16x32_bf16 v[228:231], a[200:203], a[52:55], v[228:231]
    ds_read_b128 a[8:11], v10 offset:0
    v_add_f32 v34, 1.0, v34
    v_add_f32 v35, 1.0, v35
    v_mfma_f32_16x16x32_bf16 v[232:235], a[200:203], a[56:59], v[232:235]
    s_waitcnt vmcnt(33)
    ds_read_b128 a[12:15], v10 offset:18432
    v_mul_f32 v244, v244, v13
    v_mul_f32 v245, v245, v13
    v_mfma_f32_16x16x32_bf16 v[236:239], a[200:203], a[60:63], v[236:239]
    buffer_load_dwordx4 a[200:203], v2, s[8:11], s36 offen offset:3072
    ds_read_b128 a[16:19], v8 offset:1024
    v_mfma_f32_16x16x32_bf16 v[224:227], a[204:207], a[64:67], v[224:227]
    ds_read_b128 a[20:23], v8 offset:19456
    v_rcp_f32 v34, v34
    v_mfma_f32_16x16x32_bf16 v[228:231], a[204:207], a[68:71], v[228:231]
    ds_read_b128 a[24:27], v10 offset:1024
    v_exp_f32 v32, v244
    v_mfma_f32_16x16x32_bf16 v[232:235], a[204:207], a[72:75], v[232:235]
    ds_read_b128 a[28:31], v10 offset:19456
    v_rcp_f32 v35, v35
    v_mfma_f32_16x16x32_bf16 v[236:239], a[204:207], a[76:79], v[236:239]
    buffer_load_dwordx4 a[204:207], v3, s[8:11], s36 offen offset:0
    ds_read_b128 a[32:35], v8 offset:2048
    v_mfma_f32_16x16x32_bf16 v[224:227], a[208:211], a[80:83], v[224:227]
    ds_read_b128 a[36:39], v8 offset:20480
    v_exp_f32 v33, v245
    v_mfma_f32_16x16x32_bf16 v[228:231], a[208:211], a[84:87], v[228:231]
L_tp21:
    s_cbranch_execz L_tret
    ds_read_b128 a[40:43], v10 offset:2048
    v_mul_f32 v242, v242, v34
    v_mul_f32 v243, v243, v35
    v_cvt_pk_bf16_f32 v17, v242, v243
    v_mfma_f32_16x16x32_bf16 v[232:235], a[208:211], a[88:91], v[232:235]
    s_waitcnt vmcnt(33)
    ds_read_b128 a[44:47], v10 offset:20480
    v_add_f32 v32, 1.0, v32
    v_add_f32 v33, 1.0, v33
    v_mfma_f32_16x16x32_bf16 v[236:239], a[208:211], a[92:95], v[236:239]
    buffer_load_dwordx4 a[208:211], v3, s[8:11], s36 offen offset:1024
    ds_read_b128 a[48:51], v8 offset:4096
    v_mfma_f32_16x16x32_bf16 v[224:227], a[212:215], a[96:99], v[224:227]
    ds_read_b128 a[52:55], v8 offset:22528
    v_mul_f32 v246, v246, v13
    v_mul_f32 v247, v247, v13
    v_mfma_f32_16x16x32_bf16 v[228:231], a[212:215], a[100:103], v[228:231]
    ds_read_b128 a[56:59], v10 offset:4096
    v_rcp_f32 v32, v32
    v_mfma_f32_16x16x32_bf16 v[232:235], a[212:215], a[104:107], v[232:235]
    ds_read_b128 a[60:63], v10 offset:22528
    v_exp_f32 v34, v246
    v_mfma_f32_16x16x32_bf16 v[236:239], a[212:215], a[108:111], v[236:239]
    buffer_load_dwordx4 a[212:215], v3, s[8:11], s36 offen offset:2048
    ds_read_b128 a[64:67], v8 offset:5120
    v_mfma_f32_16x16x32_bf16 v[224:227], a[216:219], a[112:115], v[224:227]
    ds_read_b128 a[68:71], v8 offset:23552
    v_rcp_f32 v33, v33
    v_mfma_f32_16x16x32_bf16 v[228:231], a[216:219], a[116:119], v[228:231]
    ds_read_b128 a[72:75], v10 offset:5120
    v_exp_f32 v35, v247
    v_mfma_f32_16x16x32_bf16 v[232:235], a[216:219], a[120:123], v[232:235]
    s_waitcnt vmcnt(33)
    ds_read_b128 a[76:79], v10 offset:23552
    v_mul_f32 v244, v244, v32
    v_mul_f32 v245, v245, v33
    v_cvt_pk_bf16_f32 v20, v244, v245
    v_mfma_f32_16x16x32_bf16 v[236:239], a[216:219], a[124:127], v[236:239]
    buffer_load_dwordx4 a[216:219], v3, s[8:11], s36 offen offset:3072
    ds_read_b128 a[80:83], v8 offset:6144
    v_add_f32 v34, 1.0, v34
    v_add_f32 v35, 1.0, v35
    v_mfma_f32_16x16x32_bf16 v[224:227], a[220:223], a[128:131], v[224:227]
    ds_read_b128 a[84:87], v8 offset:24576
    v_mul_f32 v248, v248, v14
    v_mul_f32 v249, v249, v14
    v_mfma_f32_16x16x32_bf16 v[228:231], a[220:223], a[132:135], v[228:231]
    ds_read_b128 a[88:91], v10 offset:6144
    v_rcp_f32 v34, v34
    v_mfma_f32_16x16x32_bf16 v[232:235], a[220:223], a[136:139], v[232:235]
    ds_read_b128 a[92:95], v10 offset:24576
    v_exp_f32 v32, v248
    v_mfma_f32_16x16x32_bf16 v[236:239], a[220:223], a[140:143], v[236:239]
    buffer_load_dwordx4 a[220:223], v4, s[8:11], s36 offen offset:0
    ds_read_b128 a[96:99], v8 offset:8192
    v_mfma_f32_16x16x32_bf16 v[224:227], a[224:227], a[144:147], v[224:227]
    ds_read_b128 a[100:103], v8 offset:26624
    v_rcp_f32 v35, v35
    v_mfma_f32_16x16x32_bf16 v[228:231], a[224:227], a[148:151], v[228:231]
    ds_read_b128 a[104:107], v10 offset:8192
    v_exp_f32 v33, v249
    v_mfma_f32_16x16x32_bf16 v[232:235], a[224:227], a[152:155], v[232:235]
    s_waitcnt vmcnt(33)
    ds_read_b128 a[108:111], v10 offset:26624
    v_mul_f32 v246, v246, v34
    v_mul_f32 v247, v247, v35
    v_cvt_pk_bf16_f32 v21, v246, v247
    v_mfma_f32_16x16x32_bf16 v[236:239], a[224:227], a[156:159], v[236:239]
    buffer_load_dwordx4 a[224:227], v4, s[8:11], s36 offen offset:1024
    ds_read_b128 a[112:115], v8 offset:9216
    v_add_f32 v32, 1.0, v32
    v_add_f32 v33, 1.0, v33
    v_mfma_f32_16x16x32_bf16 v[224:227], a[228:231], a[160:163], v[224:227]
    ds_read_b128 a[116:119], v8 offset:27648
    v_mul_f32 v250, v250, v14
    v_mul_f32 v251, v251, v14
    v_mfma_f32_16x16x32_bf16 v[228:231], a[228:231], a[164:167], v[228:231]
    ds_read_b128 a[120:123], v10 offset:9216
    v_rcp_f32 v32, v32
    v_mfma_f32_16x16x32_bf16 v[232:235], a[228:231], a[168:171], v[232:235]
    ds_read_b128 a[124:127], v10 offset:27648
    v_exp_f32 v34, v250
    v_mfma_f32_16x16x32_bf16 v[236:239], a[228:231], a[172:175], v[236:239]
    buffer_load_dwordx4 a[228:231], v4, s[8:11], s36 offen offset:2048
    ds_read_b128 a[128:131], v8 offset:10240
    v_mfma_f32_16x16x32_bf16 v[224:227], a[232:235], a[176:179], v[224:227]
    ds_read_b128 a[132:135], v8 offset:28672
    v_rcp_f32 v33, v33
    v_mfma_f32_16x16x32_bf16 v[228:231], a[232:235], a[180:183], v[228:231]
    ds_read_b128 a[136:139], v10 offset:10240
    v_exp_f32 v35, v251
    v_mfma_f32_16x16x32_bf16 v[232:235], a[232:235], a[184:187], v[232:235]
    s_waitcnt vmcnt(33)
    ds_read_b128 a[140:143], v10 offset:28672
    v_mul_f32 v248, v248, v32
    v_mul_f32 v249, v249, v33
    v_cvt_pk_bf16_f32 v24, v248, v249
    v_mfma_f32_16x16x32_bf16 v[236:239], a[232:235], v[48:51], v[236:239]
    buffer_load_dwordx4 a[232:235], v4, s[8:11], s36 offen offset:3072
    ds_read_b128 a[144:147], v8 offset:12288
    v_mfma_f32_16x16x32_bf16 v[224:227], a[236:239], v[52:55], v[224:227]
    ds_read_b128 a[148:151], v8 offset:30720
    v_add_f32 v34, 1.0, v34
    v_add_f32 v35, 1.0, v35
    v_mfma_f32_16x16x32_bf16 v[228:231], a[236:239], v[56:59], v[228:231]
    ds_read_b128 a[152:155], v10 offset:12288
    v_mul_f32 v252, v252, v15
    v_mul_f32 v253, v253, v15
    v_mfma_f32_16x16x32_bf16 v[232:235], a[236:239], v[60:63], v[232:235]
    ds_read_b128 a[156:159], v10 offset:30720
    v_rcp_f32 v34, v34
    v_mfma_f32_16x16x32_bf16 v[236:239], a[236:239], v[64:67], v[236:239]
    buffer_load_dwordx4 a[236:239], v5, s[8:11], s36 offen offset:0
    ds_read_b128 a[160:163], v8 offset:13312
    v_mfma_f32_16x16x32_bf16 v[224:227], a[240:243], v[68:71], v[224:227]
    ds_read_b128 a[164:167], v8 offset:31744
    v_exp_f32 v32, v252
    v_mfma_f32_16x16x32_bf16 v[228:231], a[240:243], v[72:75], v[228:231]
    ds_read_b128 a[168:171], v10 offset:13312
    v_rcp_f32 v35, v35
    v_mfma_f32_16x16x32_bf16 v[232:235], a[240:243], v[76:79], v[232:235]
    s_waitcnt vmcnt(33)
    ds_read_b128 a[172:175], v10 offset:31744
    v_exp_f32 v33, v253
    v_mfma_f32_16x16x32_bf16 v[236:239], a[240:243], v[80:83], v[236:239]
    buffer_load_dwordx4 a[240:243], v5, s[8:11], s36 offen offset:1024
    ds_read_b128 a[176:179], v8 offset:14336
    v_mfma_f32_16x16x32_bf16 v[224:227], a[244:247], v[84:87], v[224:227]
    ds_read_b128 a[180:183], v8 offset:32768
    v_mul_f32 v250, v250, v34
    v_mul_f32 v251, v251, v35
    v_cvt_pk_bf16_f32 v25, v250, v251
    v_mfma_f32_16x16x32_bf16 v[228:231], a[244:247], v[88:91], v[228:231]
    ds_read_b128 a[184:187], v10 offset:14336
    v_add_f32 v32, 1.0, v32
    v_add_f32 v33, 1.0, v33
    v_mfma_f32_16x16x32_bf16 v[232:235], a[244:247], v[92:95], v[232:235]
    ds_read_b128 v[48:51], v10 offset:32768
    v_mul_f32 v254, v254, v15
    v_mul_f32 v255, v255, v15
    v_mfma_f32_16x16x32_bf16 v[236:239], a[244:247], v[96:99], v[236:239]
    buffer_load_dwordx4 a[244:247], v5, s[8:11], s36 offen offset:2048
    ds_read_b128 v[52:55], v8 offset:16384
    v_mfma_f32_16x16x32_bf16 v[224:227], a[248:251], v[100:103], v[224:227]
    ds_read_b128 v[56:59], v8 offset:34816
    v_rcp_f32 v32, v32
    v_mfma_f32_16x16x32_bf16 v[228:231], a[248:251], v[104:107], v[228:231]
    ds_read_b128 v[60:63], v10 offset:16384
    v_exp_f32 v34, v254
    v_mfma_f32_16x16x32_bf16 v[232:235], a[248:251], v[108:111], v[232:235]
    s_waitcnt vmcnt(33)
    ds_read_b128 v[64:67], v10 offset:34816
    v_rcp_f32 v33, v33
    v_mfma_f32_16x16x32_bf16 v[236:239], a[248:251], v[112:115], v[236:239]
    buffer_load_dwordx4 a[248:251], v5, s[8:11], s36 offen offset:3072
    ds_read_b128 v[68:71], v8 offset:17408
    v_mfma_f32_16x16x32_bf16 v[224:227], a[252:255], v[116:119], v[224:227]
    ds_read_b128 v[72:75], v8 offset:35840
    v_exp_f32 v35, v255
    v_mfma_f32_16x16x32_bf16 v[228:231], a[252:255], v[120:123], v[228:231]
L_tp22:
    s_cbranch_execz L_tret
    ds_read_b128 v[76:79], v10 offset:17408
    v_mul_f32 v252, v252, v32
    v_mul_f32 v253, v253, v33
    v_cvt_pk_bf16_f32 v28, v252, v253
    v_mfma_f32_16x16x32_bf16 v[232:235], a[252:255], v[124:127], v[232:235]
    ds_read_b128 v[80:83], v10 offset:35840
    v_add_f32 v34, 1.0, v34
    v_add_f32 v35, 1.0, v35
    v_mfma_f32_16x16x32_bf16 v[236:239], a[252:255], v[128:131], v[236:239]
    buffer_load_dwordx4 a[252:255], v6, s[8:11], s36 offen offset:0
    v_mfma_f32_16x16x32_bf16 v[224:227], v[148:151], v[132:135], v[224:227]
    v_rcp_f32 v34, v34
    v_mfma_f32_16x16x32_bf16 v[228:231], v[148:151], v[136:139], v[228:231]
    v_rcp_f32 v35, v35
    v_mfma_f32_16x16x32_bf16 v[232:235], v[148:151], v[140:143], v[232:235]
    s_waitcnt vmcnt(33)
    v_mul_f32 v254, v254, v34
    v_mul_f32 v255, v255, v35
    v_cvt_pk_bf16_f32 v29, v254, v255
    v_mfma_f32_16x16x32_bf16 v[236:239], v[148:151], v[144:147], v[236:239]
    s_waitcnt lgkmcnt(15)
    buffer_load_dwordx4 v[148:151], v6, s[8:11], s36 offen offset:1024
    v_mfma_f32_16x16x32_bf16 v[240:243], v[152:155], a[0:3], 0
    s_add_u32 s36, s36, 36864
    v_mul_f32 v84, v224, v12
    v_mul_f32 v85, v225, v12
    v_mfma_f32_16x16x32_bf16 v[244:247], v[152:155], a[4:7], 0
    v_exp_f32 v32, v84
    v_mfma_f32_16x16x32_bf16 v[248:251], v[152:155], a[8:11], 0
    v_mul_f32 v86, v226, v12
    v_mul_f32 v87, v227, v12
    v_mfma_f32_16x16x32_bf16 v[252:255], v[152:155], a[12:15], 0
    buffer_load_dwordx4 v[152:155], v2, s[8:11], s37 offen offset:0
    v_mfma_f32_16x16x32_bf16 v[240:243], v[156:159], a[16:19], v[240:243]
    v_exp_f32 v33, v85
    v_mfma_f32_16x16x32_bf16 v[244:247], v[156:159], a[20:23], v[244:247]
    v_mul_f32 v88, v228, v13
    v_mul_f32 v89, v229, v13
    v_mfma_f32_16x16x32_bf16 v[248:251], v[156:159], a[24:27], v[248:251]
    s_waitcnt vmcnt(33)
    v_add_f32 v32, 1.0, v32
    v_add_f32 v33, 1.0, v33
    v_mfma_f32_16x16x32_bf16 v[252:255], v[156:159], a[28:31], v[252:255]
    buffer_load_dwordx4 v[156:159], v2, s[8:11], s37 offen offset:1024
    v_mfma_f32_16x16x32_bf16 v[240:243], v[160:163], a[32:35], v[240:243]
    v_mul_f32 v90, v230, v13
    v_mul_f32 v91, v231, v13
    v_mfma_f32_16x16x32_bf16 v[244:247], v[160:163], a[36:39], v[244:247]
    v_rcp_f32 v32, v32
    v_mfma_f32_16x16x32_bf16 v[248:251], v[160:163], a[40:43], v[248:251]
    v_exp_f32 v34, v86
    v_mfma_f32_16x16x32_bf16 v[252:255], v[160:163], a[44:47], v[252:255]
    buffer_load_dwordx4 v[160:163], v2, s[8:11], s37 offen offset:2048
    v_mfma_f32_16x16x32_bf16 v[240:243], v[164:167], a[48:51], v[240:243]
    v_rcp_f32 v33, v33
    v_mfma_f32_16x16x32_bf16 v[244:247], v[164:167], a[52:55], v[244:247]
    v_exp_f32 v35, v87
    v_mfma_f32_16x16x32_bf16 v[248:251], v[164:167], a[56:59], v[248:251]
    s_waitcnt vmcnt(33)
    v_mul_f32 v84, v84, v32
    v_mul_f32 v85, v85, v33
    v_mfma_f32_16x16x32_bf16 v[252:255], v[164:167], a[60:63], v[252:255]
    buffer_load_dwordx4 v[164:167], v2, s[8:11], s37 offen offset:3072
    v_mfma_f32_16x16x32_bf16 v[240:243], v[168:171], a[64:67], v[240:243]
    v_add_f32 v34, 1.0, v34
    v_add_f32 v35, 1.0, v35
    v_mfma_f32_16x16x32_bf16 v[244:247], v[168:171], a[68:71], v[244:247]
    v_mul_f32 v92, v232, v14
    v_mul_f32 v93, v233, v14
    v_mfma_f32_16x16x32_bf16 v[248:251], v[168:171], a[72:75], v[248:251]
    v_rcp_f32 v34, v34
    v_mfma_f32_16x16x32_bf16 v[252:255], v[168:171], a[76:79], v[252:255]
    buffer_load_dwordx4 v[168:171], v3, s[8:11], s37 offen offset:0
    v_mfma_f32_16x16x32_bf16 v[240:243], v[172:175], a[80:83], v[240:243]
    v_exp_f32 v32, v88
    v_mfma_f32_16x16x32_bf16 v[244:247], v[172:175], a[84:87], v[244:247]
    v_rcp_f32 v35, v35
    v_mfma_f32_16x16x32_bf16 v[248:251], v[172:175], a[88:91], v[248:251]
    s_waitcnt vmcnt(33)
    v_exp_f32 v33, v89
    v_mfma_f32_16x16x32_bf16 v[252:255], v[172:175], a[92:95], v[252:255]
    buffer_load_dwordx4 v[172:175], v3, s[8:11], s37 offen offset:1024
    v_mfma_f32_16x16x32_bf16 v[240:243], v[176:179], a[96:99], v[240:243]
    v_mul_f32 v86, v86, v34
    v_mul_f32 v87, v87, v35
    v_mfma_f32_16x16x32_bf16 v[244:247], v[176:179], a[100:103], v[244:247]
    v_add_f32 v32, 1.0, v32
    v_add_f32 v33, 1.0, v33
    v_mfma_f32_16x16x32_bf16 v[248:251], v[176:179], a[104:107], v[248:251]
    v_cvt_pk_bf16_f32 v18, v84, v85
    v_cvt_pk_bf16_f32 v19, v86, v87
    v_mfma_f32_16x16x32_bf16 v[252:255], v[176:179], a[108:111], v[252:255]
    buffer_load_dwordx4 v[176:179], v3, s[8:11], s37 offen offset:2048
    v_mfma_f32_16x16x32_bf16 v[240:243], v[180:183], a[112:115], v[240:243]
    ds_write_b128 v40, v[16:19] offset:0
    v_mfma_f32_16x16x32_bf16 v[244:247], v[180:183], a[116:119], v[244:247]
    v_mul_f32 v94, v234, v14
    v_mul_f32 v95, v235, v14
    v_mfma_f32_16x16x32_bf16 v[248:251], v[180:183], a[120:123], v[248:251]
    s_waitcnt vmcnt(33)
    v_rcp_f32 v32, v32
    v_mfma_f32_16x16x32_bf16 v[252:255], v[180:183], a[124:127], v[252:255]
    buffer_load_dwordx4 v[180:183], v3, s[8:11], s37 offen offset:3072
    v_mfma_f32_16x16x32_bf16 v[240:243], v[184:187], a[128:131], v[240:243]
    v_exp_f32 v34, v90
    v_mfma_f32_16x16x32_bf16 v[244:247], v[184:187], a[132:135], v[244:247]
    v_rcp_f32 v33, v33
    v_mfma_f32_16x16x32_bf16 v[248:251], v[184:187], a[136:139], v[248:251]
    v_exp_f32 v35, v91
    v_mfma_f32_16x16x32_bf16 v[252:255], v[184:187], a[140:143], v[252:255]
    buffer_load_dwordx4 v[184:187], v4, s[8:11], s37 offen offset:0
    v_mfma_f32_16x16x32_bf16 v[240:243], v[188:191], a[144:147], v[240:243]
    v_mul_f32 v88, v88, v32
    v_mul_f32 v89, v89, v33
    v_mfma_f32_16x16x32_bf16 v[244:247], v[188:191], a[148:151], v[244:247]
    v_add_f32 v34, 1.0, v34
    v_add_f32 v35, 1.0, v35
    v_mfma_f32_16x16x32_bf16 v[248:251], v[188:191], a[152:155], v[248:251]
    s_waitcnt vmcnt(33)
    v_mul_f32 v96, v236, v15
    v_mul_f32 v97, v237, v15
    v_mfma_f32_16x16x32_bf16 v[252:255], v[188:191], a[156:159], v[252:255]
    buffer_load_dwordx4 v[188:191], v4, s[8:11], s37 offen offset:1024
    v_mfma_f32_16x16x32_bf16 v[240:243], v[192:195], a[160:163], v[240:243]
    s_waitcnt lgkmcnt(15)
    v_rcp_f32 v34, v34
    v_mfma_f32_16x16x32_bf16 v[244:247], v[192:195], a[164:167], v[244:247]
    s_waitcnt lgkmcnt(14)
    v_exp_f32 v32, v92
    v_mfma_f32_16x16x32_bf16 v[248:251], v[192:195], a[168:171], v[248:251]
    s_waitcnt lgkmcnt(13)
    v_rcp_f32 v35, v35
    v_mfma_f32_16x16x32_bf16 v[252:255], v[192:195], a[172:175], v[252:255]
    s_waitcnt lgkmcnt(12)
    buffer_load_dwordx4 v[192:195], v4, s[8:11], s37 offen offset:2048
    v_mfma_f32_16x16x32_bf16 v[240:243], v[196:199], a[176:179], v[240:243]
    s_waitcnt lgkmcnt(11)
    v_exp_f32 v33, v93
    v_mfma_f32_16x16x32_bf16 v[244:247], v[196:199], a[180:183], v[244:247]
    s_waitcnt lgkmcnt(10)
    v_mul_f32 v90, v90, v34
    v_mul_f32 v91, v91, v35
    v_mfma_f32_16x16x32_bf16 v[248:251], v[196:199], a[184:187], v[248:251]
    s_waitcnt lgkmcnt(9) vmcnt(33)
    v_add_f32 v32, 1.0, v32
    v_add_f32 v33, 1.0, v33
    v_mfma_f32_16x16x32_bf16 v[252:255], v[196:199], v[48:51], v[252:255]
    s_waitcnt lgkmcnt(8)
    buffer_load_dwordx4 v[196:199], v4, s[8:11], s37 offen offset:3072
    v_mfma_f32_16x16x32_bf16 v[240:243], v[200:203], v[52:55], v[240:243]
    s_waitcnt lgkmcnt(7)
    v_cvt_pk_bf16_f32 v22, v88, v89
    v_cvt_pk_bf16_f32 v23, v90, v91
    v_mfma_f32_16x16x32_bf16 v[244:247], v[200:203], v[56:59], v[244:247]
    s_waitcnt lgkmcnt(6)
    ds_write_b128 v40, v[20:23] offset:18432
    v_mfma_f32_16x16x32_bf16 v[248:251], v[200:203], v[60:63], v[248:251]
    s_waitcnt lgkmcnt(6)
    v_mul_f32 v98, v238, v15
    v_mul_f32 v99, v239, v15
    v_mfma_f32_16x16x32_bf16 v[252:255], v[200:203], v[64:67], v[252:255]
    s_waitcnt lgkmcnt(5)
    buffer_load_dwordx4 v[200:203], v5, s[8:11], s37 offen offset:0
    v_mfma_f32_16x16x32_bf16 v[240:243], v[204:207], v[68:71], v[240:243]
    s_waitcnt lgkmcnt(4)
    v_rcp_f32 v32, v32
    v_mfma_f32_16x16x32_bf16 v[244:247], v[204:207], v[72:75], v[244:247]
    s_waitcnt lgkmcnt(3)
    v_exp_f32 v34, v94
    v_mfma_f32_16x16x32_bf16 v[248:251], v[204:207], v[76:79], v[248:251]
L_tp23:
    s_cbranch_execz L_tret
    s_waitcnt lgkmcnt(2) vmcnt(29)
    v_rcp_f32 v33, v33
    v_mfma_f32_16x16x32_bf16 v[252:255], v[204:207], v[80:83], v[252:255]
    buffer_load_dwordx4 v[204:207], v5, s[8:11], s37 offen offset:1024
    v_mfma_f32_16x16x32_bf16 v[224:227], a[188:191], a[0:3], 0
    v_exp_f32 v35, v95
    v_mfma_f32_16x16x32_bf16 v[228:231], a[188:191], a[4:7], 0
    v_mul_f32 v92, v92, v32
    v_mul_f32 v93, v93, v33
    v_mfma_f32_16x16x32_bf16 v[232:235], a[188:191], a[8:11], 0
    v_add_f32 v34, 1.0, v34
    v_add_f32 v35, 1.0, v35
    v_mfma_f32_16x16x32_bf16 v[236:239], a[188:191], a[12:15], 0
    buffer_load_dwordx4 a[188:191], v2, s[8:11], s36 offen offset:0
    v_mfma_f32_16x16x32_bf16 v[224:227], a[192:195], a[16:19], v[224:227]
    v_rcp_f32 v34, v34
    v_mfma_f32_16x16x32_bf16 v[228:231], a[192:195], a[20:23], v[228:231]
    v_exp_f32 v32, v96
    v_mfma_f32_16x16x32_bf16 v[232:235], a[192:195], a[24:27], v[232:235]
    s_waitcnt vmcnt(29)
    v_rcp_f32 v35, v35
    v_mfma_f32_16x16x32_bf16 v[236:239], a[192:195], a[28:31], v[236:239]
    buffer_load_dwordx4 a[192:195], v2, s[8:11], s36 offen offset:1024
    v_mfma_f32_16x16x32_bf16 v[224:227], a[196:199], a[32:35], v[224:227]
    v_exp_f32 v33, v97
    v_mfma_f32_16x16x32_bf16 v[228:231], a[196:199], a[36:39], v[228:231]
    v_mul_f32 v94, v94, v34
    v_mul_f32 v95, v95, v35
    v_mfma_f32_16x16x32_bf16 v[232:235], a[196:199], a[40:43], v[232:235]
    v_add_f32 v32, 1.0, v32
    v_add_f32 v33, 1.0, v33
    v_mfma_f32_16x16x32_bf16 v[236:239], a[196:199], a[44:47], v[236:239]
    buffer_load_dwordx4 a[196:199], v2, s[8:11], s36 offen offset:2048
    v_mfma_f32_16x16x32_bf16 v[224:227], a[200:203], a[48:51], v[224:227]
    v_cvt_pk_bf16_f32 v26, v92, v93
    v_cvt_pk_bf16_f32 v27, v94, v95
    v_mfma_f32_16x16x32_bf16 v[228:231], a[200:203], a[52:55], v[228:231]
    ds_write_b128 v40, v[24:27] offset:36864
    v_mfma_f32_16x16x32_bf16 v[232:235], a[200:203], a[56:59], v[232:235]
    s_waitcnt vmcnt(29)
    v_rcp_f32 v32, v32
    v_mfma_f32_16x16x32_bf16 v[236:239], a[200:203], a[60:63], v[236:239]
    buffer_load_dwordx4 a[200:203], v2, s[8:11], s36 offen offset:3072
    v_mfma_f32_16x16x32_bf16 v[224:227], a[204:207], a[64:67], v[224:227]
    v_exp_f32 v34, v98
    v_mfma_f32_16x16x32_bf16 v[228:231], a[204:207], a[68:71], v[228:231]
    v_rcp_f32 v33, v33
    v_mfma_f32_16x16x32_bf16 v[232:235], a[204:207], a[72:75], v[232:235]
    v_exp_f32 v35, v99
    v_mfma_f32_16x16x32_bf16 v[236:239], a[204:207], a[76:79], v[236:239]
    buffer_load_dwordx4 a[204:207], v3, s[8:11], s36 offen offset:0
    v_mfma_f32_16x16x32_bf16 v[224:227], a[208:211], a[80:83], v[224:227]
    v_mul_f32 v96, v96, v32
    v_mul_f32 v97, v97, v33
    v_mfma_f32_16x16x32_bf16 v[228:231], a[208:211], a[84:87], v[228:231]
    v_add_f32 v34, 1.0, v34
    v_add_f32 v35, 1.0, v35
    v_mfma_f32_16x16x32_bf16 v[232:235], a[208:211], a[88:91], v[232:235]
    s_waitcnt vmcnt(29)
    v_rcp_f32 v34, v34
    v_mfma_f32_16x16x32_bf16 v[236:239], a[208:211], a[92:95], v[236:239]
    buffer_load_dwordx4 a[208:211], v3, s[8:11], s36 offen offset:1024
    v_mfma_f32_16x16x32_bf16 v[224:227], a[212:215], a[96:99], v[224:227]
    v_rcp_f32 v35, v35
    v_mfma_f32_16x16x32_bf16 v[228:231], a[212:215], a[100:103], v[228:231]
    v_mul_f32 v98, v98, v34
    v_mul_f32 v99, v99, v35
    v_mfma_f32_16x16x32_bf16 v[232:235], a[212:215], a[104:107], v[232:235]
    v_cvt_pk_bf16_f32 v30, v96, v97
    v_cvt_pk_bf16_f32 v31, v98, v99
    v_mfma_f32_16x16x32_bf16 v[236:239], a[212:215], a[108:111], v[236:239]
    buffer_load_dwordx4 a[212:215], v3, s[8:11], s36 offen offset:2048
    v_mfma_f32_16x16x32_bf16 v[224:227], a[216:219], a[112:115], v[224:227]
    ds_write_b128 v40, v[28:31] offset:55296
    v_mfma_f32_16x16x32_bf16 v[228:231], a[216:219], a[116:119], v[228:231]
    v_mfma_f32_16x16x32_bf16 v[232:235], a[216:219], a[120:123], v[232:235]
    s_waitcnt vmcnt(29)
    v_mfma_f32_16x16x32_bf16 v[236:239], a[216:219], a[124:127], v[236:239]
    buffer_load_dwordx4 a[216:219], v3, s[8:11], s36 offen offset:3072
    v_mfma_f32_16x16x32_bf16 v[224:227], a[220:223], a[128:131], v[224:227]
    v_mfma_f32_16x16x32_bf16 v[228:231], a[220:223], a[132:135], v[228:231]
    s_waitcnt lgkmcnt(0)
    s_barrier
    v_mfma_f32_16x16x32_bf16 v[232:235], a[220:223], a[136:139], v[232:235]
    ds_read_b128 v[84:87], v8 offset:3072
    v_mfma_f32_16x16x32_bf16 v[236:239], a[220:223], a[140:143], v[236:239]
    buffer_load_dwordx4 a[220:223], v4, s[8:11], s36 offen offset:0
    ds_read_b128 v[88:91], v8 offset:21504
    v_mfma_f32_16x16x32_bf16 v[224:227], a[224:227], a[144:147], v[224:227]
    ds_read_b128 v[92:95], v10 offset:3072
    v_mfma_f32_16x16x32_bf16 v[228:231], a[224:227], a[148:151], v[228:231]
    ds_read_b128 v[96:99], v10 offset:21504
    v_mfma_f32_16x16x32_bf16 v[232:235], a[224:227], a[152:155], v[232:235]
    s_waitcnt vmcnt(29)
    ds_read_b128 v[100:103], v8 offset:7168
    v_mfma_f32_16x16x32_bf16 v[236:239], a[224:227], a[156:159], v[236:239]
    buffer_load_dwordx4 a[224:227], v4, s[8:11], s36 offen offset:1024
    ds_read_b128 v[104:107], v8 offset:25600
    v_mfma_f32_16x16x32_bf16 v[224:227], a[228:231], a[160:163], v[224:227]
    ds_read_b128 v[108:111], v10 offset:7168
    v_mfma_f32_16x16x32_bf16 v[228:231], a[228:231], a[164:167], v[228:231]
    ds_read_b128 v[112:115], v10 offset:25600
    v_mfma_f32_16x16x32_bf16 v[232:235], a[228:231], a[168:171], v[232:235]
    ds_read_b128 v[116:119], v8 offset:11264
    v_mfma_f32_16x16x32_bf16 v[236:239], a[228:231], a[172:175], v[236:239]
    ds_read_b128 v[120:123], v8 offset:29696
    v_mfma_f32_16x16x32_bf16 v[224:227], a[232:235], a[176:179], v[224:227]
    ds_read_b128 v[124:127], v10 offset:11264
    v_mfma_f32_16x16x32_bf16 v[228:231], a[232:235], a[180:183], v[228:231]
    ds_read_b128 v[128:131], v10 offset:29696
    v_mfma_f32_16x16x32_bf16 v[232:235], a[232:235], a[184:187], v[232:235]
    s_waitcnt vmcnt(28)
    ds_read_b128 v[132:135], v8 offset:15360
    v_mfma_f32_16x16x32_bf16 v[236:239], a[232:235], v[48:51], v[236:239]
    buffer_load_dwordx4 a[228:231], v4, s[8:11], s36 offen offset:2048
    ds_read_b128 v[136:139], v8 offset:33792
    v_mfma_f32_16x16x32_bf16 v[224:227], a[236:239], v[52:55], v[224:227]
    ds_read_b128 v[140:143], v10 offset:15360
    v_mfma_f32_16x16x32_bf16 v[228:231], a[236:239], v[56:59], v[228:231]
    ds_read_b128 v[144:147], v10 offset:33792
    v_mfma_f32_16x16x32_bf16 v[232:235], a[236:239], v[60:63], v[232:235]
    v_mfma_f32_16x16x32_bf16 v[236:239], a[236:239], v[64:67], v[236:239]
    buffer_load_dwordx4 a[232:235], v4, s[8:11], s36 offen offset:3072
    v_mfma_f32_16x16x32_bf16 v[224:227], a[240:243], v[68:71], v[224:227]
    v_mfma_f32_16x16x32_bf16 v[228:231], a[240:243], v[72:75], v[228:231]
    v_mfma_f32_16x16x32_bf16 v[232:235], a[240:243], v[76:79], v[232:235]
    s_waitcnt vmcnt(46)
    v_mfma_f32_16x16x32_bf16 v[236:239], a[240:243], v[80:83], v[236:239]
    s_waitcnt lgkmcnt(15)
    buffer_load_dwordx4 a[236:239], v5, s[8:11], s36 offen offset:0
    v_mfma_f32_16x16x32_bf16 v[240:243], v[208:211], v[84:87], v[240:243]
    s_waitcnt lgkmcnt(14)
    v_mfma_f32_16x16x32_bf16 v[244:247], v[208:211], v[88:91], v[244:247]
    s_waitcnt lgkmcnt(13)
    v_mfma_f32_16x16x32_bf16 v[248:251], v[208:211], v[92:95], v[248:251]
    s_waitcnt lgkmcnt(12)
    v_mfma_f32_16x16x32_bf16 v[252:255], v[208:211], v[96:99], v[252:255]
    s_waitcnt lgkmcnt(11)
    buffer_load_dwordx4 v[208:211], v5, s[8:11], s37 offen offset:2048
    v_mfma_f32_16x16x32_bf16 v[240:243], v[212:215], v[100:103], v[240:243]
    s_waitcnt lgkmcnt(10)
    v_mfma_f32_16x16x32_bf16 v[244:247], v[212:215], v[104:107], v[244:247]
    s_waitcnt lgkmcnt(9)
    v_mfma_f32_16x16x32_bf16 v[248:251], v[212:215], v[108:111], v[248:251]
    s_waitcnt lgkmcnt(8) vmcnt(46)
    v_mfma_f32_16x16x32_bf16 v[252:255], v[212:215], v[112:115], v[252:255]
    s_waitcnt lgkmcnt(7)
    buffer_load_dwordx4 v[212:215], v5, s[8:11], s37 offen offset:3072
    v_mfma_f32_16x16x32_bf16 v[240:243], v[216:219], v[116:119], v[240:243]
    s_waitcnt lgkmcnt(6)
L_tp24:
    s_cbranch_execz L_tret
    v_mfma_f32_16x16x32_bf16 v[244:247], v[216:219], v[120:123], v[244:247]
    s_waitcnt lgkmcnt(5)
    v_mfma_f32_16x16x32_bf16 v[248:251], v[216:219], v[124:127], v[248:251]
    s_waitcnt lgkmcnt(4)
    v_mfma_f32_16x16x32_bf16 v[252:255], v[216:219], v[128:131], v[252:255]
    s_waitcnt lgkmcnt(3)
    buffer_load_dwordx4 v[216:219], v6, s[8:11], s37 offen offset:0
    v_mfma_f32_16x16x32_bf16 v[240:243], v[220:223], v[132:135], v[240:243]
    s_waitcnt lgkmcnt(2)
    v_mfma_f32_16x16x32_bf16 v[244:247], v[220:223], v[136:139], v[244:247]
    s_waitcnt lgkmcnt(1)
    v_mfma_f32_16x16x32_bf16 v[248:251], v[220:223], v[140:143], v[248:251]
    s_waitcnt lgkmcnt(0) vmcnt(32)
    v_mfma_f32_16x16x32_bf16 v[252:255], v[220:223], v[144:147], v[252:255]
    buffer_load_dwordx4 v[220:223], v6, s[8:11], s37 offen offset:1024
    v_mfma_f32_16x16x32_bf16 v[224:227], a[244:247], v[84:87], v[224:227]
    s_add_u32 s37, s37, 36864
    v_mfma_f32_16x16x32_bf16 v[228:231], a[244:247], v[88:91], v[228:231]
    v_cvt_pk_bf16_f32 v24, v240, v241
    v_cvt_pk_bf16_f32 v25, v242, v243
    v_mfma_f32_16x16x32_bf16 v[232:235], a[244:247], v[92:95], v[232:235]
    buffer_store_dwordx2 v[24:25], v36, s[8:11], s41 offen offset:0 sc1
    v_mfma_f32_16x16x32_bf16 v[236:239], a[244:247], v[96:99], v[236:239]
    buffer_load_dwordx4 a[240:243], v5, s[8:11], s36 offen offset:1024
    v_mfma_f32_16x16x32_bf16 v[224:227], a[248:251], v[100:103], v[224:227]
    v_cvt_pk_bf16_f32 v26, v244, v245
    v_cvt_pk_bf16_f32 v27, v246, v247
    v_mfma_f32_16x16x32_bf16 v[228:231], a[248:251], v[104:107], v[228:231]
    buffer_store_dwordx2 v[26:27], v36, s[8:11], s41 offen offset:2048 sc1
    v_mfma_f32_16x16x32_bf16 v[232:235], a[248:251], v[108:111], v[232:235]
    s_waitcnt vmcnt(34)
    s_add_u32 s41, s41, 4096
    v_cvt_pk_bf16_f32 v28, v248, v249
    v_cvt_pk_bf16_f32 v29, v250, v251
    v_mfma_f32_16x16x32_bf16 v[236:239], a[248:251], v[112:115], v[236:239]
    buffer_load_dwordx4 a[244:247], v5, s[8:11], s36 offen offset:2048
    v_mfma_f32_16x16x32_bf16 v[224:227], a[252:255], v[116:119], v[224:227]
    buffer_store_dwordx2 v[28:29], v36, s[8:11], s41 offen offset:0 sc1
    v_mfma_f32_16x16x32_bf16 v[228:231], a[252:255], v[120:123], v[228:231]
    v_cvt_pk_bf16_f32 v30, v252, v253
    v_cvt_pk_bf16_f32 v31, v254, v255
    v_mfma_f32_16x16x32_bf16 v[232:235], a[252:255], v[124:127], v[232:235]
    buffer_store_dwordx2 v[30:31], v36, s[8:11], s41 offen offset:2048 sc1
    v_mfma_f32_16x16x32_bf16 v[236:239], a[252:255], v[128:131], v[236:239]
    buffer_load_dwordx4 a[248:251], v5, s[8:11], s36 offen offset:3072
    v_mfma_f32_16x16x32_bf16 v[224:227], v[148:151], v[132:135], v[224:227]
    v_mfma_f32_16x16x32_bf16 v[228:231], v[148:151], v[136:139], v[228:231]
    v_mfma_f32_16x16x32_bf16 v[232:235], v[148:151], v[140:143], v[232:235]
    s_waitcnt vmcnt(36)
    v_mfma_f32_16x16x32_bf16 v[236:239], v[148:151], v[144:147], v[236:239]
    buffer_load_dwordx4 a[252:255], v6, s[8:11], s36 offen offset:0
    v_mfma_f32_16x16x32_bf16 v[240:243], v[152:155], a[0:3], 0
    v_mfma_f32_16x16x32_bf16 v[244:247], v[152:155], a[4:7], 0
    s_nop 0
    v_cvt_pk_bf16_f32 v16, v224, v225
    v_cvt_pk_bf16_f32 v17, v226, v227
    v_mfma_f32_16x16x32_bf16 v[248:251], v[152:155], a[8:11], 0
    v_cvt_pk_bf16_f32 v18, v228, v229
    v_cvt_pk_bf16_f32 v19, v230, v231
    v_mfma_f32_16x16x32_bf16 v[252:255], v[152:155], a[12:15], 0
    v_mfma_f32_16x16x32_bf16 v[240:243], v[156:159], a[16:19], v[240:243]
    buffer_store_dwordx4 v[16:19], v2, s[8:11], s40 offen offset:0 sc1
    v_mfma_f32_16x16x32_bf16 v[244:247], v[156:159], a[20:23], v[244:247]
    v_mfma_f32_16x16x32_bf16 v[248:251], v[156:159], a[24:27], v[248:251]
    s_waitcnt vmcnt(36)
    v_cvt_pk_bf16_f32 v20, v232, v233
    v_cvt_pk_bf16_f32 v21, v234, v235
    v_mfma_f32_16x16x32_bf16 v[252:255], v[156:159], a[28:31], v[252:255]
    v_mfma_f32_16x16x32_bf16 v[240:243], v[160:163], a[32:35], v[240:243]
    v_cvt_pk_bf16_f32 v22, v236, v237
    v_cvt_pk_bf16_f32 v23, v238, v239
    v_mfma_f32_16x16x32_bf16 v[244:247], v[160:163], a[36:39], v[244:247]
    buffer_store_dwordx4 v[20:23], v2, s[8:11], s40 offen offset:1024 sc1
    v_mfma_f32_16x16x32_bf16 v[248:251], v[160:163], a[40:43], v[248:251]
    s_add_u32 s40, s40, 8192
    v_mfma_f32_16x16x32_bf16 v[252:255], v[160:163], a[44:47], v[252:255]
    buffer_load_dwordx4 v[160:163], v6, s[8:11], s36 offen offset:1024
    v_mfma_f32_16x16x32_bf16 v[240:243], v[164:167], a[48:51], v[240:243]
    s_add_u32 s36, s36, 36864
    v_mfma_f32_16x16x32_bf16 v[244:247], v[164:167], a[52:55], v[244:247]
    v_mfma_f32_16x16x32_bf16 v[248:251], v[164:167], a[56:59], v[248:251]
    s_waitcnt vmcnt(36)
    v_mfma_f32_16x16x32_bf16 v[252:255], v[164:167], a[60:63], v[252:255]
    v_mfma_f32_16x16x32_bf16 v[240:243], v[168:171], a[64:67], v[240:243]
    v_mfma_f32_16x16x32_bf16 v[244:247], v[168:171], a[68:71], v[244:247]
    v_mfma_f32_16x16x32_bf16 v[248:251], v[168:171], a[72:75], v[248:251]
    v_mfma_f32_16x16x32_bf16 v[252:255], v[168:171], a[76:79], v[252:255]
    buffer_load_dwordx4 v[164:167], v2, s[8:11], s37 offen offset:0
    v_mfma_f32_16x16x32_bf16 v[240:243], v[172:175], a[80:83], v[240:243]
    v_mfma_f32_16x16x32_bf16 v[244:247], v[172:175], a[84:87], v[244:247]
    v_mfma_f32_16x16x32_bf16 v[248:251], v[172:175], a[88:91], v[248:251]
    s_waitcnt vmcnt(35)
    v_mfma_f32_16x16x32_bf16 v[252:255], v[172:175], a[92:95], v[252:255]
    buffer_load_dwordx4 v[168:171], v2, s[8:11], s37 offen offset:1024
    v_mfma_f32_16x16x32_bf16 v[240:243], v[176:179], a[96:99], v[240:243]
    v_mfma_f32_16x16x32_bf16 v[244:247], v[176:179], a[100:103], v[244:247]
    v_mfma_f32_16x16x32_bf16 v[248:251], v[176:179], a[104:107], v[248:251]
    v_mfma_f32_16x16x32_bf16 v[252:255], v[176:179], a[108:111], v[252:255]
    buffer_load_dwordx4 v[172:175], v2, s[8:11], s37 offen offset:2048
    v_mfma_f32_16x16x32_bf16 v[240:243], v[180:183], a[112:115], v[240:243]
    v_mfma_f32_16x16x32_bf16 v[244:247], v[180:183], a[116:119], v[244:247]
    v_mfma_f32_16x16x32_bf16 v[248:251], v[180:183], a[120:123], v[248:251]
    s_waitcnt vmcnt(35)
    v_mfma_f32_16x16x32_bf16 v[252:255], v[180:183], a[124:127], v[252:255]
    buffer_load_dwordx4 v[176:179], v2, s[8:11], s37 offen offset:3072
    v_mfma_f32_16x16x32_bf16 v[240:243], v[184:187], a[128:131], v[240:243]
    v_mfma_f32_16x16x32_bf16 v[244:247], v[184:187], a[132:135], v[244:247]
    v_mfma_f32_16x16x32_bf16 v[248:251], v[184:187], a[136:139], v[248:251]
    v_mfma_f32_16x16x32_bf16 v[252:255], v[184:187], a[140:143], v[252:255]
    buffer_load_dwordx4 v[180:183], v3, s[8:11], s37 offen offset:0
    v_mfma_f32_16x16x32_bf16 v[240:243], v[188:191], a[144:147], v[240:243]
    v_mfma_f32_16x16x32_bf16 v[244:247], v[188:191], a[148:151], v[244:247]
    v_mfma_f32_16x16x32_bf16 v[248:251], v[188:191], a[152:155], v[248:251]
    s_waitcnt vmcnt(35)
    v_mfma_f32_16x16x32_bf16 v[252:255], v[188:191], a[156:159], v[252:255]
    v_mfma_f32_16x16x32_bf16 v[240:243], v[192:195], a[160:163], v[240:243]
    v_mfma_f32_16x16x32_bf16 v[244:247], v[192:195], a[164:167], v[244:247]
    v_mfma_f32_16x16x32_bf16 v[248:251], v[192:195], a[168:171], v[248:251]
    v_mfma_f32_16x16x32_bf16 v[252:255], v[192:195], a[172:175], v[252:255]
    buffer_load_dwordx4 v[184:187], v3, s[8:11], s37 offen offset:1024
    v_mfma_f32_16x16x32_bf16 v[240:243], v[196:199], a[176:179], v[240:243]
    v_mfma_f32_16x16x32_bf16 v[244:247], v[196:199], a[180:183], v[244:247]
    v_mfma_f32_16x16x32_bf16 v[248:251], v[196:199], a[184:187], v[248:251]
    s_waitcnt vmcnt(34)
    v_mfma_f32_16x16x32_bf16 v[252:255], v[196:199], v[48:51], v[252:255]
    buffer_load_dwordx4 v[188:191], v3, s[8:11], s37 offen offset:2048
    v_mfma_f32_16x16x32_bf16 v[240:243], v[200:203], v[52:55], v[240:243]
    v_mfma_f32_16x16x32_bf16 v[244:247], v[200:203], v[56:59], v[244:247]
    v_mfma_f32_16x16x32_bf16 v[248:251], v[200:203], v[60:63], v[248:251]
    v_mfma_f32_16x16x32_bf16 v[252:255], v[200:203], v[64:67], v[252:255]
    buffer_load_dwordx4 v[192:195], v3, s[8:11], s37 offen offset:3072
    v_mfma_f32_16x16x32_bf16 v[240:243], v[204:207], v[68:71], v[240:243]
    v_mfma_f32_16x16x32_bf16 v[244:247], v[204:207], v[72:75], v[244:247]
    v_mfma_f32_16x16x32_bf16 v[248:251], v[204:207], v[76:79], v[248:251]
    s_waitcnt vmcnt(21)
    v_mfma_f32_16x16x32_bf16 v[252:255], v[204:207], v[80:83], v[252:255]
L_tp25:
    s_cbranch_execz L_tret
    buffer_load_dwordx4 v[196:199], v4, s[8:11], s37 offen offset:0
    v_mfma_f32_16x16x32_bf16 v[240:243], v[208:211], v[84:87], v[240:243]
    v_mfma_f32_16x16x32_bf16 v[244:247], v[208:211], v[88:91], v[244:247]
    v_mfma_f32_16x16x32_bf16 v[248:251], v[208:211], v[92:95], v[248:251]
    v_mfma_f32_16x16x32_bf16 v[252:255], v[208:211], v[96:99], v[252:255]
    v_mfma_f32_16x16x32_bf16 v[240:243], v[212:215], v[100:103], v[240:243]
    v_mfma_f32_16x16x32_bf16 v[244:247], v[212:215], v[104:107], v[244:247]
    v_mfma_f32_16x16x32_bf16 v[248:251], v[212:215], v[108:111], v[248:251]
    s_waitcnt vmcnt(20)
    v_mfma_f32_16x16x32_bf16 v[252:255], v[212:215], v[112:115], v[252:255]
    buffer_load_dwordx4 v[148:151], v4, s[8:11], s37 offen offset:1024
    v_mfma_f32_16x16x32_bf16 v[240:243], v[216:219], v[116:119], v[240:243]
    v_mfma_f32_16x16x32_bf16 v[244:247], v[216:219], v[120:123], v[244:247]
    v_mfma_f32_16x16x32_bf16 v[248:251], v[216:219], v[124:127], v[248:251]
    v_mfma_f32_16x16x32_bf16 v[252:255], v[216:219], v[128:131], v[252:255]
    buffer_load_dwordx4 v[216:219], v4, s[8:11], s37 offen offset:2048
    v_mfma_f32_16x16x32_bf16 v[240:243], v[220:223], v[132:135], v[240:243]
    v_mfma_f32_16x16x32_bf16 v[244:247], v[220:223], v[136:139], v[244:247]
    v_mfma_f32_16x16x32_bf16 v[248:251], v[220:223], v[140:143], v[248:251]
    s_waitcnt vmcnt(37)
    v_mfma_f32_16x16x32_bf16 v[252:255], v[220:223], v[144:147], v[252:255]
    buffer_load_dwordx4 v[220:223], v4, s[8:11], s37 offen offset:3072
    v_mfma_f32_16x16x32_bf16 v[224:227], a[188:191], a[0:3], 0
    v_mfma_f32_16x16x32_bf16 v[228:231], a[188:191], a[4:7], 0
    s_nop 0
    v_cvt_pk_bf16_f32 v24, v240, v241
    v_cvt_pk_bf16_f32 v25, v242, v243
    v_mfma_f32_16x16x32_bf16 v[232:235], a[188:191], a[8:11], 0
    v_cvt_pk_bf16_f32 v26, v244, v245
    v_cvt_pk_bf16_f32 v27, v246, v247
    v_mfma_f32_16x16x32_bf16 v[236:239], a[188:191], a[12:15], 0
    buffer_load_dwordx4 a[188:191], v5, s[8:11], s37 offen offset:0
    v_mfma_f32_16x16x32_bf16 v[224:227], a[192:195], a[16:19], v[224:227]
    buffer_store_dwordx4 v[24:27], v2, s[8:11], s40 offen offset:0 sc1
    v_mfma_f32_16x16x32_bf16 v[228:231], a[192:195], a[20:23], v[228:231]
    v_mfma_f32_16x16x32_bf16 v[232:235], a[192:195], a[24:27], v[232:235]
    s_waitcnt vmcnt(38)
    v_cvt_pk_bf16_f32 v28, v248, v249
    v_cvt_pk_bf16_f32 v29, v250, v251
    v_mfma_f32_16x16x32_bf16 v[236:239], a[192:195], a[28:31], v[236:239]
    v_mfma_f32_16x16x32_bf16 v[224:227], a[196:199], a[32:35], v[224:227]
    v_cvt_pk_bf16_f32 v30, v252, v253
    v_cvt_pk_bf16_f32 v31, v254, v255
    v_mfma_f32_16x16x32_bf16 v[228:231], a[196:199], a[36:39], v[228:231]
    buffer_store_dwordx4 v[28:31], v2, s[8:11], s40 offen offset:1024 sc1
    v_mfma_f32_16x16x32_bf16 v[232:235], a[196:199], a[40:43], v[232:235]
    s_add_u32 s40, s40, 8192
    v_mfma_f32_16x16x32_bf16 v[236:239], a[196:199], a[44:47], v[236:239]
    buffer_load_dwordx4 a[192:195], v5, s[8:11], s37 offen offset:1024
    v_mfma_f32_16x16x32_bf16 v[224:227], a[200:203], a[48:51], v[224:227]
    v_mfma_f32_16x16x32_bf16 v[228:231], a[200:203], a[52:55], v[228:231]
    v_mfma_f32_16x16x32_bf16 v[232:235], a[200:203], a[56:59], v[232:235]
    s_waitcnt vmcnt(38)
    v_mfma_f32_16x16x32_bf16 v[236:239], a[200:203], a[60:63], v[236:239]
    buffer_load_dwordx4 a[196:199], v5, s[8:11], s37 offen offset:2048
    v_mfma_f32_16x16x32_bf16 v[224:227], a[204:207], a[64:67], v[224:227]
    v_mfma_f32_16x16x32_bf16 v[228:231], a[204:207], a[68:71], v[228:231]
    v_mfma_f32_16x16x32_bf16 v[232:235], a[204:207], a[72:75], v[232:235]
    v_mfma_f32_16x16x32_bf16 v[236:239], a[204:207], a[76:79], v[236:239]
    buffer_load_dwordx4 a[200:203], v5, s[8:11], s37 offen offset:3072
    v_mfma_f32_16x16x32_bf16 v[224:227], a[208:211], a[80:83], v[224:227]
    v_mfma_f32_16x16x32_bf16 v[228:231], a[208:211], a[84:87], v[228:231]
    v_mfma_f32_16x16x32_bf16 v[232:235], a[208:211], a[88:91], v[232:235]
    s_waitcnt vmcnt(38)
    v_mfma_f32_16x16x32_bf16 v[236:239], a[208:211], a[92:95], v[236:239]
    buffer_load_dwordx4 a[204:207], v6, s[8:11], s37 offen offset:0
    v_mfma_f32_16x16x32_bf16 v[224:227], a[212:215], a[96:99], v[224:227]
    v_mfma_f32_16x16x32_bf16 v[228:231], a[212:215], a[100:103], v[228:231]
    v_mfma_f32_16x16x32_bf16 v[232:235], a[212:215], a[104:107], v[232:235]
    v_mfma_f32_16x16x32_bf16 v[236:239], a[212:215], a[108:111], v[236:239]
    v_mfma_f32_16x16x32_bf16 v[224:227], a[216:219], a[112:115], v[224:227]
    v_mfma_f32_16x16x32_bf16 v[228:231], a[216:219], a[116:119], v[228:231]
    v_mfma_f32_16x16x32_bf16 v[232:235], a[216:219], a[120:123], v[232:235]
    s_waitcnt vmcnt(37)
    v_mfma_f32_16x16x32_bf16 v[236:239], a[216:219], a[124:127], v[236:239]
    buffer_load_dwordx4 a[208:211], v6, s[8:11], s37 offen offset:1024
    v_mfma_f32_16x16x32_bf16 v[224:227], a[220:223], a[128:131], v[224:227]
    s_add_u32 s37, s37, 36864
    v_mfma_f32_16x16x32_bf16 v[228:231], a[220:223], a[132:135], v[228:231]
    v_mfma_f32_16x16x32_bf16 v[232:235], a[220:223], a[136:139], v[232:235]
    v_mfma_f32_16x16x32_bf16 v[236:239], a[220:223], a[140:143], v[236:239]
    buffer_load_dwordx4 a[212:215], v2, s[8:11], s36 offen offset:0
    v_mfma_f32_16x16x32_bf16 v[224:227], a[224:227], a[144:147], v[224:227]
    v_mfma_f32_16x16x32_bf16 v[228:231], a[224:227], a[148:151], v[228:231]
    v_mfma_f32_16x16x32_bf16 v[232:235], a[224:227], a[152:155], v[232:235]
    s_waitcnt vmcnt(37)
    v_mfma_f32_16x16x32_bf16 v[236:239], a[224:227], a[156:159], v[236:239]
    buffer_load_dwordx4 a[216:219], v2, s[8:11], s36 offen offset:1024
    v_mfma_f32_16x16x32_bf16 v[224:227], a[228:231], a[160:163], v[224:227]
    v_mfma_f32_16x16x32_bf16 v[228:231], a[228:231], a[164:167], v[228:231]
    v_mfma_f32_16x16x32_bf16 v[232:235], a[228:231], a[168:171], v[232:235]
    v_mfma_f32_16x16x32_bf16 v[236:239], a[228:231], a[172:175], v[236:239]
    buffer_load_dwordx4 a[220:223], v2, s[8:11], s36 offen offset:2048
    v_mfma_f32_16x16x32_bf16 v[224:227], a[232:235], a[176:179], v[224:227]
    v_mfma_f32_16x16x32_bf16 v[228:231], a[232:235], a[180:183], v[228:231]
    v_mfma_f32_16x16x32_bf16 v[232:235], a[232:235], a[184:187], v[232:235]
    s_waitcnt vmcnt(32)
    v_mfma_f32_16x16x32_bf16 v[236:239], a[232:235], v[48:51], v[236:239]
    buffer_load_dwordx4 a[224:227], v2, s[8:11], s36 offen offset:3072
    v_mfma_f32_16x16x32_bf16 v[224:227], a[236:239], v[52:55], v[224:227]
    v_mfma_f32_16x16x32_bf16 v[228:231], a[236:239], v[56:59], v[228:231]
    v_mfma_f32_16x16x32_bf16 v[232:235], a[236:239], v[60:63], v[232:235]
    v_mfma_f32_16x16x32_bf16 v[236:239], a[236:239], v[64:67], v[236:239]
    v_mfma_f32_16x16x32_bf16 v[224:227], a[240:243], v[68:71], v[224:227]
    v_mfma_f32_16x16x32_bf16 v[228:231], a[240:243], v[72:75], v[228:231]
    v_mfma_f32_16x16x32_bf16 v[232:235], a[240:243], v[76:79], v[232:235]
    s_waitcnt vmcnt(28)
    v_mfma_f32_16x16x32_bf16 v[236:239], a[240:243], v[80:83], v[236:239]
    buffer_load_dwordx4 a[228:231], v3, s[8:11], s36 offen offset:0
    v_mfma_f32_16x16x32_bf16 v[224:227], a[244:247], v[84:87], v[224:227]
    v_mfma_f32_16x16x32_bf16 v[228:231], a[244:247], v[88:91], v[228:231]
    buffer_load_dwordx4 v[152:155], v39, s[8:11], s53 offen sc1
    v_mfma_f32_16x16x32_bf16 v[232:235], a[244:247], v[92:95], v[232:235]
    v_mfma_f32_16x16x32_bf16 v[236:239], a[244:247], v[96:99], v[236:239]
    buffer_load_dwordx4 a[232:235], v3, s[8:11], s36 offen offset:1024
    v_mfma_f32_16x16x32_bf16 v[224:227], a[248:251], v[100:103], v[224:227]
    v_mfma_f32_16x16x32_bf16 v[228:231], a[248:251], v[104:107], v[228:231]
    buffer_load_dwordx4 v[156:159], v39, s[8:11], s45 offen sc1
    v_mfma_f32_16x16x32_bf16 v[232:235], a[248:251], v[108:111], v[232:235]
    s_waitcnt vmcnt(28)
    v_mfma_f32_16x16x32_bf16 v[236:239], a[248:251], v[112:115], v[236:239]
    buffer_load_dwordx4 a[236:239], v3, s[8:11], s36 offen offset:2048
    v_mfma_f32_16x16x32_bf16 v[224:227], a[252:255], v[116:119], v[224:227]
    v_mfma_f32_16x16x32_bf16 v[228:231], a[252:255], v[120:123], v[228:231]
    v_mfma_f32_16x16x32_bf16 v[232:235], a[252:255], v[124:127], v[232:235]
    v_mfma_f32_16x16x32_bf16 v[236:239], a[252:255], v[128:131], v[236:239]
    buffer_load_dwordx4 a[240:243], v3, s[8:11], s36 offen offset:3072
    v_mfma_f32_16x16x32_bf16 v[224:227], v[160:163], v[132:135], v[224:227]
    v_mfma_f32_16x16x32_bf16 v[228:231], v[160:163], v[136:139], v[228:231]
    v_mfma_f32_16x16x32_bf16 v[232:235], v[160:163], v[140:143], v[232:235]
    s_waitcnt vmcnt(28)
    v_mfma_f32_16x16x32_bf16 v[236:239], v[160:163], v[144:147], v[236:239]
    v_mfma_f32_16x16x32_bf16 v[240:243], v[164:167], a[0:3], 0
L_tp26:
    s_cbranch_execz L_tret
    v_mfma_f32_16x16x32_bf16 v[244:247], v[164:167], a[4:7], 0
    s_nop 1
    v_cvt_pk_bf16_f32 v16, v224, v225
    v_cvt_pk_bf16_f32 v17, v226, v227
    v_mfma_f32_16x16x32_bf16 v[248:251], v[164:167], a[8:11], 0
    v_cvt_pk_bf16_f32 v18, v228, v229
    v_cvt_pk_bf16_f32 v19, v230, v231
    v_mfma_f32_16x16x32_bf16 v[252:255], v[164:167], a[12:15], 0
    buffer_load_dwordx4 a[244:247], v4, s[8:11], s36 offen offset:0
    v_mfma_f32_16x16x32_bf16 v[240:243], v[168:171], a[16:19], v[240:243]
    buffer_store_dwordx4 v[16:19], v2, s[8:11], s40 offen offset:0 sc1
    v_mfma_f32_16x16x32_bf16 v[244:247], v[168:171], a[20:23], v[244:247]
    v_mfma_f32_16x16x32_bf16 v[248:251], v[168:171], a[24:27], v[248:251]
    s_waitcnt vmcnt(28)
    v_cvt_pk_bf16_f32 v20, v232, v233
    v_cvt_pk_bf16_f32 v21, v234, v235
    v_mfma_f32_16x16x32_bf16 v[252:255], v[168:171], a[28:31], v[252:255]
    buffer_load_dwordx4 a[248:251], v4, s[8:11], s36 offen offset:1024
    v_mfma_f32_16x16x32_bf16 v[240:243], v[172:175], a[32:35], v[240:243]
    v_cvt_pk_bf16_f32 v22, v236, v237
    v_cvt_pk_bf16_f32 v23, v238, v239
    v_mfma_f32_16x16x32_bf16 v[244:247], v[172:175], a[36:39], v[244:247]
    buffer_store_dwordx4 v[20:23], v2, s[8:11], s40 offen offset:1024 sc1
    v_mfma_f32_16x16x32_bf16 v[248:251], v[172:175], a[40:43], v[248:251]
    s_add_u32 s40, s40, 8192
    v_mfma_f32_16x16x32_bf16 v[252:255], v[172:175], a[44:47], v[252:255]
    buffer_load_dwordx4 a[252:255], v4, s[8:11], s36 offen offset:2048
    v_mfma_f32_16x16x32_bf16 v[240:243], v[176:179], a[48:51], v[240:243]
    v_mfma_f32_16x16x32_bf16 v[244:247], v[176:179], a[52:55], v[244:247]
    v_mfma_f32_16x16x32_bf16 v[248:251], v[176:179], a[56:59], v[248:251]
    s_waitcnt vmcnt(29)
    v_mfma_f32_16x16x32_bf16 v[252:255], v[176:179], a[60:63], v[252:255]
    buffer_load_dwordx4 v[176:179], v4, s[8:11], s36 offen offset:3072
    v_mfma_f32_16x16x32_bf16 v[240:243], v[180:183], a[64:67], v[240:243]
    v_mfma_f32_16x16x32_bf16 v[244:247], v[180:183], a[68:71], v[244:247]
    v_mfma_f32_16x16x32_bf16 v[248:251], v[180:183], a[72:75], v[248:251]
    v_mfma_f32_16x16x32_bf16 v[252:255], v[180:183], a[76:79], v[252:255]
    v_mfma_f32_16x16x32_bf16 v[240:243], v[184:187], a[80:83], v[240:243]
    v_mfma_f32_16x16x32_bf16 v[244:247], v[184:187], a[84:87], v[244:247]
    v_mfma_f32_16x16x32_bf16 v[248:251], v[184:187], a[88:91], v[248:251]
    s_waitcnt vmcnt(28)
    v_mfma_f32_16x16x32_bf16 v[252:255], v[184:187], a[92:95], v[252:255]
    buffer_load_dwordx4 v[180:183], v5, s[8:11], s36 offen offset:0
    v_mfma_f32_16x16x32_bf16 v[240:243], v[188:191], a[96:99], v[240:243]
    v_mfma_f32_16x16x32_bf16 v[244:247], v[188:191], a[100:103], v[244:247]
    v_mfma_f32_16x16x32_bf16 v[248:251], v[188:191], a[104:107], v[248:251]
    v_mfma_f32_16x16x32_bf16 v[252:255], v[188:191], a[108:111], v[252:255]
    buffer_load_dwordx4 v[184:187], v5, s[8:11], s36 offen offset:1024
    v_mfma_f32_16x16x32_bf16 v[240:243], v[192:195], a[112:115], v[240:243]
    v_mfma_f32_16x16x32_bf16 v[244:247], v[192:195], a[116:119], v[244:247]
    buffer_load_dwordx4 v[160:163], v2, s[8:11], s56 offen offset:0 sc1
    v_mfma_f32_16x16x32_bf16 v[248:251], v[192:195], a[120:123], v[248:251]
    s_waitcnt vmcnt(29)
    v_mfma_f32_16x16x32_bf16 v[252:255], v[192:195], a[124:127], v[252:255]
    buffer_load_dwordx4 v[188:191], v5, s[8:11], s36 offen offset:2048
    v_mfma_f32_16x16x32_bf16 v[240:243], v[196:199], a[128:131], v[240:243]
    v_mfma_f32_16x16x32_bf16 v[244:247], v[196:199], a[132:135], v[244:247]
    buffer_load_dwordx4 v[164:167], v2, s[8:11], s56 offen offset:1024 sc1
    v_mfma_f32_16x16x32_bf16 v[248:251], v[196:199], a[136:139], v[248:251]
    v_mfma_f32_16x16x32_bf16 v[252:255], v[196:199], a[140:143], v[252:255]
    buffer_load_dwordx4 v[192:195], v5, s[8:11], s36 offen offset:3072
    v_mfma_f32_16x16x32_bf16 v[240:243], v[148:151], a[144:147], v[240:243]
    v_mfma_f32_16x16x32_bf16 v[244:247], v[148:151], a[148:151], v[244:247]
    v_mfma_f32_16x16x32_bf16 v[248:251], v[148:151], a[152:155], v[248:251]
    s_waitcnt vmcnt(30)
    v_mfma_f32_16x16x32_bf16 v[252:255], v[148:151], a[156:159], v[252:255]
    v_mfma_f32_16x16x32_bf16 v[240:243], v[216:219], a[160:163], v[240:243]
    v_mfma_f32_16x16x32_bf16 v[244:247], v[216:219], a[164:167], v[244:247]
    v_mfma_f32_16x16x32_bf16 v[248:251], v[216:219], a[168:171], v[248:251]
    v_mfma_f32_16x16x32_bf16 v[252:255], v[216:219], a[172:175], v[252:255]
    buffer_load_dwordx4 v[216:219], v6, s[8:11], s36 offen offset:0
    v_mfma_f32_16x16x32_bf16 v[240:243], v[220:223], a[176:179], v[240:243]
    v_mfma_f32_16x16x32_bf16 v[244:247], v[220:223], a[180:183], v[244:247]
    v_mfma_f32_16x16x32_bf16 v[248:251], v[220:223], a[184:187], v[248:251]
    s_waitcnt vmcnt(27)
    v_mfma_f32_16x16x32_bf16 v[252:255], v[220:223], v[48:51], v[252:255]
    buffer_load_dwordx4 v[220:223], v6, s[8:11], s36 offen offset:1024
    v_mfma_f32_16x16x32_bf16 v[240:243], a[188:191], v[52:55], v[240:243]
    s_add_u32 s36, s36, 36864
    v_mfma_f32_16x16x32_bf16 v[244:247], a[188:191], v[56:59], v[244:247]
    v_mfma_f32_16x16x32_bf16 v[248:251], a[188:191], v[60:63], v[248:251]
    v_mfma_f32_16x16x32_bf16 v[252:255], a[188:191], v[64:67], v[252:255]
    buffer_load_dwordx4 a[188:191], v2, s[8:11], s37 offen offset:0
    v_mfma_f32_16x16x32_bf16 v[240:243], a[192:195], v[68:71], v[240:243]
    v_mfma_f32_16x16x32_bf16 v[244:247], a[192:195], v[72:75], v[244:247]
    v_mfma_f32_16x16x32_bf16 v[248:251], a[192:195], v[76:79], v[248:251]
    s_waitcnt vmcnt(27)
    v_mfma_f32_16x16x32_bf16 v[252:255], a[192:195], v[80:83], v[252:255]
    buffer_load_dwordx4 a[192:195], v2, s[8:11], s37 offen offset:1024
    v_mfma_f32_16x16x32_bf16 v[240:243], a[196:199], v[84:87], v[240:243]
    v_mfma_f32_16x16x32_bf16 v[244:247], a[196:199], v[88:91], v[244:247]
    v_mfma_f32_16x16x32_bf16 v[248:251], a[196:199], v[92:95], v[248:251]
    v_mfma_f32_16x16x32_bf16 v[252:255], a[196:199], v[96:99], v[252:255]
    buffer_load_dwordx4 a[196:199], v2, s[8:11], s37 offen offset:2048
    v_mfma_f32_16x16x32_bf16 v[240:243], a[200:203], v[100:103], v[240:243]
    v_mfma_f32_16x16x32_bf16 v[244:247], a[200:203], v[104:107], v[244:247]
    v_mfma_f32_16x16x32_bf16 v[248:251], a[200:203], v[108:111], v[248:251]
    s_waitcnt vmcnt(27)
    v_mfma_f32_16x16x32_bf16 v[252:255], a[200:203], v[112:115], v[252:255]
    v_mfma_f32_16x16x32_bf16 v[240:243], a[204:207], v[116:119], v[240:243]
    v_mfma_f32_16x16x32_bf16 v[244:247], a[204:207], v[120:123], v[244:247]
    v_mfma_f32_16x16x32_bf16 v[248:251], a[204:207], v[124:127], v[248:251]
    v_mfma_f32_16x16x32_bf16 v[252:255], a[204:207], v[128:131], v[252:255]
    buffer_load_dwordx4 a[200:203], v2, s[8:11], s37 offen offset:3072
    v_mfma_f32_16x16x32_bf16 v[240:243], a[208:211], v[132:135], v[240:243]
    v_mfma_f32_16x16x32_bf16 v[244:247], a[208:211], v[136:139], v[244:247]
    v_mfma_f32_16x16x32_bf16 v[248:251], a[208:211], v[140:143], v[248:251]
    s_waitcnt vmcnt(26)
    v_mfma_f32_16x16x32_bf16 v[252:255], a[208:211], v[144:147], v[252:255]
    buffer_load_dwordx4 a[204:207], v3, s[8:11], s37 offen offset:0
    v_mfma_f32_16x16x32_bf16 v[224:227], a[212:215], a[0:3], 0
    v_mfma_f32_16x16x32_bf16 v[228:231], a[212:215], a[4:7], 0
    s_nop 0
    v_cvt_pk_bf16_f32 v24, v240, v241
    v_cvt_pk_bf16_f32 v25, v242, v243
    v_mfma_f32_16x16x32_bf16 v[232:235], a[212:215], a[8:11], 0
    v_cvt_pk_bf16_f32 v26, v244, v245
    v_cvt_pk_bf16_f32 v27, v246, v247
    v_mfma_f32_16x16x32_bf16 v[236:239], a[212:215], a[12:15], 0
    buffer_load_dwordx4 a[208:211], v3, s[8:11], s37 offen offset:1024
    v_mfma_f32_16x16x32_bf16 v[224:227], a[216:219], a[16:19], v[224:227]
    buffer_store_dwordx4 v[24:27], v2, s[8:11], s40 offen offset:0 sc1
    v_mfma_f32_16x16x32_bf16 v[228:231], a[216:219], a[20:23], v[228:231]
    buffer_load_dwordx4 v[168:171], v2, s[8:11], s57 offen offset:0 sc1
    v_mfma_f32_16x16x32_bf16 v[232:235], a[216:219], a[24:27], v[232:235]
    s_waitcnt vmcnt(28)
    v_cvt_pk_bf16_f32 v28, v248, v249
    v_cvt_pk_bf16_f32 v29, v250, v251
    v_mfma_f32_16x16x32_bf16 v[236:239], a[216:219], a[28:31], v[236:239]
    buffer_load_dwordx4 a[212:215], v3, s[8:11], s37 offen offset:2048
    v_mfma_f32_16x16x32_bf16 v[224:227], a[220:223], a[32:35], v[224:227]
    v_cvt_pk_bf16_f32 v30, v252, v253
    v_cvt_pk_bf16_f32 v31, v254, v255
    v_mfma_f32_16x16x32_bf16 v[228:231], a[220:223], a[36:39], v[228:231]
L_tp27:
    s_cbranch_execz L_tret
    buffer_store_dwordx4 v[28:31], v2, s[8:11], s40 offen offset:1024 sc1
    buffer_load_dwordx4 v[172:175], v2, s[8:11], s57 offen offset:1024 sc1
    v_mfma_f32_16x16x32_bf16 v[232:235], a[220:223], a[40:43], v[232:235]
    s_add_u32 s40, s40, 8192
    v_mfma_f32_16x16x32_bf16 v[236:239], a[220:223], a[44:47], v[236:239]
    v_mfma_f32_16x16x32_bf16 v[224:227], a[224:227], a[48:51], v[224:227]
    v_mfma_f32_16x16x32_bf16 v[228:231], a[224:227], a[52:55], v[228:231]
    v_mfma_f32_16x16x32_bf16 v[232:235], a[224:227], a[56:59], v[232:235]
    s_waitcnt vmcnt(28)
    v_mfma_f32_16x16x32_bf16 v[236:239], a[224:227], a[60:63], v[236:239]
    buffer_load_dwordx4 a[216:219], v3, s[8:11], s37 offen offset:3072
    v_mfma_f32_16x16x32_bf16 v[224:227], a[228:231], a[64:67], v[224:227]
    v_mfma_f32_16x16x32_bf16 v[228:231], a[228:231], a[68:71], v[228:231]
    v_mfma_f32_16x16x32_bf16 v[232:235], a[228:231], a[72:75], v[232:235]
    v_mfma_f32_16x16x32_bf16 v[236:239], a[228:231], a[76:79], v[236:239]
    buffer_load_dwordx4 a[220:223], v4, s[8:11], s37 offen offset:0
    v_mfma_f32_16x16x32_bf16 v[224:227], a[232:235], a[80:83], v[224:227]
    v_mfma_f32_16x16x32_bf16 v[228:231], a[232:235], a[84:87], v[228:231]
    v_mfma_f32_16x16x32_bf16 v[232:235], a[232:235], a[88:91], v[232:235]
    s_waitcnt vmcnt(27)
    v_mfma_f32_16x16x32_bf16 v[236:239], a[232:235], a[92:95], v[236:239]
    buffer_load_dwordx4 a[224:227], v4, s[8:11], s37 offen offset:1024
    v_mfma_f32_16x16x32_bf16 v[224:227], a[236:239], a[96:99], v[224:227]
    v_mfma_f32_16x16x32_bf16 v[228:231], a[236:239], a[100:103], v[228:231]
    v_mfma_f32_16x16x32_bf16 v[232:235], a[236:239], a[104:107], v[232:235]
    v_mfma_f32_16x16x32_bf16 v[236:239], a[236:239], a[108:111], v[236:239]
    buffer_load_dwordx4 a[228:231], v4, s[8:11], s37 offen offset:2048
    v_mfma_f32_16x16x32_bf16 v[224:227], a[240:243], a[112:115], v[224:227]
    v_mfma_f32_16x16x32_bf16 v[228:231], a[240:243], a[116:119], v[228:231]
    v_mfma_f32_16x16x32_bf16 v[232:235], a[240:243], a[120:123], v[232:235]
    s_waitcnt vmcnt(26)
    v_mfma_f32_16x16x32_bf16 v[236:239], a[240:243], a[124:127], v[236:239]
    v_mfma_f32_16x16x32_bf16 v[224:227], a[244:247], a[128:131], v[224:227]
    v_mfma_f32_16x16x32_bf16 v[228:231], a[244:247], a[132:135], v[228:231]
    v_mfma_f32_16x16x32_bf16 v[232:235], a[244:247], a[136:139], v[232:235]
    v_mfma_f32_16x16x32_bf16 v[236:239], a[244:247], a[140:143], v[236:239]
    buffer_load_dwordx4 a[232:235], v4, s[8:11], s37 offen offset:3072
    v_mfma_f32_16x16x32_bf16 v[224:227], a[248:251], a[144:147], v[224:227]
    v_mfma_f32_16x16x32_bf16 v[228:231], a[248:251], a[148:151], v[228:231]
    v_mfma_f32_16x16x32_bf16 v[232:235], a[248:251], a[152:155], v[232:235]
    s_waitcnt vmcnt(24)
    v_mfma_f32_16x16x32_bf16 v[236:239], a[248:251], a[156:159], v[236:239]
    buffer_load_dwordx4 v[196:199], v5, s[8:11], s37 offen offset:0
    v_mfma_f32_16x16x32_bf16 v[224:227], a[252:255], a[160:163], v[224:227]
    v_mfma_f32_16x16x32_bf16 v[228:231], a[252:255], a[164:167], v[228:231]
    v_mfma_f32_16x16x32_bf16 v[232:235], a[252:255], a[168:171], v[232:235]
    v_mfma_f32_16x16x32_bf16 v[236:239], a[252:255], a[172:175], v[236:239]
    buffer_load_dwordx4 a[236:239], v5, s[8:11], s37 offen offset:1024
    v_mfma_f32_16x16x32_bf16 v[224:227], v[176:179], a[176:179], v[224:227]
    v_mfma_f32_16x16x32_bf16 v[228:231], v[176:179], a[180:183], v[228:231]
    v_mfma_f32_16x16x32_bf16 v[232:235], v[176:179], a[184:187], v[232:235]
    s_waitcnt vmcnt(24)
    v_mfma_f32_16x16x32_bf16 v[236:239], v[176:179], v[48:51], v[236:239]
    buffer_load_dwordx4 a[240:243], v5, s[8:11], s37 offen offset:2048
    v_mfma_f32_16x16x32_bf16 v[224:227], v[180:183], v[52:55], v[224:227]
    v_mfma_f32_16x16x32_bf16 v[228:231], v[180:183], v[56:59], v[228:231]
    v_mfma_f32_16x16x32_bf16 v[232:235], v[180:183], v[60:63], v[232:235]
    v_mfma_f32_16x16x32_bf16 v[236:239], v[180:183], v[64:67], v[236:239]
    v_mfma_f32_16x16x32_bf16 v[224:227], v[184:187], v[68:71], v[224:227]
    v_mfma_f32_16x16x32_bf16 v[228:231], v[184:187], v[72:75], v[228:231]
    buffer_load_dwordx4 v[176:179], v2, s[8:11], s58 offen offset:0 sc1
    v_mfma_f32_16x16x32_bf16 v[232:235], v[184:187], v[76:79], v[232:235]
    s_waitcnt vmcnt(22)
    v_mfma_f32_16x16x32_bf16 v[236:239], v[184:187], v[80:83], v[236:239]
    buffer_load_dwordx4 v[184:187], v5, s[8:11], s37 offen offset:3072
    v_mfma_f32_16x16x32_bf16 v[224:227], v[188:191], v[84:87], v[224:227]
    v_mfma_f32_16x16x32_bf16 v[228:231], v[188:191], v[88:91], v[228:231]
    buffer_load_dwordx4 v[180:183], v2, s[8:11], s58 offen offset:1024 sc1
    v_mfma_f32_16x16x32_bf16 v[232:235], v[188:191], v[92:95], v[232:235]
    v_mfma_f32_16x16x32_bf16 v[236:239], v[188:191], v[96:99], v[236:239]
    buffer_load_dwordx4 v[188:191], v6, s[8:11], s37 offen offset:0
    v_mfma_f32_16x16x32_bf16 v[224:227], v[192:195], v[100:103], v[224:227]
    v_mfma_f32_16x16x32_bf16 v[228:231], v[192:195], v[104:107], v[228:231]
    v_mfma_f32_16x16x32_bf16 v[232:235], v[192:195], v[108:111], v[232:235]
    s_waitcnt vmcnt(23)
    v_mfma_f32_16x16x32_bf16 v[236:239], v[192:195], v[112:115], v[236:239]
    buffer_load_dwordx4 v[192:195], v6, s[8:11], s37 offen offset:1024
    v_mfma_f32_16x16x32_bf16 v[224:227], v[216:219], v[116:119], v[224:227]
    s_add_u32 s37, s37, 36864
    v_mfma_f32_16x16x32_bf16 v[228:231], v[216:219], v[120:123], v[228:231]
    v_mfma_f32_16x16x32_bf16 v[232:235], v[216:219], v[124:127], v[232:235]
    v_mfma_f32_16x16x32_bf16 v[236:239], v[216:219], v[128:131], v[236:239]
    buffer_load_dwordx4 v[216:219], v2, s[8:11], s36 offen offset:0
    v_mfma_f32_16x16x32_bf16 v[224:227], v[220:223], v[132:135], v[224:227]
    v_mfma_f32_16x16x32_bf16 v[228:231], v[220:223], v[136:139], v[228:231]
    v_mfma_f32_16x16x32_bf16 v[232:235], v[220:223], v[140:143], v[232:235]
    s_waitcnt vmcnt(23)
    v_mfma_f32_16x16x32_bf16 v[236:239], v[220:223], v[144:147], v[236:239]
    buffer_load_dwordx4 v[220:223], v2, s[8:11], s36 offen offset:1024
    v_mfma_f32_16x16x32_bf16 v[240:243], a[188:191], a[0:3], 0
    v_mfma_f32_16x16x32_bf16 v[244:247], a[188:191], a[4:7], 0
    s_nop 0
    v_cvt_pk_bf16_f32 v16, v224, v225
    v_cvt_pk_bf16_f32 v17, v226, v227
    v_mfma_f32_16x16x32_bf16 v[248:251], a[188:191], a[8:11], 0
    v_cvt_pk_bf16_f32 v18, v228, v229
    v_cvt_pk_bf16_f32 v19, v230, v231
    v_mfma_f32_16x16x32_bf16 v[252:255], a[188:191], a[12:15], 0
    v_mfma_f32_16x16x32_bf16 v[240:243], a[192:195], a[16:19], v[240:243]
    buffer_store_dwordx4 v[16:19], v2, s[8:11], s40 offen offset:0 sc1
    v_mfma_f32_16x16x32_bf16 v[244:247], a[192:195], a[20:23], v[244:247]
    v_mfma_f32_16x16x32_bf16 v[248:251], a[192:195], a[24:27], v[248:251]
    s_waitcnt vmcnt(23)
    v_cvt_pk_bf16_f32 v20, v232, v233
    v_cvt_pk_bf16_f32 v21, v234, v235
    v_mfma_f32_16x16x32_bf16 v[252:255], a[192:195], a[28:31], v[252:255]
    buffer_load_dwordx4 a[244:247], v2, s[8:11], s36 offen offset:2048
    v_mfma_f32_16x16x32_bf16 v[240:243], a[196:199], a[32:35], v[240:243]
    v_cvt_pk_bf16_f32 v22, v236, v237
    v_cvt_pk_bf16_f32 v23, v238, v239
    v_mfma_f32_16x16x32_bf16 v[244:247], a[196:199], a[36:39], v[244:247]
    buffer_store_dwordx4 v[20:23], v2, s[8:11], s40 offen offset:1024 sc1
    v_mfma_f32_16x16x32_bf16 v[248:251], a[196:199], a[40:43], v[248:251]
    s_add_u32 s40, s40, 8192
    v_mfma_f32_16x16x32_bf16 v[252:255], a[196:199], a[44:47], v[252:255]
    buffer_load_dwordx4 a[248:251], v2, s[8:11], s36 offen offset:3072
    v_mfma_f32_16x16x32_bf16 v[240:243], a[200:203], a[48:51], v[240:243]
    v_mfma_f32_16x16x32_bf16 v[244:247], a[200:203], a[52:55], v[244:247]
    v_mfma_f32_16x16x32_bf16 v[248:251], a[200:203], a[56:59], v[248:251]
    s_waitcnt vmcnt(24)
    v_mfma_f32_16x16x32_bf16 v[252:255], a[200:203], a[60:63], v[252:255]
    buffer_load_dwordx4 a[252:255], v3, s[8:11], s36 offen offset:0
    v_mfma_f32_16x16x32_bf16 v[240:243], a[204:207], a[64:67], v[240:243]
    v_mfma_f32_16x16x32_bf16 v[244:247], a[204:207], a[68:71], v[244:247]
    v_mfma_f32_16x16x32_bf16 v[248:251], a[204:207], a[72:75], v[248:251]
    v_mfma_f32_16x16x32_bf16 v[252:255], a[204:207], a[76:79], v[252:255]
    buffer_load_dwordx4 v[148:151], v3, s[8:11], s36 offen offset:1024
    v_mfma_f32_16x16x32_bf16 v[240:243], a[208:211], a[80:83], v[240:243]
    v_mfma_f32_16x16x32_bf16 v[244:247], a[208:211], a[84:87], v[244:247]
    v_mfma_f32_16x16x32_bf16 v[248:251], a[208:211], a[88:91], v[248:251]
    s_waitcnt vmcnt(20)
    v_mfma_f32_16x16x32_bf16 v[252:255], a[208:211], a[92:95], v[252:255]
    v_mfma_f32_16x16x32_bf16 v[240:243], a[212:215], a[96:99], v[240:243]
L_tp28:
    s_cbranch_execz L_tret
    v_mfma_f32_16x16x32_bf16 v[244:247], a[212:215], a[100:103], v[244:247]
    v_mfma_f32_16x16x32_bf16 v[248:251], a[212:215], a[104:107], v[248:251]
    v_mfma_f32_16x16x32_bf16 v[252:255], a[212:215], a[108:111], v[252:255]
    buffer_load_dwordx4 a[212:215], v3, s[8:11], s36 offen offset:2048
    v_mfma_f32_16x16x32_bf16 v[240:243], a[216:219], a[112:115], v[240:243]
    v_mfma_f32_16x16x32_bf16 v[244:247], a[216:219], a[116:119], v[244:247]
    v_mfma_f32_16x16x32_bf16 v[248:251], a[216:219], a[120:123], v[248:251]
    s_waitcnt vmcnt(19)
    v_mfma_f32_16x16x32_bf16 v[252:255], a[216:219], a[124:127], v[252:255]
    buffer_load_dwordx4 a[216:219], v3, s[8:11], s36 offen offset:3072
    v_mfma_f32_16x16x32_bf16 v[240:243], a[220:223], a[128:131], v[240:243]
    v_mfma_f32_16x16x32_bf16 v[244:247], a[220:223], a[132:135], v[244:247]
    v_mfma_f32_16x16x32_bf16 v[248:251], a[220:223], a[136:139], v[248:251]
    v_mfma_f32_16x16x32_bf16 v[252:255], a[220:223], a[140:143], v[252:255]
    buffer_load_dwordx4 a[220:223], v4, s[8:11], s36 offen offset:0
    v_mfma_f32_16x16x32_bf16 v[240:243], a[224:227], a[144:147], v[240:243]
    v_mfma_f32_16x16x32_bf16 v[244:247], a[224:227], a[148:151], v[244:247]
    v_mfma_f32_16x16x32_bf16 v[248:251], a[224:227], a[152:155], v[248:251]
    s_waitcnt vmcnt(19)
    v_mfma_f32_16x16x32_bf16 v[252:255], a[224:227], a[156:159], v[252:255]
    buffer_load_dwordx4 a[224:227], v4, s[8:11], s36 offen offset:1024
    v_mfma_f32_16x16x32_bf16 v[240:243], a[228:231], a[160:163], v[240:243]
    v_mfma_f32_16x16x32_bf16 v[244:247], a[228:231], a[164:167], v[244:247]
    v_mfma_f32_16x16x32_bf16 v[248:251], a[228:231], a[168:171], v[248:251]
    v_mfma_f32_16x16x32_bf16 v[252:255], a[228:231], a[172:175], v[252:255]
    v_mfma_f32_16x16x32_bf16 v[240:243], a[232:235], a[176:179], v[240:243]
    v_mfma_f32_16x16x32_bf16 v[244:247], a[232:235], a[180:183], v[244:247]
    v_mfma_f32_16x16x32_bf16 v[248:251], a[232:235], a[184:187], v[248:251]
    s_waitcnt vmcnt(18)
    v_mfma_f32_16x16x32_bf16 v[252:255], a[232:235], v[48:51], v[252:255]
    buffer_load_dwordx4 a[228:231], v4, s[8:11], s36 offen offset:2048
    v_mfma_f32_16x16x32_bf16 v[240:243], v[196:199], v[52:55], v[240:243]
    v_mfma_f32_16x16x32_bf16 v[244:247], v[196:199], v[56:59], v[244:247]
    v_mfma_f32_16x16x32_bf16 v[248:251], v[196:199], v[60:63], v[248:251]
    v_mfma_f32_16x16x32_bf16 v[252:255], v[196:199], v[64:67], v[252:255]
    buffer_load_dwordx4 a[232:235], v4, s[8:11], s36 offen offset:3072
    v_mfma_f32_16x16x32_bf16 v[240:243], a[236:239], v[68:71], v[240:243]
    v_mfma_f32_16x16x32_bf16 v[244:247], a[236:239], v[72:75], v[244:247]
    v_mfma_f32_16x16x32_bf16 v[248:251], a[236:239], v[76:79], v[248:251]
    s_waitcnt vmcnt(17)
    v_mfma_f32_16x16x32_bf16 v[252:255], a[236:239], v[80:83], v[252:255]
    buffer_load_dwordx4 a[236:239], v5, s[8:11], s36 offen offset:0
    v_mfma_f32_16x16x32_bf16 v[240:243], a[240:243], v[84:87], v[240:243]
    v_mfma_f32_16x16x32_bf16 v[244:247], a[240:243], v[88:91], v[244:247]
    v_mfma_f32_16x16x32_bf16 v[248:251], a[240:243], v[92:95], v[248:251]
    v_mfma_f32_16x16x32_bf16 v[252:255], a[240:243], v[96:99], v[252:255]
    buffer_load_dwordx4 a[240:243], v5, s[8:11], s36 offen offset:1024
    v_mfma_f32_16x16x32_bf16 v[240:243], v[184:187], v[100:103], v[240:243]
    v_mfma_f32_16x16x32_bf16 v[244:247], v[184:187], v[104:107], v[244:247]
    v_mfma_f32_16x16x32_bf16 v[248:251], v[184:187], v[108:111], v[248:251]
    s_waitcnt vmcnt(16)
    v_mfma_f32_16x16x32_bf16 v[252:255], v[184:187], v[112:115], v[252:255]
    v_mfma_f32_16x16x32_bf16 v[240:243], v[188:191], v[116:119], v[240:243]
    v_mfma_f32_16x16x32_bf16 v[244:247], v[188:191], v[120:123], v[244:247]
    v_mfma_f32_16x16x32_bf16 v[248:251], v[188:191], v[124:127], v[248:251]
    v_mfma_f32_16x16x32_bf16 v[252:255], v[188:191], v[128:131], v[252:255]
    buffer_load_dwordx4 v[200:203], v5, s[8:11], s36 offen offset:2048
    v_mfma_f32_16x16x32_bf16 v[240:243], v[192:195], v[132:135], v[240:243]
    v_mfma_f32_16x16x32_bf16 v[244:247], v[192:195], v[136:139], v[244:247]
    v_mfma_f32_16x16x32_bf16 v[248:251], v[192:195], v[140:143], v[248:251]
    s_waitcnt vmcnt(15)
    v_mfma_f32_16x16x32_bf16 v[252:255], v[192:195], v[144:147], v[252:255]
    buffer_load_dwordx4 v[204:207], v5, s[8:11], s36 offen offset:3072
    v_mfma_f32_16x16x32_bf16 v[224:227], v[216:219], a[0:3], 0
    v_mfma_f32_16x16x32_bf16 v[228:231], v[216:219], a[4:7], 0
    s_nop 0
    v_cvt_pk_bf16_f32 v24, v240, v241
    v_cvt_pk_bf16_f32 v25, v242, v243
    v_mfma_f32_16x16x32_bf16 v[232:235], v[216:219], a[8:11], 0
    v_cvt_pk_bf16_f32 v26, v244, v245
    v_cvt_pk_bf16_f32 v27, v246, v247
    v_mfma_f32_16x16x32_bf16 v[236:239], v[216:219], a[12:15], 0
    buffer_load_dwordx4 v[208:211], v6, s[8:11], s36 offen offset:0
    ds_read_b128 a[188:191], v46 offset:0
    v_mfma_f32_16x16x32_bf16 v[224:227], v[220:223], a[16:19], v[224:227]
    buffer_store_dwordx4 v[24:27], v2, s[8:11], s40 offen offset:0 sc1
    v_mfma_f32_16x16x32_bf16 v[228:231], v[220:223], a[20:23], v[228:231]
    v_mfma_f32_16x16x32_bf16 v[232:235], v[220:223], a[24:27], v[232:235]
    s_waitcnt vmcnt(14)
    v_cvt_pk_bf16_f32 v28, v248, v249
    v_cvt_pk_bf16_f32 v29, v250, v251
    v_mfma_f32_16x16x32_bf16 v[236:239], v[220:223], a[28:31], v[236:239]
    buffer_load_dwordx4 v[212:215], v6, s[8:11], s36 offen offset:1024
    ds_read_b128 a[192:195], v46 offset:1024
    v_mfma_f32_16x16x32_bf16 v[224:227], a[244:247], a[32:35], v[224:227]
    v_cvt_pk_bf16_f32 v30, v252, v253
    v_cvt_pk_bf16_f32 v31, v254, v255
    v_mfma_f32_16x16x32_bf16 v[228:231], a[244:247], a[36:39], v[228:231]
    buffer_store_dwordx4 v[28:31], v2, s[8:11], s40 offen offset:1024 sc1
    v_mfma_f32_16x16x32_bf16 v[232:235], a[244:247], a[40:43], v[232:235]
    s_add_u32 s40, s40, 8192
    v_mfma_f32_16x16x32_bf16 v[236:239], a[244:247], a[44:47], v[236:239]
    ds_read_b128 a[196:199], v46 offset:2048
    v_mfma_f32_16x16x32_bf16 v[224:227], a[248:251], a[48:51], v[224:227]
    v_and_b32 v37, 15, v1
    v_mfma_f32_16x16x32_bf16 v[228:231], a[248:251], a[52:55], v[228:231]
    buffer_load_dwordx4 v[184:187], v2, s[8:11], s59 offen offset:0 sc1
    v_mfma_f32_16x16x32_bf16 v[232:235], a[248:251], a[56:59], v[232:235]
    s_waitcnt vmcnt(15)
    buffer_load_dwordx4 v[188:191], v2, s[8:11], s59 offen offset:1024 sc1
    v_mfma_f32_16x16x32_bf16 v[236:239], a[248:251], a[60:63], v[236:239]
    ds_read_b128 a[200:203], v46 offset:3072
    v_mfma_f32_16x16x32_bf16 v[224:227], a[252:255], a[64:67], v[224:227]
    v_lshlrev_b32 v216, 2, v37
    v_mfma_f32_16x16x32_bf16 v[228:231], a[252:255], a[68:71], v[228:231]
    v_add_u32 v216, 147520, v216
    v_mfma_f32_16x16x32_bf16 v[232:235], a[252:255], a[72:75], v[232:235]
    v_bfe_u32 v38, v1, 1, 1
    v_mfma_f32_16x16x32_bf16 v[236:239], a[252:255], a[76:79], v[236:239]
    ds_read_b128 a[204:207], v46 offset:16384
    v_mfma_f32_16x16x32_bf16 v[224:227], v[148:151], a[80:83], v[224:227]
    v_lshlrev_b32 v220, 2, v38
    v_mfma_f32_16x16x32_bf16 v[228:231], v[148:151], a[84:87], v[228:231]
    s_lshl_b32 s33, s47, 7
    s_and_b32 s34, s31, 1
    s_lshl_b32 s34, s34, 5
    s_add_u32 s33, s33, s34
    s_add_u32 s33, s33, 147520
    s_lshl_b32 s34, s32, 3
    s_add_u32 s33, s33, s34
    v_add_u32 v220, s33, v220
    v_mfma_f32_16x16x32_bf16 v[232:235], v[148:151], a[88:91], v[232:235]
    s_waitcnt vmcnt(14)
    ds_read2_b32 v[218:219], v216 offset0:64 offset1:96
    v_mfma_f32_16x16x32_bf16 v[236:239], v[148:151], a[92:95], v[236:239]
    ds_read_b128 a[208:211], v46 offset:17408
    v_mfma_f32_16x16x32_bf16 v[224:227], a[212:215], a[96:99], v[224:227]
    ds_read2_b32 v[216:217], v216 offset1:32
    v_mfma_f32_16x16x32_bf16 v[228:231], a[212:215], a[100:103], v[228:231]
    ds_read_b32 v220, v220
    v_mfma_f32_16x16x32_bf16 v[232:235], a[212:215], a[104:107], v[232:235]
    v_lshrrev_b32 v47, 4, v1
    v_mfma_f32_16x16x32_bf16 v[236:239], a[212:215], a[108:111], v[236:239]
    ds_read_b128 a[212:215], v46 offset:18432
    v_mfma_f32_16x16x32_bf16 v[224:227], a[216:219], a[112:115], v[224:227]
    v_lshlrev_b32 v3, 3, v47
    v_mfma_f32_16x16x32_bf16 v[228:231], a[216:219], a[116:119], v[228:231]
L_tp29:
    s_cbranch_execz L_tret
    v_lshl_add_u32 v3, v37, 5, v3
    v_mfma_f32_16x16x32_bf16 v[232:235], a[216:219], a[120:123], v[232:235]
    s_waitcnt vmcnt(12)
    s_add_u32 s33, s48, 86016
    v_add_u32 v3, s33, v3
    v_mfma_f32_16x16x32_bf16 v[236:239], a[216:219], a[124:127], v[236:239]
    ds_read_b128 a[216:219], v46 offset:19456
    v_mfma_f32_16x16x32_bf16 v[224:227], a[220:223], a[128:131], v[224:227]
    s_lshl_b32 s34, s32, 9
    s_add_u32 s34, s34, 86016
    v_lshl_add_u32 v4, v1, 2, s34
    v_mfma_f32_16x16x32_bf16 v[228:231], a[220:223], a[132:135], v[228:231]
    v_lshrrev_b32 v37, 3, v1
    v_mfma_f32_16x16x32_bf16 v[232:235], a[220:223], a[136:139], v[232:235]
    v_mul_u32_u24 v14, 1024, v37
    v_mfma_f32_16x16x32_bf16 v[236:239], a[220:223], a[140:143], v[236:239]
    ds_read_b128 a[220:223], v46 offset:45056
    v_mfma_f32_16x16x32_bf16 v[224:227], a[224:227], a[144:147], v[224:227]
    v_add_u32 v14, v14, v2
    v_mfma_f32_16x16x32_bf16 v[228:231], a[224:227], a[148:151], v[228:231]
    v_bfe_u32 v47, v1, 4, 1
    v_mfma_f32_16x16x32_bf16 v[232:235], a[224:227], a[152:155], v[232:235]
    s_waitcnt vmcnt(10)
    v_mul_u32_u24 v15, 1152, v38
    v_mfma_f32_16x16x32_bf16 v[236:239], a[224:227], a[156:159], v[236:239]
    ds_read_b128 a[224:227], v46 offset:46080
    v_mfma_f32_16x16x32_bf16 v[224:227], a[228:231], a[160:163], v[224:227]
    v_lshl_add_u32 v15, v47, 3, v15
    v_mfma_f32_16x16x32_bf16 v[228:231], a[228:231], a[164:167], v[228:231]
    v_lshrrev_b32 v47, 5, v1
    v_mfma_f32_16x16x32_bf16 v[232:235], a[228:231], a[168:171], v[232:235]
    v_lshl_add_u32 v15, v47, 6, v15
    v_mfma_f32_16x16x32_bf16 v[236:239], a[228:231], a[172:175], v[236:239]
    ds_read_b128 a[228:231], v46 offset:47104
    v_mfma_f32_16x16x32_bf16 v[224:227], a[232:235], a[176:179], v[224:227]
    v_bfe_u32 v47, v1, 2, 2
    v_mfma_f32_16x16x32_bf16 v[228:231], a[232:235], a[180:183], v[228:231]
    v_lshl_add_u32 v15, v47, 4, v15
    v_mfma_f32_16x16x32_bf16 v[232:235], a[232:235], a[184:187], v[232:235]
    s_waitcnt vmcnt(8)
    v_bfe_u32 v45, v1, 2, 1
    v_mfma_f32_16x16x32_bf16 v[236:239], a[232:235], v[48:51], v[236:239]
    ds_read_b128 a[232:235], v46 offset:48128
    v_mfma_f32_16x16x32_bf16 v[224:227], a[236:239], v[52:55], v[224:227]
    buffer_load_dwordx4 v[192:195], v2, s[8:11], s60 offen offset:0 sc1
    v_add_u32 v46, s38, v46
    v_mfma_f32_16x16x32_bf16 v[228:231], a[236:239], v[56:59], v[228:231]
    buffer_load_dwordx4 v[196:199], v2, s[8:11], s60 offen offset:1024 sc1
    v_mfma_f32_16x16x32_bf16 v[232:235], a[236:239], v[60:63], v[232:235]
    v_lshlrev_b32 v45, 4, v45
    v_mfma_f32_16x16x32_bf16 v[236:239], a[236:239], v[64:67], v[236:239]
    ds_read_b128 a[236:239], v46 offset:0
    v_mfma_f32_16x16x32_bf16 v[224:227], a[240:243], v[68:71], v[224:227]
    v_mov_b32 v47, 0x3f80
    v_mfma_f32_16x16x32_bf16 v[228:231], a[240:243], v[72:75], v[228:231]
    v_lshlrev_b32 v45, v45, v47
    v_mfma_f32_16x16x32_bf16 v[232:235], a[240:243], v[76:79], v[232:235]
    s_waitcnt vmcnt(8)
    v_lshlrev_b32 v38, 4, v38
    v_mfma_f32_16x16x32_bf16 v[236:239], a[240:243], v[80:83], v[236:239]
    ds_read_b128 a[240:243], v46 offset:1024
    v_mfma_f32_16x16x32_bf16 v[224:227], v[200:203], v[84:87], v[224:227]
    v_lshlrev_b32 v38, v38, v47
    v_mfma_f32_16x16x32_bf16 v[228:231], v[200:203], v[88:91], v[228:231]
    v_mov_b32 v8, 0
    v_mfma_f32_16x16x32_bf16 v[232:235], v[200:203], v[92:95], v[232:235]
    v_mov_b32 v9, 0
    v_mfma_f32_16x16x32_bf16 v[236:239], v[200:203], v[96:99], v[236:239]
    ds_read_b128 a[244:247], v46 offset:2048
    v_mfma_f32_16x16x32_bf16 v[224:227], v[204:207], v[100:103], v[224:227]
    v_mov_b32 v12, 0
    v_mfma_f32_16x16x32_bf16 v[228:231], v[204:207], v[104:107], v[228:231]
    v_mov_b32 v13, 0
    v_mfma_f32_16x16x32_bf16 v[232:235], v[204:207], v[108:111], v[232:235]
    s_waitcnt vmcnt(5)
    s_mov_b32 vcc_lo, 0x00110011
    s_mov_b32 vcc_hi, 0x00110011
    v_cndmask_b32 v32, 0, v45, vcc
    v_mfma_f32_16x16x32_bf16 v[236:239], v[204:207], v[112:115], v[236:239]
    ds_read_b128 a[248:251], v46 offset:32768
    v_mfma_f32_16x16x32_bf16 v[224:227], v[208:211], v[116:119], v[224:227]
    s_mov_b32 vcc_lo, 0x11001100
    s_mov_b32 vcc_hi, 0x11001100
    v_cndmask_b32 v33, 0, v45, vcc
    v_mfma_f32_16x16x32_bf16 v[228:231], v[208:211], v[120:123], v[228:231]
    s_mov_b32 vcc_lo, 0x00440044
    s_mov_b32 vcc_hi, 0x00440044
    v_cndmask_b32 v34, 0, v45, vcc
    v_mfma_f32_16x16x32_bf16 v[232:235], v[208:211], v[124:127], v[232:235]
    s_mov_b32 vcc_lo, 0x44004400
    s_mov_b32 vcc_hi, 0x44004400
    v_cndmask_b32 v35, 0, v45, vcc
    v_mfma_f32_16x16x32_bf16 v[236:239], v[208:211], v[128:131], v[236:239]
    ds_read_b128 a[252:255], v46 offset:33792
    v_mfma_f32_16x16x32_bf16 v[224:227], v[212:215], v[132:135], v[224:227]
    s_mov_b32 vcc_lo, 0x00220011
    s_mov_b32 vcc_hi, 0x00000000
    v_cndmask_b32 v40, 0, v45, vcc
    v_mfma_f32_16x16x32_bf16 v[228:231], v[212:215], v[136:139], v[228:231]
    s_mov_b32 vcc_lo, 0x22001100
    s_mov_b32 vcc_hi, 0x00000000
    v_cndmask_b32 v41, 0, v45, vcc
    v_mfma_f32_16x16x32_bf16 v[232:235], v[212:215], v[140:143], v[232:235]
    s_mov_b32 vcc_lo, 0x00880044
    s_mov_b32 vcc_hi, 0x00000000
    v_cndmask_b32 v42, 0, v45, vcc
    v_mfma_f32_16x16x32_bf16 v[236:239], v[212:215], v[144:147], v[236:239]
    s_waitcnt lgkmcnt(15)
    ds_read_b128 v[148:151], v46 offset:34816
    v_mfma_f32_16x16x32_bf16 v[240:243], a[188:191], a[0:3], 0
    s_mov_b32 vcc_lo, 0x88004400
    s_mov_b32 vcc_hi, 0x00000000
    v_cndmask_b32 v43, 0, v45, vcc
    v_mfma_f32_16x16x32_bf16 v[244:247], a[188:191], a[4:7], 0
    v_cvt_pk_bf16_f32 v16, v224, v225
    v_cvt_pk_bf16_f32 v17, v226, v227
    v_mfma_f32_16x16x32_bf16 v[248:251], a[188:191], a[8:11], 0
    v_cvt_pk_bf16_f32 v18, v228, v229
    v_cvt_pk_bf16_f32 v19, v230, v231
    v_mfma_f32_16x16x32_bf16 v[252:255], a[188:191], a[12:15], 0
    buffer_store_dwordx4 v[16:19], v2, s[8:11], s40 offen offset:0 sc1
    v_mfma_f32_16x16x32_bf16 v[240:243], a[192:195], a[16:19], v[240:243]
    v_cvt_pk_bf16_f32 v20, v232, v233
    v_cvt_pk_bf16_f32 v21, v234, v235
    v_mfma_f32_16x16x32_bf16 v[244:247], a[192:195], a[20:23], v[244:247]
    v_cvt_pk_bf16_f32 v22, v236, v237
    v_cvt_pk_bf16_f32 v23, v238, v239
    v_mfma_f32_16x16x32_bf16 v[248:251], a[192:195], a[24:27], v[248:251]
    buffer_store_dwordx4 v[20:23], v2, s[8:11], s40 offen offset:1024 sc1
    v_mfma_f32_16x16x32_bf16 v[252:255], a[192:195], a[28:31], v[252:255]
    s_mov_b32 vcc_lo, 0x05000005
    s_mov_b32 vcc_hi, 0x0a00000a
    v_cndmask_b32 v10, 0, v38, vcc
    v_mfma_f32_16x16x32_bf16 v[240:243], a[196:199], a[32:35], v[240:243]
    s_mov_b32 vcc_lo, 0x50000050
    s_mov_b32 vcc_hi, 0xa00000a0
    v_cndmask_b32 v11, 0, v38, vcc
    v_mfma_f32_16x16x32_bf16 v[244:247], a[196:199], a[36:39], v[244:247]
    s_waitcnt lgkmcnt(12)
    v_mfma_f32_16x16x32_bf16 v[248:251], a[196:199], a[40:43], v[248:251]
    v_mov_b32 v221, v220
    v_mfma_f32_16x16x32_bf16 v[252:255], a[196:199], a[44:47], v[252:255]
    v_mov_b32 v222, v220
    v_mfma_f32_16x16x32_bf16 v[240:243], a[200:203], a[48:51], v[240:243]
    v_mov_b32 v223, v220
    v_mfma_f32_16x16x32_bf16 v[244:247], a[200:203], a[52:55], v[244:247]
    ds_read_b128 v[224:227], v44 offset:0
    v_mfma_f32_16x16x32_bf16 v[248:251], a[200:203], a[56:59], v[248:251]
L_tp30:
    s_cbranch_execz L_tret
    ds_read_b128 v[228:231], v44 offset:1024
    v_mfma_f32_16x16x32_bf16 v[252:255], a[200:203], a[60:63], v[252:255]
    ds_read_b128 v[232:235], v44 offset:2048
    v_mfma_f32_16x16x32_bf16 v[240:243], a[204:207], a[64:67], v[240:243]
    v_mfma_f32_16x16x32_bf16 v[244:247], a[204:207], a[68:71], v[244:247]
    v_mfma_f32_16x16x32_bf16 v[248:251], a[204:207], a[72:75], v[248:251]
    v_mfma_f32_16x16x32_bf16 v[252:255], a[204:207], a[76:79], v[252:255]
    v_mfma_f32_16x16x32_bf16 v[240:243], a[208:211], a[80:83], v[240:243]
    v_mfma_f32_16x16x32_bf16 v[244:247], a[208:211], a[84:87], v[244:247]
    v_mfma_f32_16x16x32_bf16 v[248:251], a[208:211], a[88:91], v[248:251]
    v_mfma_f32_16x16x32_bf16 v[252:255], a[208:211], a[92:95], v[252:255]
    s_waitcnt lgkmcnt(14)
    v_mfma_f32_16x16x32_bf16 v[240:243], a[212:215], a[96:99], v[240:243]
    v_mfma_f32_16x16x32_bf16 v[244:247], a[212:215], a[100:103], v[244:247]
    v_mfma_f32_16x16x32_bf16 v[248:251], a[212:215], a[104:107], v[248:251]
    v_mfma_f32_16x16x32_bf16 v[252:255], a[212:215], a[108:111], v[252:255]
    s_waitcnt lgkmcnt(13)
    v_mfma_f32_16x16x32_bf16 v[240:243], a[216:219], a[112:115], v[240:243]
    v_mfma_f32_16x16x32_bf16 v[244:247], a[216:219], a[116:119], v[244:247]
    v_mfma_f32_16x16x32_bf16 v[248:251], a[216:219], a[120:123], v[248:251]
    v_mfma_f32_16x16x32_bf16 v[252:255], a[216:219], a[124:127], v[252:255]
    s_waitcnt lgkmcnt(12)
    v_mfma_f32_16x16x32_bf16 v[240:243], a[220:223], a[128:131], v[240:243]
    v_mfma_f32_16x16x32_bf16 v[244:247], a[220:223], a[132:135], v[244:247]
    v_mfma_f32_16x16x32_bf16 v[248:251], a[220:223], a[136:139], v[248:251]
    v_mfma_f32_16x16x32_bf16 v[252:255], a[220:223], a[140:143], v[252:255]
    s_waitcnt lgkmcnt(11)
    v_mfma_f32_16x16x32_bf16 v[240:243], a[224:227], a[144:147], v[240:243]
    buffer_load_dwordx4 v[200:203], v2, s[8:11], s61 offen offset:0 sc1
    v_mfma_f32_16x16x32_bf16 v[244:247], a[224:227], a[148:151], v[244:247]
    buffer_load_dwordx4 v[204:207], v2, s[8:11], s61 offen offset:1024 sc1
    v_mfma_f32_16x16x32_bf16 v[248:251], a[224:227], a[152:155], v[248:251]
    v_mfma_f32_16x16x32_bf16 v[252:255], a[224:227], a[156:159], v[252:255]
    s_waitcnt lgkmcnt(10)
    v_mfma_f32_16x16x32_bf16 v[240:243], a[228:231], a[160:163], v[240:243]
    v_mfma_f32_16x16x32_bf16 v[244:247], a[228:231], a[164:167], v[244:247]
    v_mfma_f32_16x16x32_bf16 v[248:251], a[228:231], a[168:171], v[248:251]
    v_mfma_f32_16x16x32_bf16 v[252:255], a[228:231], a[172:175], v[252:255]
    s_waitcnt lgkmcnt(9)
    v_mfma_f32_16x16x32_bf16 v[240:243], a[232:235], a[176:179], v[240:243]
    v_mfma_f32_16x16x32_bf16 v[244:247], a[232:235], a[180:183], v[244:247]
    v_mfma_f32_16x16x32_bf16 v[248:251], a[232:235], a[184:187], v[248:251]
    v_mfma_f32_16x16x32_bf16 v[252:255], a[232:235], v[48:51], v[252:255]
    s_waitcnt lgkmcnt(8)
    v_mfma_f32_16x16x32_bf16 v[240:243], a[236:239], v[52:55], v[240:243]
    v_mfma_f32_16x16x32_bf16 v[244:247], a[236:239], v[56:59], v[244:247]
    v_mfma_f32_16x16x32_bf16 v[248:251], a[236:239], v[60:63], v[248:251]
    v_mfma_f32_16x16x32_bf16 v[252:255], a[236:239], v[64:67], v[252:255]
    s_waitcnt lgkmcnt(7)
    v_mfma_f32_16x16x32_bf16 v[240:243], a[240:243], v[68:71], v[240:243]
    v_mfma_f32_16x16x32_bf16 v[244:247], a[240:243], v[72:75], v[244:247]
    v_mfma_f32_16x16x32_bf16 v[248:251], a[240:243], v[76:79], v[248:251]
    v_mfma_f32_16x16x32_bf16 v[252:255], a[240:243], v[80:83], v[252:255]
    s_waitcnt lgkmcnt(6)
    v_mfma_f32_16x16x32_bf16 v[240:243], a[244:247], v[84:87], v[240:243]
    v_mfma_f32_16x16x32_bf16 v[244:247], a[244:247], v[88:91], v[244:247]
    v_mfma_f32_16x16x32_bf16 v[248:251], a[244:247], v[92:95], v[248:251]
    v_mfma_f32_16x16x32_bf16 v[252:255], a[244:247], v[96:99], v[252:255]
    s_waitcnt lgkmcnt(5)
    v_mfma_f32_16x16x32_bf16 v[240:243], a[248:251], v[100:103], v[240:243]
    v_mfma_f32_16x16x32_bf16 v[244:247], a[248:251], v[104:107], v[244:247]
    v_mfma_f32_16x16x32_bf16 v[248:251], a[248:251], v[108:111], v[248:251]
    v_mfma_f32_16x16x32_bf16 v[252:255], a[248:251], v[112:115], v[252:255]
    s_waitcnt lgkmcnt(4)
    v_mfma_f32_16x16x32_bf16 v[240:243], a[252:255], v[116:119], v[240:243]
    v_mfma_f32_16x16x32_bf16 v[244:247], a[252:255], v[120:123], v[244:247]
    v_mfma_f32_16x16x32_bf16 v[248:251], a[252:255], v[124:127], v[248:251]
    v_mfma_f32_16x16x32_bf16 v[252:255], a[252:255], v[128:131], v[252:255]
    s_waitcnt lgkmcnt(3)
    v_mfma_f32_16x16x32_bf16 v[240:243], v[148:151], v[132:135], v[240:243]
    v_mfma_f32_16x16x32_bf16 v[244:247], v[148:151], v[136:139], v[244:247]
    v_mfma_f32_16x16x32_bf16 v[248:251], v[148:151], v[140:143], v[248:251]
    v_mfma_f32_16x16x32_bf16 v[252:255], v[148:151], v[144:147], v[252:255]
    s_mov_b32 s100, 0xbf317218
    s_waitcnt lgkmcnt(0)
    v_mfma_f32_16x16x32_bf16 v[48:51], v[10:13], v[224:227], 0
    v_mfma_f32_16x16x32_bf16 v[52:55], v[8:11], v[224:227], 0
    v_mfma_f32_16x16x32_bf16 v[56:59], v[10:13], v[228:231], 0
    v_mfma_f32_16x16x32_bf16 v[60:63], v[8:11], v[228:231], 0
    v_mfma_f32_16x16x32_bf16 v[68:71], v[232:235], v[40:43], v[220:223]
    v_mfma_f32_16x16x32_bf16 v[64:67], v[152:155], v[32:35], 0
    v_mfma_f32_16x16x32_bf16 v[64:67], v[156:159], v[32:35], v[64:67]
    v_mfma_f32_16x16x32_bf16 v[80:83], v[10:13], v[160:163], v[240:243]
    s_nop 0
    v_add_f32 v48, v48, v216
    v_add_f32 v49, v49, v216
    v_mfma_f32_16x16x32_bf16 v[84:87], v[8:11], v[160:163], v[244:247]
    v_add_f32 v50, v50, v216
    v_add_f32 v51, v51, v216
    v_mfma_f32_16x16x32_bf16 v[88:91], v[10:13], v[164:167], v[248:251]
    v_add_f32 v52, v52, v217
    v_add_f32 v53, v53, v217
    v_mfma_f32_16x16x32_bf16 v[92:95], v[8:11], v[164:167], v[252:255]
    v_add_f32 v54, v54, v217
    v_add_f32 v55, v55, v217
    v_mfma_f32_16x16x32_bf16 v[80:83], v[10:13], v[168:171], v[80:83]
    v_add_f32 v56, v56, v218
    v_add_f32 v57, v57, v218
    v_mfma_f32_16x16x32_bf16 v[84:87], v[8:11], v[168:171], v[84:87]
    v_add_f32 v58, v58, v218
    v_add_f32 v59, v59, v218
    v_mfma_f32_16x16x32_bf16 v[88:91], v[10:13], v[172:175], v[88:91]
    v_add_f32 v60, v60, v219
    v_add_f32 v61, v61, v219
    v_mfma_f32_16x16x32_bf16 v[92:95], v[8:11], v[172:175], v[92:95]
    v_add_f32 v62, v62, v219
    v_add_f32 v63, v63, v219
    v_mfma_f32_16x16x32_bf16 v[80:83], v[10:13], v[176:179], v[80:83]
    v_mfma_f32_16x16x32_bf16 v[84:87], v[8:11], v[176:179], v[84:87]
    v_mfma_f32_16x16x32_bf16 v[88:91], v[10:13], v[180:183], v[88:91]
    v_mfma_f32_16x16x32_bf16 v[92:95], v[8:11], v[180:183], v[92:95]
    v_cmp_u_f32 vcc, v64, v65
    v_cmp_u_f32 s[68:69], v66, v67
    s_nop 0
    s_or_b64 vcc, vcc, s[68:69]
    s_cbranch_vccnz L_k4_ree
L_k4_oke:
    v_fmac_f32 v68, s100, v64
    v_fmac_f32 v69, s100, v65
    v_fmac_f32 v70, s100, v66
    v_fmac_f32 v71, s100, v67
    v_cvt_pk_bf16_f32 v68, v68, v69
    v_cvt_pk_bf16_f32 v69, v70, v71
    s_mov_b32 exec_lo, 0x55555555
    s_mov_b32 exec_hi, 0x55555555
    buffer_store_dwordx2 v[68:69], v15, s[12:15], s50 offen offset:1024
    s_mov_b64 exec, -1
    s_waitcnt vmcnt(8)
    v_mfma_f32_16x16x32_bf16 v[80:83], v[10:13], v[184:187], v[80:83]
    v_mfma_f32_16x16x32_bf16 v[84:87], v[8:11], v[184:187], v[84:87]
    s_waitcnt vmcnt(7)
    v_mfma_f32_16x16x32_bf16 v[88:91], v[10:13], v[188:191], v[88:91]
    v_mfma_f32_16x16x32_bf16 v[92:95], v[8:11], v[188:191], v[92:95]
    buffer_load_dwordx4 v[208:211], v2, s[8:11], s62 offen offset:0 sc1
    buffer_load_dwordx4 v[212:215], v2, s[8:11], s62 offen offset:1024 sc1
    s_waitcnt vmcnt(8)
    v_mfma_f32_16x16x32_bf16 v[80:83], v[10:13], v[192:195], v[80:83]
    v_mfma_f32_16x16x32_bf16 v[84:87], v[8:11], v[192:195], v[84:87]
    s_waitcnt vmcnt(7)
    v_mfma_f32_16x16x32_bf16 v[88:91], v[10:13], v[196:199], v[88:91]
    v_mfma_f32_16x16x32_bf16 v[92:95], v[8:11], v[196:199], v[92:95]
    s_nop 6
    v_cmp_u_f32 vcc, v80, v88
    s_cbranch_vccnz L_k4_re0
L_k4_ok0:
    s_waitcnt vmcnt(4)
    v_mfma_f32_16x16x32_bf16 v[96:99], v[10:13], v[200:203], v[80:83]
    v_mfma_f32_16x16x32_bf16 v[100:103], v[8:11], v[200:203], v[84:87]
    s_waitcnt vmcnt(3)
    v_mfma_f32_16x16x32_bf16 v[104:107], v[10:13], v[204:207], v[88:91]
    v_mfma_f32_16x16x32_bf16 v[108:111], v[8:11], v[204:207], v[92:95]
    s_nop 6
    v_cmp_u_f32 vcc, v96, v104
    s_cbranch_vccnz L_k4_re1
L_k4_ok1:
    s_waitcnt vmcnt(1)
    v_mfma_f32_16x16x32_bf16 v[112:115], v[10:13], v[208:211], v[96:99]
L_tp31:
    s_cbranch_execz L_tret
    v_mfma_f32_16x16x32_bf16 v[116:119], v[8:11], v[208:211], v[100:103]
    s_waitcnt vmcnt(0)
    v_mfma_f32_16x16x32_bf16 v[120:123], v[10:13], v[212:215], v[104:107]
    v_mfma_f32_16x16x32_bf16 v[124:127], v[8:11], v[212:215], v[108:111]
    s_nop 6
    v_cmp_u_f32 vcc, v112, v120
    s_cbranch_vccnz L_k4_re2
L_k4_ok2:
    v_fmac_f32 v48, s100, v112
    v_fmac_f32 v49, s100, v113
    v_fmac_f32 v50, s100, v114
    v_fmac_f32 v51, s100, v115
    v_cvt_pk_bf16_f32 v48, v48, v49
    v_cvt_pk_bf16_f32 v49, v50, v51
    ds_write_b64 v3, v[48:49] offset:0
    v_fmac_f32 v52, s100, v116
    v_fmac_f32 v53, s100, v117
    v_fmac_f32 v54, s100, v118
    v_fmac_f32 v55, s100, v119
    v_cvt_pk_bf16_f32 v52, v52, v53
    v_cvt_pk_bf16_f32 v53, v54, v55
    ds_write_b64 v3, v[52:53] offset:512
    v_fmac_f32 v56, s100, v120
    v_fmac_f32 v57, s100, v121
    v_fmac_f32 v58, s100, v122
    v_fmac_f32 v59, s100, v123
    v_cvt_pk_bf16_f32 v56, v56, v57
    v_cvt_pk_bf16_f32 v57, v58, v59
    ds_write_b64 v3, v[56:57] offset:1024
    v_fmac_f32 v60, s100, v124
    v_fmac_f32 v61, s100, v125
    v_fmac_f32 v62, s100, v126
    v_fmac_f32 v63, s100, v127
    v_cvt_pk_bf16_f32 v60, v60, v61
    v_cvt_pk_bf16_f32 v61, v62, v63
    ds_write_b64 v3, v[60:61] offset:1536
    s_waitcnt lgkmcnt(0)
    s_barrier
    ds_read2st64_b32 v[72:73], v4 offset0:0 offset1:16
    ds_read2st64_b32 v[74:75], v4 offset0:32 offset1:48
    ds_read2st64_b32 v[76:77], v4 offset0:1 offset1:17
    ds_read2st64_b32 v[78:79], v4 offset0:33 offset1:49
    s_waitcnt lgkmcnt(2)
    buffer_store_dwordx4 v[72:75], v14, s[12:15], s49 offen
    s_waitcnt lgkmcnt(0)
    buffer_store_dwordx4 v[76:79], v14, s[12:15], s46 offen
L_end_k3_kernel:
    s_endpgm
L_k4_re1:
    v_cmpx_ne_u32 vcc, s54, v200
    v_cmpx_ne_u32 vcc, s54, v201
    v_cmpx_ne_u32 vcc, s54, v202
    v_cmpx_ne_u32 vcc, s54, v203
    v_cmpx_ne_u32 vcc, s54, v204
    v_cmpx_ne_u32 vcc, s54, v205
    v_cmpx_ne_u32 vcc, s54, v206
    v_cmpx_ne_u32 vcc, s54, v207
    s_sub_u32 s52, s52, 1
    s_cmp_eq_u64 exec, -1
    s_mov_b64 exec, -1
    s_cbranch_scc1 L_k4_ok1
    s_cmp_lt_i32 s52, 0
    s_cbranch_scc1 L_k4_ok1
    buffer_load_dwordx4 v[200:203], v2, s[8:11], s61 offen offset:0 sc1
    buffer_load_dwordx4 v[204:207], v2, s[8:11], s61 offen offset:1024 sc1
    s_waitcnt vmcnt(0)
    v_mfma_f32_16x16x32_bf16 v[96:99], v[10:13], v[200:203], v[80:83]
    v_mfma_f32_16x16x32_bf16 v[100:103], v[8:11], v[200:203], v[84:87]
    v_mfma_f32_16x16x32_bf16 v[104:107], v[10:13], v[204:207], v[88:91]
    v_mfma_f32_16x16x32_bf16 v[108:111], v[8:11], v[204:207], v[92:95]
    s_nop 6
    v_cmp_u_f32 vcc, v96, v104
    s_cbranch_vccnz L_k4_re1
    s_branch L_k4_ok1
L_k4_re0:
    v_cmpx_ne_u32 vcc, s54, v160
    v_cmpx_ne_u32 vcc, s54, v161
    v_cmpx_ne_u32 vcc, s54, v162
    v_cmpx_ne_u32 vcc, s54, v163
    v_cmpx_ne_u32 vcc, s54, v164
    v_cmpx_ne_u32 vcc, s54, v165
    v_cmpx_ne_u32 vcc, s54, v166
    v_cmpx_ne_u32 vcc, s54, v167
    v_cmpx_ne_u32 vcc, s54, v168
    v_cmpx_ne_u32 vcc, s54, v169
    v_cmpx_ne_u32 vcc, s54, v170
    v_cmpx_ne_u32 vcc, s54, v171
    v_cmpx_ne_u32 vcc, s54, v172
    v_cmpx_ne_u32 vcc, s54, v173
    v_cmpx_ne_u32 vcc, s54, v174
    v_cmpx_ne_u32 vcc, s54, v175
    v_cmpx_ne_u32 vcc, s54, v176
    v_cmpx_ne_u32 vcc, s54, v177
    v_cmpx_ne_u32 vcc, s54, v178
    v_cmpx_ne_u32 vcc, s54, v179
    v_cmpx_ne_u32 vcc, s54, v180
    v_cmpx_ne_u32 vcc, s54, v181
    v_cmpx_ne_u32 vcc, s54, v182
    v_cmpx_ne_u32 vcc, s54, v183
    v_cmpx_ne_u32 vcc, s54, v184
    v_cmpx_ne_u32 vcc, s54, v185
    v_cmpx_ne_u32 vcc, s54, v186
    v_cmpx_ne_u32 vcc, s54, v187
    v_cmpx_ne_u32 vcc, s54, v188
    v_cmpx_ne_u32 vcc, s54, v189
    v_cmpx_ne_u32 vcc, s54, v190
    v_cmpx_ne_u32 vcc, s54, v191
    v_cmpx_ne_u32 vcc, s54, v192
    v_cmpx_ne_u32 vcc, s54, v193
    v_cmpx_ne_u32 vcc, s54, v194
    v_cmpx_ne_u32 vcc, s54, v195
    v_cmpx_ne_u32 vcc, s54, v196
    v_cmpx_ne_u32 vcc, s54, v197
    v_cmpx_ne_u32 vcc, s54, v198
    v_cmpx_ne_u32 vcc, s54, v199
    s_sub_u32 s52, s52, 1
    s_cmp_eq_u64 exec, -1
    s_mov_b64 exec, -1
    s_cbranch_scc1 L_k4_ok0
    s_cmp_lt_i32 s52, 0
    s_cbranch_scc1 L_k4_ok0
    buffer_load_dwordx4 v[160:163], v2, s[8:11], s56 offen offset:0 sc1
    buffer_load_dwordx4 v[164:167], v2, s[8:11], s56 offen offset:1024 sc1
    buffer_load_dwordx4 v[168:171], v2, s[8:11], s57 offen offset:0 sc1
    buffer_load_dwordx4 v[172:175], v2, s[8:11], s57 offen offset:1024 sc1
    buffer_load_dwordx4 v[176:179], v2, s[8:11], s58 offen offset:0 sc1
    buffer_load_dwordx4 v[180:183], v2, s[8:11], s58 offen offset:1024 sc1
    buffer_load_dwordx4 v[184:187], v2, s[8:11], s59 offen offset:0 sc1
    buffer_load_dwordx4 v[188:191], v2, s[8:11], s59 offen offset:1024 sc1
    buffer_load_dwordx4 v[192:195], v2, s[8:11], s60 offen offset:0 sc1
    buffer_load_dwordx4 v[196:199], v2, s[8:11], s60 offen offset:1024 sc1
    s_waitcnt vmcnt(0)
    v_mfma_f32_16x16x32_bf16 v[80:83], v[10:13], v[160:163], v[240:243]
    v_mfma_f32_16x16x32_bf16 v[84:87], v[8:11], v[160:163], v[244:247]
    v_mfma_f32_16x16x32_bf16 v[88:91], v[10:13], v[164:167], v[248:251]
    v_mfma_f32_16x16x32_bf16 v[92:95], v[8:11], v[164:167], v[252:255]
    v_mfma_f32_16x16x32_bf16 v[80:83], v[10:13], v[168:171], v[80:83]
    v_mfma_f32_16x16x32_bf16 v[84:87], v[8:11], v[168:171], v[84:87]
    v_mfma_f32_16x16x32_bf16 v[88:91], v[10:13], v[172:175], v[88:91]
    v_mfma_f32_16x16x32_bf16 v[92:95], v[8:11], v[172:175], v[92:95]
    v_mfma_f32_16x16x32_bf16 v[80:83], v[10:13], v[176:179], v[80:83]
    v_mfma_f32_16x16x32_bf16 v[84:87], v[8:11], v[176:179], v[84:87]
    v_mfma_f32_16x16x32_bf16 v[88:91], v[10:13], v[180:183], v[88:91]
    v_mfma_f32_16x16x32_bf16 v[92:95], v[8:11], v[180:183], v[92:95]
    v_mfma_f32_16x16x32_bf16 v[80:83], v[10:13], v[184:187], v[80:83]
    v_mfma_f32_16x16x32_bf16 v[84:87], v[8:11], v[184:187], v[84:87]
    v_mfma_f32_16x16x32_bf16 v[88:91], v[10:13], v[188:191], v[88:91]
    v_mfma_f32_16x16x32_bf16 v[92:95], v[8:11], v[188:191], v[92:95]
    v_mfma_f32_16x16x32_bf16 v[80:83], v[10:13], v[192:195], v[80:83]
    v_mfma_f32_16x16x32_bf16 v[84:87], v[8:11], v[192:195], v[84:87]
    v_mfma_f32_16x16x32_bf16 v[88:91], v[10:13], v[196:199], v[88:91]
    v_mfma_f32_16x16x32_bf16 v[92:95], v[8:11], v[196:199], v[92:95]
    s_nop 6
    v_cmp_u_f32 vcc, v80, v88
    s_cbranch_vccnz L_k4_re0
    s_branch L_k4_ok0
L_k4_ree:
    v_cmpx_ne_u32 vcc, s54, v152
    v_cmpx_ne_u32 vcc, s54, v153
    v_cmpx_ne_u32 vcc, s54, v154
    v_cmpx_ne_u32 vcc, s54, v155
    v_cmpx_ne_u32 vcc, s54, v156
    v_cmpx_ne_u32 vcc, s54, v157
    v_cmpx_ne_u32 vcc, s54, v158
    v_cmpx_ne_u32 vcc, s54, v159
    s_sub_u32 s52, s52, 1
    s_cmp_eq_u64 exec, -1
    s_mov_b64 exec, -1
    s_cbranch_scc1 L_k4_oke
    s_cmp_lt_i32 s52, 0
    s_cbranch_scc1 L_k4_oke
    buffer_load_dwordx4 v[152:155], v39, s[8:11], s53 offen sc1
    buffer_load_dwordx4 v[156:159], v39, s[8:11], s45 offen sc1
    s_waitcnt vmcnt(0)
    v_mfma_f32_16x16x32_bf16 v[64:67], v[152:155], v[32:35], 0
    v_mfma_f32_16x16x32_bf16 v[64:67], v[156:159], v[32:35], v[64:67]
    s_nop 7
    v_cmp_u_f32 vcc, v64, v65
    v_cmp_u_f32 s[68:69], v66, v67
    s_nop 0
    s_or_b64 vcc, vcc, s[68:69]
    s_cbranch_vccnz L_k4_ree
    s_branch L_k4_oke
L_k4_redo:
    s_mov_b32 s34, 0
L_k4_redo1:
    s_waitcnt vmcnt(0) lgkmcnt(0)
    v_mov_b32 v20, v2
    s_mov_b32 s33, 72
L_k4_scan:
    s_mov_b64 exec, -1
    ds_read_b128 v[16:19], v20
    v_add_u32 v20, 1024, v20
    s_waitcnt lgkmcnt(0)
    v_cmpx_ne_u32 vcc, s54, v16
    v_cmpx_ne_u32 vcc, s54, v17
    v_cmpx_ne_u32 vcc, s54, v18
    v_cmpx_ne_u32 vcc, s54, v19
    s_sub_u32 s33, s33, 1
    s_cmp_eq_u64 exec, -1
    s_mov_b64 exec, -1
    s_cbranch_scc0 L_k4_again
    s_cmp_lg_u32 s33, 0
    s_cbranch_scc1 L_k4_scan
L_k4_clean:
    s_cmp_eq_u32 s34, 0
    s_cbranch_scc1 L_k4_t1
    ds_read_b128 a[0:3], v8 offset:0
    ds_read_b128 a[4:7], v8 offset:18432
    ds_read_b128 a[8:11], v10 offset:0
    ds_read_b128 a[12:15], v10 offset:18432
    ds_read_b128 a[16:19], v8 offset:1024
    ds_read_b128 a[20:23], v8 offset:19456
    ds_read_b128 a[24:27], v10 offset:1024
    ds_read_b128 a[28:31], v10 offset:19456
    ds_read_b128 a[32:35], v8 offset:2048
    ds_read_b128 a[36:39], v8 offset:20480
    ds_read_b128 a[40:43], v10 offset:2048
    ds_read_b128 a[44:47], v10 offset:20480
    ds_read_b128 a[48:51], v8 offset:3072
    ds_read_b128 a[52:55], v8 offset:21504
    ds_read_b128 a[56:59], v10 offset:3072
    ds_read_b128 a[60:63], v10 offset:21504
    ds_read_b128 a[64:67], v8 offset:4096
    ds_read_b128 a[68:71], v8 offset:22528
    ds_read_b128 a[72:75], v10 offset:4096
    ds_read_b128 a[76:79], v10 offset:22528
    ds_read_b128 a[80:83], v8 offset:5120
    ds_read_b128 a[84:87], v8 offset:23552
    ds_read_b128 a[88:91], v10 offset:5120
    ds_read_b128 a[92:95], v10 offset:23552
    ds_read_b128 a[96:99], v8 offset:6144
    ds_read_b128 a[100:103], v8 offset:24576
    ds_read_b128 a[104:107], v10 offset:6144
    ds_read_b128 a[108:111], v10 offset:24576
    ds_read_b128 a[112:115], v8 offset:7168
    ds_read_b128 a[116:119], v8 offset:25600
    ds_read_b128 a[120:123], v10 offset:7168
    ds_read_b128 a[124:127], v10 offset:25600
    ds_read_b128 a[128:131], v8 offset:8192
    ds_read_b128 a[132:135], v8 offset:26624
    ds_read_b128 a[136:139], v10 offset:8192
    ds_read_b128 a[140:143], v10 offset:26624
    ds_read_b128 a[144:147], v8 offset:9216
    ds_read_b128 a[148:151], v8 offset:27648
    ds_read_b128 a[152:155], v10 offset:9216
    ds_read_b128 a[156:159], v10 offset:27648
    ds_read_b128 a[160:163], v8 offset:10240
    ds_read_b128 a[164:167], v8 offset:28672
    ds_read_b128 a[168:171], v10 offset:10240
    ds_read_b128 a[172:175], v10 offset:28672
    ds_read_b128 a[176:179], v8 offset:11264
    ds_read_b128 a[180:183], v8 offset:29696
    ds_read_b128 a[184:187], v10 offset:11264
    ds_read_b128 v[48:51], v10 offset:29696
    ds_read_b128 v[52:55], v8 offset:12288
    ds_read_b128 v[56:59], v8 offset:30720
    ds_read_b128 v[60:63], v10 offset:12288
    ds_read_b128 v[64:67], v10 offset:30720
    ds_read_b128 v[68:71], v8 offset:13312
    ds_read_b128 v[72:75], v8 offset:31744
    ds_read_b128 v[76:79], v10 offset:13312
    ds_read_b128 v[80:83], v10 offset:31744
    ds_read_b128 v[84:87], v8 offset:14336
    ds_read_b128 v[88:91], v8 offset:32768
    ds_read_b128 v[92:95], v10 offset:14336
    ds_read_b128 v[96:99], v10 offset:32768
    ds_read_b128 v[100:103], v8 offset:15360
    ds_read_b128 v[104:107], v8 offset:33792
    ds_read_b128 v[108:111], v10 offset:15360
    ds_read_b128 v[112:115], v10 offset:33792
    ds_read2st64_b32 v[116:117], v7 offset0:0 offset1:1
    ds_read2st64_b32 v[118:119], v7 offset0:2 offset1:3
    ds_read2st64_b32 v[120:121], v7 offset0:72 offset1:73
    ds_read2st64_b32 v[122:123], v7 offset0:74 offset1:75
    ds_read2st64_b32 v[124:125], v7 offset0:144 offset1:145
    ds_read2st64_b32 v[126:127], v7 offset0:146 offset1:147
    ds_read2st64_b32 v[128:129], v7 offset0:216 offset1:217
    ds_read2st64_b32 v[130:131], v7 offset0:218 offset1:219
    ds_read2st64_b32 v[132:133], v7 offset0:4 offset1:5
    ds_read2st64_b32 v[134:135], v7 offset0:6 offset1:7
    ds_read2st64_b32 v[136:137], v7 offset0:76 offset1:77
    ds_read2st64_b32 v[138:139], v7 offset0:78 offset1:79
    ds_read2st64_b32 v[140:141], v7 offset0:148 offset1:149
    ds_read2st64_b32 v[142:143], v7 offset0:150 offset1:151
    ds_read2st64_b32 v[144:145], v7 offset0:220 offset1:221
    ds_read2st64_b32 v[146:147], v7 offset0:222 offset1:223
    s_waitcnt lgkmcnt(0)
    s_waitcnt lgkmcnt(0)
    s_waitcnt lgkmcnt(0)
    s_waitcnt lgkmcnt(0)
    s_waitcnt lgkmcnt(0)
    s_waitcnt lgkmcnt(0)
    s_waitcnt lgkmcnt(0)
    s_waitcnt lgkmcnt(0)
    s_waitcnt lgkmcnt(0)
    ds_read_b64 v[16:17], v38 offset:0
    ds_read_b64 v[18:19], v38 offset:18432
    ds_read_b64 v[20:21], v38 offset:36864
    ds_read_b64 v[22:23], v38 offset:55296
    ds_read2_b32 v[24:25], v45 offset1:64
    ds_read2_b32 v[26:27], v45 offset0:1 offset1:65
    s_waitcnt lgkmcnt(0)
    ds_write_b128 v44, v[16:19] offset:0
    ds_write_b128 v44, v[20:23] offset:1024
    ds_write_b128 v44, v[24:27] offset:2048
    buffer_load_dwordx4 v[32:35], v2, s[8:11], s51 offen offset:0
    s_waitcnt vmcnt(0)
    v_mfma_f32_16x16x32_bf16 v[224:227], v[32:35], a[0:3], 0
    v_mfma_f32_16x16x32_bf16 v[228:231], v[32:35], a[4:7], 0
    v_mfma_f32_16x16x32_bf16 v[232:235], v[32:35], a[8:11], 0
    v_mfma_f32_16x16x32_bf16 v[236:239], v[32:35], a[12:15], 0
    buffer_load_dwordx4 v[32:35], v2, s[8:11], s51 offen offset:1024
    s_waitcnt vmcnt(0)
    v_mfma_f32_16x16x32_bf16 v[224:227], v[32:35], a[16:19], v[224:227]
    v_mfma_f32_16x16x32_bf16 v[228:231], v[32:35], a[20:23], v[228:231]
    v_mfma_f32_16x16x32_bf16 v[232:235], v[32:35], a[24:27], v[232:235]
    v_mfma_f32_16x16x32_bf16 v[236:239], v[32:35], a[28:31], v[236:239]
    buffer_load_dwordx4 v[32:35], v2, s[8:11], s51 offen offset:2048
    s_waitcnt vmcnt(0)
    v_mfma_f32_16x16x32_bf16 v[224:227], v[32:35], a[32:35], v[224:227]
    v_mfma_f32_16x16x32_bf16 v[228:231], v[32:35], a[36:39], v[228:231]
    v_mfma_f32_16x16x32_bf16 v[232:235], v[32:35], a[40:43], v[232:235]
    v_mfma_f32_16x16x32_bf16 v[236:239], v[32:35], a[44:47], v[236:239]
    buffer_load_dwordx4 v[32:35], v2, s[8:11], s51 offen offset:3072
    s_waitcnt vmcnt(0)
    v_mfma_f32_16x16x32_bf16 v[224:227], v[32:35], a[48:51], v[224:227]
    v_mfma_f32_16x16x32_bf16 v[228:231], v[32:35], a[52:55], v[228:231]
    v_mfma_f32_16x16x32_bf16 v[232:235], v[32:35], a[56:59], v[232:235]
    v_mfma_f32_16x16x32_bf16 v[236:239], v[32:35], a[60:63], v[236:239]
    buffer_load_dwordx4 v[32:35], v3, s[8:11], s51 offen offset:0
    s_waitcnt vmcnt(0)
    v_mfma_f32_16x16x32_bf16 v[224:227], v[32:35], a[64:67], v[224:227]
    v_mfma_f32_16x16x32_bf16 v[228:231], v[32:35], a[68:71], v[228:231]
    v_mfma_f32_16x16x32_bf16 v[232:235], v[32:35], a[72:75], v[232:235]
    v_mfma_f32_16x16x32_bf16 v[236:239], v[32:35], a[76:79], v[236:239]
    buffer_load_dwordx4 v[32:35], v3, s[8:11], s51 offen offset:1024
    s_waitcnt vmcnt(0)
    v_mfma_f32_16x16x32_bf16 v[224:227], v[32:35], a[80:83], v[224:227]
    v_mfma_f32_16x16x32_bf16 v[228:231], v[32:35], a[84:87], v[228:231]
    v_mfma_f32_16x16x32_bf16 v[232:235], v[32:35], a[88:91], v[232:235]
    v_mfma_f32_16x16x32_bf16 v[236:239], v[32:35], a[92:95], v[236:239]
    buffer_load_dwordx4 v[32:35], v3, s[8:11], s51 offen offset:2048
    s_waitcnt vmcnt(0)
    v_mfma_f32_16x16x32_bf16 v[224:227], v[32:35], a[96:99], v[224:227]
    v_mfma_f32_16x16x32_bf16 v[228:231], v[32:35], a[100:103], v[228:231]
    v_mfma_f32_16x16x32_bf16 v[232:235], v[32:35], a[104:107], v[232:235]
    v_mfma_f32_16x16x32_bf16 v[236:239], v[32:35], a[108:111], v[236:239]
    buffer_load_dwordx4 v[32:35], v3, s[8:11], s51 offen offset:3072
    s_waitcnt vmcnt(0)
    v_mfma_f32_16x16x32_bf16 v[224:227], v[32:35], a[112:115], v[224:227]
    v_mfma_f32_16x16x32_bf16 v[228:231], v[32:35], a[116:119], v[228:231]
    v_mfma_f32_16x16x32_bf16 v[232:235], v[32:35], a[120:123], v[232:235]
    v_mfma_f32_16x16x32_bf16 v[236:239], v[32:35], a[124:127], v[236:239]
    buffer_load_dwordx4 v[32:35], v4, s[8:11], s51 offen offset:0
    s_waitcnt vmcnt(0)
    v_mfma_f32_16x16x32_bf16 v[224:227], v[32:35], a[128:131], v[224:227]
    v_mfma_f32_16x16x32_bf16 v[228:231], v[32:35], a[132:135], v[228:231]
    v_mfma_f32_16x16x32_bf16 v[232:235], v[32:35], a[136:139], v[232:235]
    v_mfma_f32_16x16x32_bf16 v[236:239], v[32:35], a[140:143], v[236:239]
    buffer_load_dwordx4 v[32:35], v4, s[8:11], s51 offen offset:1024
    s_waitcnt vmcnt(0)
    v_mfma_f32_16x16x32_bf16 v[224:227], v[32:35], a[144:147], v[224:227]
    v_mfma_f32_16x16x32_bf16 v[228:231], v[32:35], a[148:151], v[228:231]
    v_mfma_f32_16x16x32_bf16 v[232:235], v[32:35], a[152:155], v[232:235]
    v_mfma_f32_16x16x32_bf16 v[236:239], v[32:35], a[156:159], v[236:239]
    buffer_load_dwordx4 v[32:35], v4, s[8:11], s51 offen offset:2048
    s_waitcnt vmcnt(0)
    v_mfma_f32_16x16x32_bf16 v[224:227], v[32:35], a[160:163], v[224:227]
    v_mfma_f32_16x16x32_bf16 v[228:231], v[32:35], a[164:167], v[228:231]
    v_mfma_f32_16x16x32_bf16 v[232:235], v[32:35], a[168:171], v[232:235]
    v_mfma_f32_16x16x32_bf16 v[236:239], v[32:35], a[172:175], v[236:239]
    buffer_load_dwordx4 v[32:35], v4, s[8:11], s51 offen offset:3072
    s_waitcnt vmcnt(0)
    v_mfma_f32_16x16x32_bf16 v[224:227], v[32:35], a[176:179], v[224:227]
    v_mfma_f32_16x16x32_bf16 v[228:231], v[32:35], a[180:183], v[228:231]
    v_mfma_f32_16x16x32_bf16 v[232:235], v[32:35], a[184:187], v[232:235]
    v_mfma_f32_16x16x32_bf16 v[236:239], v[32:35], v[48:51], v[236:239]
    buffer_load_dwordx4 v[32:35], v5, s[8:11], s51 offen offset:0
    s_waitcnt vmcnt(0)
    v_mfma_f32_16x16x32_bf16 v[224:227], v[32:35], v[52:55], v[224:227]
    v_mfma_f32_16x16x32_bf16 v[228:231], v[32:35], v[56:59], v[228:231]
    v_mfma_f32_16x16x32_bf16 v[232:235], v[32:35], v[60:63], v[232:235]
    v_mfma_f32_16x16x32_bf16 v[236:239], v[32:35], v[64:67], v[236:239]
    buffer_load_dwordx4 v[32:35], v5, s[8:11], s51 offen offset:1024
    s_waitcnt vmcnt(0)
    v_mfma_f32_16x16x32_bf16 v[224:227], v[32:35], v[68:71], v[224:227]
    v_mfma_f32_16x16x32_bf16 v[228:231], v[32:35], v[72:75], v[228:231]
    v_mfma_f32_16x16x32_bf16 v[232:235], v[32:35], v[76:79], v[232:235]
    v_mfma_f32_16x16x32_bf16 v[236:239], v[32:35], v[80:83], v[236:239]
    buffer_load_dwordx4 v[32:35], v5, s[8:11], s51 offen offset:2048
    s_waitcnt vmcnt(0)
    v_mfma_f32_16x16x32_bf16 v[224:227], v[32:35], v[84:87], v[224:227]
    v_mfma_f32_16x16x32_bf16 v[228:231], v[32:35], v[88:91], v[228:231]
    v_mfma_f32_16x16x32_bf16 v[232:235], v[32:35], v[92:95], v[232:235]
    v_mfma_f32_16x16x32_bf16 v[236:239], v[32:35], v[96:99], v[236:239]
    buffer_load_dwordx4 v[32:35], v5, s[8:11], s51 offen offset:3072
    s_waitcnt vmcnt(0)
    v_mfma_f32_16x16x32_bf16 v[224:227], v[32:35], v[100:103], v[224:227]
    v_mfma_f32_16x16x32_bf16 v[228:231], v[32:35], v[104:107], v[228:231]
    v_mfma_f32_16x16x32_bf16 v[232:235], v[32:35], v[108:111], v[232:235]
    v_mfma_f32_16x16x32_bf16 v[236:239], v[32:35], v[112:115], v[236:239]
    buffer_load_dwordx4 v[32:35], v6, s[8:11], s51 offen offset:0
    s_waitcnt vmcnt(0)
    v_mfma_f32_16x16x32_bf16 v[224:227], v[32:35], v[116:119], v[224:227]
    v_mfma_f32_16x16x32_bf16 v[228:231], v[32:35], v[120:123], v[228:231]
    v_mfma_f32_16x16x32_bf16 v[232:235], v[32:35], v[124:127], v[232:235]
    v_mfma_f32_16x16x32_bf16 v[236:239], v[32:35], v[128:131], v[236:239]
    buffer_load_dwordx4 v[32:35], v6, s[8:11], s51 offen offset:1024
    s_waitcnt vmcnt(0)
    v_mfma_f32_16x16x32_bf16 v[224:227], v[32:35], v[132:135], v[224:227]
    v_mfma_f32_16x16x32_bf16 v[228:231], v[32:35], v[136:139], v[228:231]
    v_mfma_f32_16x16x32_bf16 v[232:235], v[32:35], v[140:143], v[232:235]
    v_mfma_f32_16x16x32_bf16 v[236:239], v[32:35], v[144:147], v[236:239]
    s_nop 7
    s_branch L_k4_t1
L_k4_again:
    s_add_u32 s34, s34, 1
    s_cmp_gt_u32 s34, 0x4000
    s_cbranch_scc1 L_k4_clean
    s_barrier
    s_mov_b32 m0, s55
    s_nop 0
    buffer_load_dwordx4 v2, s[8:11], s35 offen offset:0 sc1 lds
    buffer_load_dwordx4 v2, s[8:11], s35 offen offset:1024 sc1 lds
    buffer_load_dwordx4 v2, s[8:11], s35 offen offset:2048 sc1 lds
    buffer_load_dwordx4 v2, s[8:11], s35 offen offset:3072 sc1 lds
    s_add_u32 m0, m0, 4096
    s_nop 0
    buffer_load_dwordx4 v3, s[8:11], s35 offen offset:0 sc1 lds
    buffer_load_dwordx4 v3, s[8:11], s35 offen offset:1024 sc1 lds
    buffer_load_dwordx4 v3, s[8:11], s35 offen offset:2048 sc1 lds
    buffer_load_dwordx4 v3, s[8:11], s35 offen offset:3072 sc1 lds
    s_add_u32 m0, m0, 4096
    s_nop 0
    buffer_load_dwordx4 v4, s[8:11], s35 offen offset:0 sc1 lds
    buffer_load_dwordx4 v4, s[8:11], s35 offen offset:1024 sc1 lds
    buffer_load_dwordx4 v4, s[8:11], s35 offen offset:2048 sc1 lds
    buffer_load_dwordx4 v4, s[8:11], s35 offen offset:3072 sc1 lds
    s_add_u32 m0, m0, 4096
    s_nop 0
    buffer_load_dwordx4 v5, s[8:11], s35 offen offset:0 sc1 lds
    buffer_load_dwordx4 v5, s[8:11], s35 offen offset:1024 sc1 lds
    buffer_load_dwordx4 v5, s[8:11], s35 offen offset:2048 sc1 lds
    buffer_load_dwordx4 v5, s[8:11], s35 offen offset:3072 sc1 lds
    s_add_u32 m0, m0, 4096
    s_nop 0
    buffer_load_dwordx4 v6, s[8:11], s35 offen offset:0 sc1 lds
    buffer_load_dwordx4 v6, s[8:11], s35 offen offset:1024 sc1 lds
    s_waitcnt vmcnt(0)
    s_barrier
    s_branch L_k4_redo1
L_k3_redo:
    s_waitcnt vmcnt(0) lgkmcnt(0)
    v_accvgpr_read_b32 v48, a0
    v_cmpx_ne_u32 vcc, s54, v48
    v_accvgpr_read_b32 v48, a1
    v_cmpx_ne_u32 vcc, s54, v48
    v_accvgpr_read_b32 v48, a2
    v_cmpx_ne_u32 vcc, s54, v48
    v_accvgpr_read_b32 v48, a3
    v_cmpx_ne_u32 vcc, s54, v48
    v_accvgpr_read_b32 v48, a4
    v_cmpx_ne_u32 vcc, s54, v48
    v_accvgpr_read_b32 v48, a5
    v_cmpx_ne_u32 vcc, s54, v48
    v_accvgpr_read_b32 v48, a6
    v_cmpx_ne_u32 vcc, s54, v48
    v_accvgpr_read_b32 v48, a7
    v_cmpx_ne_u32 vcc, s54, v48
    v_accvgpr_read_b32 v48, a8
    v_cmpx_ne_u32 vcc, s54, v48
    v_accvgpr_read_b32 v48, a9
    v_cmpx_ne_u32 vcc, s54, v48
    v_accvgpr_read_b32 v48, a10
    v_cmpx_ne_u32 vcc, s54, v48
    v_accvgpr_read_b32 v48, a11
    v_cmpx_ne_u32 vcc, s54, v48
    v_accvgpr_read_b32 v48, a12
    v_cmpx_ne_u32 vcc, s54, v48
    v_accvgpr_read_b32 v48, a13
    v_cmpx_ne_u32 vcc, s54, v48
    v_accvgpr_read_b32 v48, a14
    v_cmpx_ne_u32 vcc, s54, v48
    v_accvgpr_read_b32 v48, a15
    v_cmpx_ne_u32 vcc, s54, v48
    v_accvgpr_read_b32 v48, a16
    v_cmpx_ne_u32 vcc, s54, v48
    v_accvgpr_read_b32 v48, a17
    v_cmpx_ne_u32 vcc, s54, v48
    v_accvgpr_read_b32 v48, a18
    v_cmpx_ne_u32 vcc, s54, v48
    v_accvgpr_read_b32 v48, a19
    v_cmpx_ne_u32 vcc, s54, v48
    v_accvgpr_read_b32 v48, a20
    v_cmpx_ne_u32 vcc, s54, v48
    v_accvgpr_read_b32 v48, a21
    v_cmpx_ne_u32 vcc, s54, v48
    v_accvgpr_read_b32 v48, a22
    v_cmpx_ne_u32 vcc, s54, v48
    v_accvgpr_read_b32 v48, a23
    v_cmpx_ne_u32 vcc, s54, v48
    v_accvgpr_read_b32 v48, a24
    v_cmpx_ne_u32 vcc, s54, v48
    v_accvgpr_read_b32 v48, a25
    v_cmpx_ne_u32 vcc, s54, v48
    v_accvgpr_read_b32 v48, a26
    v_cmpx_ne_u32 vcc, s54, v48
    v_accvgpr_read_b32 v48, a27
    v_cmpx_ne_u32 vcc, s54, v48
    v_accvgpr_read_b32 v48, a28
    v_cmpx_ne_u32 vcc, s54, v48
    v_accvgpr_read_b32 v48, a29
    v_cmpx_ne_u32 vcc, s54, v48
    v_accvgpr_read_b32 v48, a30
    v_cmpx_ne_u32 vcc, s54, v48
    v_accvgpr_read_b32 v48, a31
    v_cmpx_ne_u32 vcc, s54, v48
    v_accvgpr_read_b32 v48, a32
    v_cmpx_ne_u32 vcc, s54, v48
    v_accvgpr_read_b32 v48, a33
    v_cmpx_ne_u32 vcc, s54, v48
    v_accvgpr_read_b32 v48, a34
    v_cmpx_ne_u32 vcc, s54, v48
    v_accvgpr_read_b32 v48, a35
    v_cmpx_ne_u32 vcc, s54, v48
    v_accvgpr_read_b32 v48, a36
    v_cmpx_ne_u32 vcc, s54, v48
    v_accvgpr_read_b32 v48, a37
    v_cmpx_ne_u32 vcc, s54, v48
    v_accvgpr_read_b32 v48, a38
    v_cmpx_ne_u32 vcc, s54, v48
    v_accvgpr_read_b32 v48, a39
    v_cmpx_ne_u32 vcc, s54, v48
    v_accvgpr_read_b32 v48, a40
    v_cmpx_ne_u32 vcc, s54, v48
    v_accvgpr_read_b32 v48, a41
    v_cmpx_ne_u32 vcc, s54, v48
    v_accvgpr_read_b32 v48, a42
    v_cmpx_ne_u32 vcc, s54, v48
    v_accvgpr_read_b32 v48, a43
    v_cmpx_ne_u32 vcc, s54, v48
    v_accvgpr_read_b32 v48, a44
    v_cmpx_ne_u32 vcc, s54, v48
    v_accvgpr_read_b32 v48, a45
    v_cmpx_ne_u32 vcc, s54, v48
    v_accvgpr_read_b32 v48, a46
    v_cmpx_ne_u32 vcc, s54, v48
    v_accvgpr_read_b32 v48, a47
    v_cmpx_ne_u32 vcc, s54, v48
    v_accvgpr_read_b32 v48, a48
    v_cmpx_ne_u32 vcc, s54, v48
    v_accvgpr_read_b32 v48, a49
    v_cmpx_ne_u32 vcc, s54, v48
    v_accvgpr_read_b32 v48, a50
    v_cmpx_ne_u32 vcc, s54, v48
    v_accvgpr_read_b32 v48, a51
    v_cmpx_ne_u32 vcc, s54, v48
    v_accvgpr_read_b32 v48, a52
    v_cmpx_ne_u32 vcc, s54, v48
    v_accvgpr_read_b32 v48, a53
    v_cmpx_ne_u32 vcc, s54, v48
    v_accvgpr_read_b32 v48, a54
    v_cmpx_ne_u32 vcc, s54, v48
    v_accvgpr_read_b32 v48, a55
    v_cmpx_ne_u32 vcc, s54, v48
    v_accvgpr_read_b32 v48, a56
    v_cmpx_ne_u32 vcc, s54, v48
    v_accvgpr_read_b32 v48, a57
    v_cmpx_ne_u32 vcc, s54, v48
    v_accvgpr_read_b32 v48, a58
    v_cmpx_ne_u32 vcc, s54, v48
    v_accvgpr_read_b32 v48, a59
    v_cmpx_ne_u32 vcc, s54, v48
    v_accvgpr_read_b32 v48, a60
    v_cmpx_ne_u32 vcc, s54, v48
    v_accvgpr_read_b32 v48, a61
    v_cmpx_ne_u32 vcc, s54, v48
    v_accvgpr_read_b32 v48, a62
    v_cmpx_ne_u32 vcc, s54, v48
    v_accvgpr_read_b32 v48, a63
    v_cmpx_ne_u32 vcc, s54, v48
    s_sub_u32 s52, s52, 1
    s_cmp_eq_u64 exec, -1
    s_mov_b64 exec, -1
    s_cbranch_scc1 L_k3_ok
    s_cmp_lt_i32 s52, 0
    s_cbranch_scc1 L_k3_ok
    s_add_u32 s64, s58, 0x02860000
    buffer_load_dwordx4 a[0:3], v2, s[8:11], s64 offen offset:0 sc1
    buffer_load_dwordx4 a[4:7], v2, s[8:11], s64 offen offset:1024 sc1
    buffer_load_dwordx4 a[8:11], v2, s[8:11], s64 offen offset:2048 sc1
    buffer_load_dwordx4 a[12:15], v2, s[8:11], s64 offen offset:3072 sc1
    s_add_u32 s64, s58, 0x02861000
    buffer_load_dwordx4 a[16:19], v2, s[8:11], s64 offen offset:0 sc1
    buffer_load_dwordx4 a[20:23], v2, s[8:11], s64 offen offset:1024 sc1
    buffer_load_dwordx4 a[24:27], v2, s[8:11], s64 offen offset:2048 sc1
    buffer_load_dwordx4 a[28:31], v2, s[8:11], s64 offen offset:3072 sc1
    s_add_u32 s64, s58, 0x02862000
    buffer_load_dwordx4 a[32:35], v2, s[8:11], s64 offen offset:0 sc1
    buffer_load_dwordx4 a[36:39], v2, s[8:11], s64 offen offset:1024 sc1
    buffer_load_dwordx4 a[40:43], v2, s[8:11], s64 offen offset:2048 sc1
    buffer_load_dwordx4 a[44:47], v2, s[8:11], s64 offen offset:3072 sc1
    s_add_u32 s64, s58, 0x02863000
    buffer_load_dwordx4 a[48:51], v2, s[8:11], s64 offen offset:0 sc1
    buffer_load_dwordx4 a[52:55], v2, s[8:11], s64 offen offset:1024 sc1
    buffer_load_dwordx4 a[56:59], v2, s[8:11], s64 offen offset:2048 sc1
    buffer_load_dwordx4 a[60:63], v2, s[8:11], s64 offen offset:3072 sc1
    s_waitcnt vmcnt(0)
    v_dot2_f32_bf16 v224, v88, v107, 0
    v_dot2_f32_bf16 v225, v92, v107, 0
    v_dot2_f32_bf16 v226, v96, v107, 0
    v_dot2_f32_bf16 v227, v100, v107, 0
    v_dot2_f32_bf16 v228, v89, v107, 0
    v_dot2_f32_bf16 v229, v93, v107, 0
    v_dot2_f32_bf16 v230, v97, v107, 0
    v_dot2_f32_bf16 v231, v101, v107, 0
    v_dot2_f32_bf16 v232, v90, v107, 0
    v_dot2_f32_bf16 v233, v94, v107, 0
    v_dot2_f32_bf16 v234, v98, v107, 0
    v_dot2_f32_bf16 v235, v102, v107, 0
    v_dot2_f32_bf16 v236, v91, v107, 0
    v_dot2_f32_bf16 v237, v95, v107, 0
    v_dot2_f32_bf16 v238, v99, v107, 0
    v_dot2_f32_bf16 v239, v103, v107, 0
    v_dot2_f32_bf16 v240, v104, v107, 0
    v_dot2_f32_bf16 v241, v105, v107, 0
    v_mov_b64 v[242:243], 0
    ds_read_b128 v[48:51], v12 offset:33152
    ds_read_b128 v[52:55], v12 offset:34176
    ds_read_b128 v[56:59], v12 offset:35200
    ds_read_b128 v[60:63], v12 offset:36224
    ds_read_b128 v[64:67], v13 offset:37248
    s_waitcnt lgkmcnt(0)
    v_mfma_f32_16x16x32_bf16 v[224:227], v[48:51], v[108:111], v[224:227]
    v_mfma_f32_16x16x32_bf16 v[228:231], v[52:55], v[108:111], v[228:231]
    v_mfma_f32_16x16x32_bf16 v[232:235], v[56:59], v[108:111], v[232:235]
    v_mfma_f32_16x16x32_bf16 v[236:239], v[60:63], v[108:111], v[236:239]
    v_mfma_f32_16x16x32_bf16 v[240:243], v[64:67], v[108:111], v[240:243]
    ds_read_b128 v[68:71], v12 offset:37888
    ds_read_b128 v[72:75], v12 offset:38912
    ds_read_b128 v[76:79], v12 offset:39936
    ds_read_b128 v[80:83], v12 offset:40960
    ds_read_b128 v[84:87], v13 offset:41984
    s_waitcnt lgkmcnt(0)
    v_mfma_f32_16x16x32_bf16 v[224:227], v[68:71], v[112:115], v[224:227]
    v_mfma_f32_16x16x32_bf16 v[228:231], v[72:75], v[112:115], v[228:231]
    v_mfma_f32_16x16x32_bf16 v[232:235], v[76:79], v[112:115], v[232:235]
    v_mfma_f32_16x16x32_bf16 v[236:239], v[80:83], v[112:115], v[236:239]
    v_mfma_f32_16x16x32_bf16 v[240:243], v[84:87], v[112:115], v[240:243]
    ds_read_b128 v[48:51], v2 offset:0
    ds_read_b128 v[52:55], v2 offset:1024
    ds_read_b128 v[56:59], v2 offset:2048
    ds_read_b128 v[60:63], v2 offset:3072
    ds_read_b128 v[64:67], v11 offset:4096
    s_waitcnt lgkmcnt(0)
    v_mfma_f32_16x16x32_bf16 v[224:227], v[48:51], a[0:3], v[224:227]
    v_mfma_f32_16x16x32_bf16 v[228:231], v[52:55], a[0:3], v[228:231]
    v_mfma_f32_16x16x32_bf16 v[232:235], v[56:59], a[0:3], v[232:235]
    v_mfma_f32_16x16x32_bf16 v[236:239], v[60:63], a[0:3], v[236:239]
    v_mfma_f32_16x16x32_bf16 v[240:243], v[64:67], a[0:3], v[240:243]
    ds_read_b128 v[68:71], v2 offset:4736
    ds_read_b128 v[72:75], v2 offset:5760
    ds_read_b128 v[76:79], v2 offset:6784
    ds_read_b128 v[80:83], v2 offset:7808
    ds_read_b128 v[84:87], v11 offset:8832
    s_waitcnt lgkmcnt(0)
    v_mfma_f32_16x16x32_bf16 v[224:227], v[68:71], a[4:7], v[224:227]
    v_mfma_f32_16x16x32_bf16 v[228:231], v[72:75], a[4:7], v[228:231]
    v_mfma_f32_16x16x32_bf16 v[232:235], v[76:79], a[4:7], v[232:235]
    v_mfma_f32_16x16x32_bf16 v[236:239], v[80:83], a[4:7], v[236:239]
    v_mfma_f32_16x16x32_bf16 v[240:243], v[84:87], a[4:7], v[240:243]
    ds_read_b128 v[48:51], v2 offset:9472
    ds_read_b128 v[52:55], v2 offset:10496
    ds_read_b128 v[56:59], v2 offset:11520
    ds_read_b128 v[60:63], v2 offset:12544
    ds_read_b128 v[64:67], v11 offset:13568
    s_waitcnt lgkmcnt(0)
    v_mfma_f32_16x16x32_bf16 v[224:227], v[48:51], a[8:11], v[224:227]
    v_mfma_f32_16x16x32_bf16 v[228:231], v[52:55], a[8:11], v[228:231]
    v_mfma_f32_16x16x32_bf16 v[232:235], v[56:59], a[8:11], v[232:235]
    v_mfma_f32_16x16x32_bf16 v[236:239], v[60:63], a[8:11], v[236:239]
    v_mfma_f32_16x16x32_bf16 v[240:243], v[64:67], a[8:11], v[240:243]
    ds_read_b128 v[68:71], v2 offset:14208
    ds_read_b128 v[72:75], v2 offset:15232
    ds_read_b128 v[76:79], v2 offset:16256
    ds_read_b128 v[80:83], v2 offset:17280
    ds_read_b128 v[84:87], v11 offset:18304
    s_waitcnt lgkmcnt(0)
    v_mfma_f32_16x16x32_bf16 v[224:227], v[68:71], a[12:15], v[224:227]
    v_mfma_f32_16x16x32_bf16 v[228:231], v[72:75], a[12:15], v[228:231]
    v_mfma_f32_16x16x32_bf16 v[232:235], v[76:79], a[12:15], v[232:235]
    v_mfma_f32_16x16x32_bf16 v[236:239], v[80:83], a[12:15], v[236:239]
    v_mfma_f32_16x16x32_bf16 v[240:243], v[84:87], a[12:15], v[240:243]
    ds_read_b128 v[48:51], v2 offset:18944
    ds_read_b128 v[52:55], v2 offset:19968
    ds_read_b128 v[56:59], v2 offset:20992
    ds_read_b128 v[60:63], v2 offset:22016
    ds_read_b128 v[64:67], v11 offset:23040
    s_waitcnt lgkmcnt(0)
    v_mfma_f32_16x16x32_bf16 v[224:227], v[48:51], a[16:19], v[224:227]
    v_mfma_f32_16x16x32_bf16 v[228:231], v[52:55], a[16:19], v[228:231]
    v_mfma_f32_16x16x32_bf16 v[232:235], v[56:59], a[16:19], v[232:235]
    v_mfma_f32_16x16x32_bf16 v[236:239], v[60:63], a[16:19], v[236:239]
    v_mfma_f32_16x16x32_bf16 v[240:243], v[64:67], a[16:19], v[240:243]
    ds_read_b128 v[68:71], v2 offset:23680
    ds_read_b128 v[72:75], v2 offset:24704
    ds_read_b128 v[76:79], v2 offset:25728
    ds_read_b128 v[80:83], v2 offset:26752
    ds_read_b128 v[84:87], v11 offset:27776
    s_waitcnt lgkmcnt(0)
    v_mfma_f32_16x16x32_bf16 v[224:227], v[68:71], a[20:23], v[224:227]
    v_mfma_f32_16x16x32_bf16 v[228:231], v[72:75], a[20:23], v[228:231]
    v_mfma_f32_16x16x32_bf16 v[232:235], v[76:79], a[20:23], v[232:235]
    v_mfma_f32_16x16x32_bf16 v[236:239], v[80:83], a[20:23], v[236:239]
    v_mfma_f32_16x16x32_bf16 v[240:243], v[84:87], a[20:23], v[240:243]
    ds_read_b128 v[48:51], v2 offset:28416
    ds_read_b128 v[52:55], v2 offset:29440
    ds_read_b128 v[56:59], v2 offset:30464
    ds_read_b128 v[60:63], v2 offset:31488
    ds_read_b128 v[64:67], v11 offset:32512
    s_waitcnt lgkmcnt(0)
    v_mfma_f32_16x16x32_bf16 v[224:227], v[48:51], a[24:27], v[224:227]
    v_mfma_f32_16x16x32_bf16 v[228:231], v[52:55], a[24:27], v[228:231]
    v_mfma_f32_16x16x32_bf16 v[232:235], v[56:59], a[24:27], v[232:235]
    v_mfma_f32_16x16x32_bf16 v[236:239], v[60:63], a[24:27], v[236:239]
    v_mfma_f32_16x16x32_bf16 v[240:243], v[64:67], a[24:27], v[240:243]
    ds_read_b128 v[68:71], v2 offset:33152
    ds_read_b128 v[72:75], v2 offset:34176
    ds_read_b128 v[76:79], v2 offset:35200
    ds_read_b128 v[80:83], v2 offset:36224
    ds_read_b128 v[84:87], v11 offset:37248
    s_waitcnt lgkmcnt(0)
    v_mfma_f32_16x16x32_bf16 v[224:227], v[68:71], a[28:31], v[224:227]
    v_mfma_f32_16x16x32_bf16 v[228:231], v[72:75], a[28:31], v[228:231]
    v_mfma_f32_16x16x32_bf16 v[232:235], v[76:79], a[28:31], v[232:235]
    v_mfma_f32_16x16x32_bf16 v[236:239], v[80:83], a[28:31], v[236:239]
    v_mfma_f32_16x16x32_bf16 v[240:243], v[84:87], a[28:31], v[240:243]
    ds_read_b128 v[48:51], v2 offset:37888
    ds_read_b128 v[52:55], v2 offset:38912
    ds_read_b128 v[56:59], v2 offset:39936
    ds_read_b128 v[60:63], v2 offset:40960
    ds_read_b128 v[64:67], v11 offset:41984
    s_waitcnt lgkmcnt(0)
    v_mfma_f32_16x16x32_bf16 v[224:227], v[48:51], a[32:35], v[224:227]
    v_mfma_f32_16x16x32_bf16 v[228:231], v[52:55], a[32:35], v[228:231]
    v_mfma_f32_16x16x32_bf16 v[232:235], v[56:59], a[32:35], v[232:235]
    v_mfma_f32_16x16x32_bf16 v[236:239], v[60:63], a[32:35], v[236:239]
    v_mfma_f32_16x16x32_bf16 v[240:243], v[64:67], a[32:35], v[240:243]
    ds_read_b128 v[68:71], v12 offset:0
    ds_read_b128 v[72:75], v12 offset:1024
    ds_read_b128 v[76:79], v12 offset:2048
    ds_read_b128 v[80:83], v12 offset:3072
    ds_read_b128 v[84:87], v13 offset:4096
    s_waitcnt lgkmcnt(0)
    v_mfma_f32_16x16x32_bf16 v[224:227], v[68:71], a[36:39], v[224:227]
    v_mfma_f32_16x16x32_bf16 v[228:231], v[72:75], a[36:39], v[228:231]
    v_mfma_f32_16x16x32_bf16 v[232:235], v[76:79], a[36:39], v[232:235]
    v_mfma_f32_16x16x32_bf16 v[236:239], v[80:83], a[36:39], v[236:239]
    v_mfma_f32_16x16x32_bf16 v[240:243], v[84:87], a[36:39], v[240:243]
    ds_read_b128 v[48:51], v12 offset:4736
    ds_read_b128 v[52:55], v12 offset:5760
    ds_read_b128 v[56:59], v12 offset:6784
    ds_read_b128 v[60:63], v12 offset:7808
    ds_read_b128 v[64:67], v13 offset:8832
    s_waitcnt lgkmcnt(0)
    v_mfma_f32_16x16x32_bf16 v[224:227], v[48:51], a[40:43], v[224:227]
    v_mfma_f32_16x16x32_bf16 v[228:231], v[52:55], a[40:43], v[228:231]
    v_mfma_f32_16x16x32_bf16 v[232:235], v[56:59], a[40:43], v[232:235]
    v_mfma_f32_16x16x32_bf16 v[236:239], v[60:63], a[40:43], v[236:239]
    v_mfma_f32_16x16x32_bf16 v[240:243], v[64:67], a[40:43], v[240:243]
    ds_read_b128 v[68:71], v12 offset:9472
    ds_read_b128 v[72:75], v12 offset:10496
    ds_read_b128 v[76:79], v12 offset:11520
    ds_read_b128 v[80:83], v12 offset:12544
    ds_read_b128 v[84:87], v13 offset:13568
    s_waitcnt lgkmcnt(0)
    v_mfma_f32_16x16x32_bf16 v[224:227], v[68:71], a[44:47], v[224:227]
    v_mfma_f32_16x16x32_bf16 v[228:231], v[72:75], a[44:47], v[228:231]
    v_mfma_f32_16x16x32_bf16 v[232:235], v[76:79], a[44:47], v[232:235]
    v_mfma_f32_16x16x32_bf16 v[236:239], v[80:83], a[44:47], v[236:239]
    v_mfma_f32_16x16x32_bf16 v[240:243], v[84:87], a[44:47], v[240:243]
    ds_read_b128 v[48:51], v12 offset:14208
    ds_read_b128 v[52:55], v12 offset:15232
    ds_read_b128 v[56:59], v12 offset:16256
    ds_read_b128 v[60:63], v12 offset:17280
    ds_read_b128 v[64:67], v13 offset:18304
    s_waitcnt lgkmcnt(0)
    v_mfma_f32_16x16x32_bf16 v[224:227], v[48:51], a[48:51], v[224:227]
    v_mfma_f32_16x16x32_bf16 v[228:231], v[52:55], a[48:51], v[228:231]
    v_mfma_f32_16x16x32_bf16 v[232:235], v[56:59], a[48:51], v[232:235]
    v_mfma_f32_16x16x32_bf16 v[236:239], v[60:63], a[48:51], v[236:239]
    v_mfma_f32_16x16x32_bf16 v[240:243], v[64:67], a[48:51], v[240:243]
    ds_read_b128 v[68:71], v12 offset:18944
    ds_read_b128 v[72:75], v12 offset:19968
    ds_read_b128 v[76:79], v12 offset:20992
    ds_read_b128 v[80:83], v12 offset:22016
    ds_read_b128 v[84:87], v13 offset:23040
    s_waitcnt lgkmcnt(0)
    v_mfma_f32_16x16x32_bf16 v[224:227], v[68:71], a[52:55], v[224:227]
    v_mfma_f32_16x16x32_bf16 v[228:231], v[72:75], a[52:55], v[228:231]
    v_mfma_f32_16x16x32_bf16 v[232:235], v[76:79], a[52:55], v[232:235]
    v_mfma_f32_16x16x32_bf16 v[236:239], v[80:83], a[52:55], v[236:239]
    v_mfma_f32_16x16x32_bf16 v[240:243], v[84:87], a[52:55], v[240:243]
    ds_read_b128 v[48:51], v12 offset:23680
    ds_read_b128 v[52:55], v12 offset:24704
    ds_read_b128 v[56:59], v12 offset:25728
    ds_read_b128 v[60:63], v12 offset:26752
    ds_read_b128 v[64:67], v13 offset:27776
    s_waitcnt lgkmcnt(0)
    v_mfma_f32_16x16x32_bf16 v[224:227], v[48:51], a[56:59], v[224:227]
    v_mfma_f32_16x16x32_bf16 v[228:231], v[52:55], a[56:59], v[228:231]
    v_mfma_f32_16x16x32_bf16 v[232:235], v[56:59], a[56:59], v[232:235]
    v_mfma_f32_16x16x32_bf16 v[236:239], v[60:63], a[56:59], v[236:239]
    v_mfma_f32_16x16x32_bf16 v[240:243], v[64:67], a[56:59], v[240:243]
    ds_read_b128 v[68:71], v12 offset:28416
    ds_read_b128 v[72:75], v12 offset:29440
    ds_read_b128 v[76:79], v12 offset:30464
    ds_read_b128 v[80:83], v12 offset:31488
    ds_read_b128 v[84:87], v13 offset:32512
    s_waitcnt lgkmcnt(0)
    v_mfma_f32_16x16x32_bf16 v[224:227], v[68:71], a[60:63], v[224:227]
    v_mfma_f32_16x16x32_bf16 v[228:231], v[72:75], a[60:63], v[228:231]
    v_mfma_f32_16x16x32_bf16 v[232:235], v[76:79], a[60:63], v[232:235]
    v_mfma_f32_16x16x32_bf16 v[236:239], v[80:83], a[60:63], v[236:239]
    v_mfma_f32_16x16x32_bf16 v[240:243], v[84:87], a[60:63], v[240:243]
    s_nop 7
    s_branch L_k3_ck
L_k2_far:
    v_cvt_pk_bf16_f32 v244, v82, v83
    v_cvt_pk_bf16_f32 v245, v84, v85
    v_cvt_pk_bf16_f32 v246, v86, v87
    v_cvt_pk_bf16_f32 v247, v88, v89
    v_cvt_pk_bf16_f32 v252, v90, v91
    buffer_store_dwordx4 v[244:247], v254, s[8:11], s26 offen offset:0 sc1
    v_cvt_pk_bf16_f32 v248, v98, v99
    v_cvt_pk_bf16_f32 v249, v100, v101
    v_cvt_pk_bf16_f32 v250, v102, v103
    v_cvt_pk_bf16_f32 v251, v104, v105
    v_cvt_pk_bf16_f32 v253, v106, v107
    buffer_store_dwordx4 v[248:251], v254, s[8:11], s26 offen offset:1024 sc1
    s_mov_b32 exec_hi, 0
    buffer_store_dword v252, v255, s[8:11], s27 offen offset:0 sc1
    buffer_store_dword v253, v255, s[8:11], s27 offen offset:8 sc1
    s_mov_b32 exec_hi, -1
    s_branch L_k2_end
L_p1_sl:
    v_mfma_f32_16x16x32_bf16 v[104:107], v[166:169], v[32:35], v[152:155]
    v_mfma_f32_16x16x32_bf16 v[108:111], v[164:167], v[32:35], v[152:155]
    s_nop 6
    v_cvt_pk_bf16_f32 v112, v104, v105
    v_cvt_pk_bf16_f32 v113, v106, v107
    v_cvt_pk_bf16_f32 v114, v108, v109
    v_cvt_pk_bf16_f32 v115, v110, v111
    s_nop 1
    v_mfma_f32_16x16x32_bf16 v[156:159], v[112:115], v[112:115], 0
    v_mfma_f32_16x16x32_bf16 v[172:175], a[16:19], v[112:115], 0
    v_mfma_f32_16x16x32_bf16 v[104:107], v[166:169], v[36:39], v[152:155]
    v_mfma_f32_16x16x32_bf16 v[108:111], v[164:167], v[36:39], v[152:155]
    s_nop 6
    v_cvt_pk_bf16_f32 v112, v104, v105
    v_cvt_pk_bf16_f32 v113, v106, v107
    v_cvt_pk_bf16_f32 v114, v108, v109
    v_cvt_pk_bf16_f32 v115, v110, v111
    s_nop 1
    v_mfma_f32_16x16x32_bf16 v[156:159], v[112:115], v[112:115], v[156:159]
    v_mfma_f32_16x16x32_bf16 v[172:175], a[20:23], v[112:115], v[172:175]
    v_mfma_f32_16x16x32_bf16 v[104:107], v[166:169], v[40:43], v[152:155]
    v_mfma_f32_16x16x32_bf16 v[108:111], v[164:167], v[40:43], v[152:155]
    s_nop 6
    v_cvt_pk_bf16_f32 v112, v104, v105
    v_cvt_pk_bf16_f32 v113, v106, v107
    v_cvt_pk_bf16_f32 v114, v108, v109
    v_cvt_pk_bf16_f32 v115, v110, v111
    s_nop 1
    v_mfma_f32_16x16x32_bf16 v[156:159], v[112:115], v[112:115], v[156:159]
    v_mfma_f32_16x16x32_bf16 v[172:175], a[24:27], v[112:115], v[172:175]
    v_mfma_f32_16x16x32_bf16 v[104:107], v[166:169], v[44:47], v[152:155]
    v_mfma_f32_16x16x32_bf16 v[108:111], v[164:167], v[44:47], v[152:155]
    s_nop 6
    v_cvt_pk_bf16_f32 v112, v104, v105
    v_cvt_pk_bf16_f32 v113, v106, v107
    v_cvt_pk_bf16_f32 v114, v108, v109
    v_cvt_pk_bf16_f32 v115, v110, v111
    s_nop 1
    v_mfma_f32_16x16x32_bf16 v[156:159], v[112:115], v[112:115], v[156:159]
    v_mfma_f32_16x16x32_bf16 v[172:175], a[28:31], v[112:115], v[172:175]
    v_mfma_f32_16x16x32_bf16 v[104:107], v[166:169], v[48:51], v[152:155]
    v_mfma_f32_16x16x32_bf16 v[108:111], v[164:167], v[48:51], v[152:155]
    s_nop 6
    v_cvt_pk_bf16_f32 v112, v104, v105
    v_cvt_pk_bf16_f32 v113, v106, v107
    v_cvt_pk_bf16_f32 v114, v108, v109
    v_cvt_pk_bf16_f32 v115, v110, v111
    s_nop 1
    v_mfma_f32_16x16x32_bf16 v[156:159], v[112:115], v[112:115], v[156:159]
    v_mfma_f32_16x16x32_bf16 v[172:175], a[32:35], v[112:115], v[172:175]
    v_mfma_f32_16x16x32_bf16 v[104:107], v[166:169], v[52:55], v[152:155]
    v_mfma_f32_16x16x32_bf16 v[108:111], v[164:167], v[52:55], v[152:155]
    s_nop 6
    v_cvt_pk_bf16_f32 v112, v104, v105
    v_cvt_pk_bf16_f32 v113, v106, v107
    v_cvt_pk_bf16_f32 v114, v108, v109
    v_cvt_pk_bf16_f32 v115, v110, v111
    s_nop 1
    v_mfma_f32_16x16x32_bf16 v[156:159], v[112:115], v[112:115], v[156:159]
    v_mfma_f32_16x16x32_bf16 v[172:175], a[36:39], v[112:115], v[172:175]
    v_mfma_f32_16x16x32_bf16 v[104:107], v[166:169], v[56:59], v[152:155]
    v_mfma_f32_16x16x32_bf16 v[108:111], v[164:167], v[56:59], v[152:155]
    s_nop 6
    v_cvt_pk_bf16_f32 v112, v104, v105
    v_cvt_pk_bf16_f32 v113, v106, v107
    v_cvt_pk_bf16_f32 v114, v108, v109
    v_cvt_pk_bf16_f32 v115, v110, v111
    s_nop 1
    v_mfma_f32_16x16x32_bf16 v[156:159], v[112:115], v[112:115], v[156:159]
    v_mfma_f32_16x16x32_bf16 v[172:175], a[40:43], v[112:115], v[172:175]
    v_mfma_f32_16x16x32_bf16 v[104:107], v[166:169], v[60:63], v[152:155]
    v_mfma_f32_16x16x32_bf16 v[108:111], v[164:167], v[60:63], v[152:155]
    s_nop 6
    v_cvt_pk_bf16_f32 v112, v104, v105
    v_cvt_pk_bf16_f32 v113, v106, v107
    v_cvt_pk_bf16_f32 v114, v108, v109
    v_cvt_pk_bf16_f32 v115, v110, v111
    s_nop 1
    v_mfma_f32_16x16x32_bf16 v[156:159], v[112:115], v[112:115], v[156:159]
    v_mfma_f32_16x16x32_bf16 v[172:175], a[44:47], v[112:115], v[172:175]
    v_mfma_f32_16x16x32_bf16 v[104:107], v[166:169], v[64:67], v[152:155]
    v_mfma_f32_16x16x32_bf16 v[108:111], v[164:167], v[64:67], v[152:155]
    s_nop 6
    v_cvt_pk_bf16_f32 v112, v104, v105
    v_cvt_pk_bf16_f32 v113, v106, v107
    v_cvt_pk_bf16_f32 v114, v108, v109
    v_cvt_pk_bf16_f32 v115, v110, v111
    s_nop 1
    v_mfma_f32_16x16x32_bf16 v[156:159], v[112:115], v[112:115], v[156:159]
    v_mfma_f32_16x16x32_bf16 v[172:175], a[48:51], v[112:115], v[172:175]
    v_mfma_f32_16x16x32_bf16 v[104:107], v[166:169], v[68:71], v[152:155]
    v_mfma_f32_16x16x32_bf16 v[108:111], v[164:167], v[68:71], v[152:155]
    s_nop 6
    v_cvt_pk_bf16_f32 v112, v104, v105
    v_cvt_pk_bf16_f32 v113, v106, v107
    v_cvt_pk_bf16_f32 v114, v108, v109
    v_cvt_pk_bf16_f32 v115, v110, v111
    s_nop 1
    v_mfma_f32_16x16x32_bf16 v[156:159], v[112:115], v[112:115], v[156:159]
    v_mfma_f32_16x16x32_bf16 v[172:175], a[52:55], v[112:115], v[172:175]
    v_mfma_f32_16x16x32_bf16 v[104:107], v[166:169], v[72:75], v[152:155]
    v_mfma_f32_16x16x32_bf16 v[108:111], v[164:167], v[72:75], v[152:155]
    s_nop 6
    v_cvt_pk_bf16_f32 v112, v104, v105
    v_cvt_pk_bf16_f32 v113, v106, v107
    v_cvt_pk_bf16_f32 v114, v108, v109
    v_cvt_pk_bf16_f32 v115, v110, v111
    s_nop 1
    v_mfma_f32_16x16x32_bf16 v[156:159], v[112:115], v[112:115], v[156:159]
    v_mfma_f32_16x16x32_bf16 v[172:175], a[56:59], v[112:115], v[172:175]
    v_mfma_f32_16x16x32_bf16 v[104:107], v[166:169], v[76:79], v[152:155]
    v_mfma_f32_16x16x32_bf16 v[108:111], v[164:167], v[76:79], v[152:155]
    s_nop 6
    v_cvt_pk_bf16_f32 v112, v104, v105
    v_cvt_pk_bf16_f32 v113, v106, v107
    v_cvt_pk_bf16_f32 v114, v108, v109
    v_cvt_pk_bf16_f32 v115, v110, v111
    s_nop 1
    v_mfma_f32_16x16x32_bf16 v[156:159], v[112:115], v[112:115], v[156:159]
    v_mfma_f32_16x16x32_bf16 v[172:175], a[60:63], v[112:115], v[172:175]
    v_mfma_f32_16x16x32_bf16 v[104:107], v[166:169], v[80:83], v[152:155]
    v_mfma_f32_16x16x32_bf16 v[108:111], v[164:167], v[80:83], v[152:155]
    s_nop 6
    v_cvt_pk_bf16_f32 v112, v104, v105
    v_cvt_pk_bf16_f32 v113, v106, v107
    v_cvt_pk_bf16_f32 v114, v108, v109
    v_cvt_pk_bf16_f32 v115, v110, v111
    s_nop 1
    v_mfma_f32_16x16x32_bf16 v[156:159], v[112:115], v[112:115], v[156:159]
    v_mfma_f32_16x16x32_bf16 v[172:175], a[64:67], v[112:115], v[172:175]
    v_mfma_f32_16x16x32_bf16 v[104:107], v[166:169], v[84:87], v[152:155]
    v_mfma_f32_16x16x32_bf16 v[108:111], v[164:167], v[84:87], v[152:155]
    s_nop 6
    v_cvt_pk_bf16_f32 v112, v104, v105
    v_cvt_pk_bf16_f32 v113, v106, v107
    v_cvt_pk_bf16_f32 v114, v108, v109
    v_cvt_pk_bf16_f32 v115, v110, v111
    s_nop 1
    v_mfma_f32_16x16x32_bf16 v[156:159], v[112:115], v[112:115], v[156:159]
    v_mfma_f32_16x16x32_bf16 v[172:175], a[68:71], v[112:115], v[172:175]
    v_mfma_f32_16x16x32_bf16 v[104:107], v[166:169], v[88:91], v[152:155]
    v_mfma_f32_16x16x32_bf16 v[108:111], v[164:167], v[88:91], v[152:155]
    s_nop 6
    v_cvt_pk_bf16_f32 v112, v104, v105
    v_cvt_pk_bf16_f32 v113, v106, v107
    v_cvt_pk_bf16_f32 v114, v108, v109
    v_cvt_pk_bf16_f32 v115, v110, v111
    s_nop 1
    v_mfma_f32_16x16x32_bf16 v[156:159], v[112:115], v[112:115], v[156:159]
    v_mfma_f32_16x16x32_bf16 v[172:175], a[72:75], v[112:115], v[172:175]
    v_mfma_f32_16x16x32_bf16 v[104:107], v[166:169], v[92:95], v[152:155]
    v_mfma_f32_16x16x32_bf16 v[108:111], v[164:167], v[92:95], v[152:155]
    s_nop 6
    v_cvt_pk_bf16_f32 v112, v104, v105
    v_cvt_pk_bf16_f32 v113, v106, v107
    v_cvt_pk_bf16_f32 v114, v108, v109
    v_cvt_pk_bf16_f32 v115, v110, v111
    s_nop 1
    v_mfma_f32_16x16x32_bf16 v[156:159], v[112:115], v[112:115], v[156:159]
    v_mfma_f32_16x16x32_bf16 v[172:175], a[76:79], v[112:115], v[172:175]
    v_mfma_f32_16x16x32_bf16 v[104:107], v[166:169], v[96:99], v[152:155]
    v_mfma_f32_16x16x32_bf16 v[108:111], v[164:167], v[96:99], v[152:155]
    s_nop 6
    v_cvt_pk_bf16_f32 v112, v104, v105
    v_cvt_pk_bf16_f32 v113, v106, v107
    v_cvt_pk_bf16_f32 v114, v108, v109
    v_cvt_pk_bf16_f32 v115, v110, v111
    s_nop 1
    v_mfma_f32_16x16x32_bf16 v[156:159], v[112:115], v[112:115], v[156:159]
    v_mfma_f32_16x16x32_bf16 v[172:175], a[80:83], v[112:115], v[172:175]
    v_mfma_f32_16x16x32_bf16 v[104:107], v[166:169], v[100:103], v[152:155]
    v_mfma_f32_16x16x32_bf16 v[108:111], v[164:167], v[100:103], v[152:155]
    s_nop 6
    v_cvt_pk_bf16_f32 v112, v104, v105
    v_cvt_pk_bf16_f32 v113, v106, v107
    v_cvt_pk_bf16_f32 v114, v108, v109
    v_cvt_pk_bf16_f32 v115, v110, v111
    s_nop 1
    v_mfma_f32_16x16x32_bf16 v[156:159], v[112:115], v[112:115], v[156:159]
    v_mfma_f32_16x16x32_bf16 v[172:175], a[84:87], v[112:115], v[172:175]
    s_nop 6
    v_cndmask_b32 v156, v156, v157, s[66:67]
    v_cndmask_b32 v158, v158, v159, s[66:67]
    v_cndmask_b32 v156, v156, v158, s[68:69]
    ds_bpermute_b32 v156, v213, v156
    s_waitcnt lgkmcnt(0)
    v_fmac_f32 v214, 0x3ae38e39, v156
    v_rsq_f32 v156, v214
    s_branch L_p1_st
.p2align 12
L_k2_wbar:
    s_cmp_eq_u32 s50, 0
    s_cbranch_scc1 L_k2_sn
    v_mov_b32 v216, 0x3f803f80
    v_mov_b32 v217, 0x3f803f80
    v_mov_b32 v218, 0x3f803f80
    v_mov_b32 v219, 0x3f803f80
    s_nop 1
    v_mfma_f32_16x16x32_bf16 v[220:223], v[216:219], v[148:151], 0
    v_mfma_f32_16x16x32_bf16 v[220:223], v[216:219], v[152:155], v[220:223]
L_tp32:
    s_cbranch_execz L_tret
    v_mfma_f32_16x16x32_bf16 v[220:223], v[216:219], v[156:159], v[220:223]
    v_mfma_f32_16x16x32_bf16 v[220:223], v[216:219], v[160:163], v[220:223]
    v_mfma_f32_16x16x32_bf16 v[220:223], v[216:219], v[164:167], v[220:223]
    v_mfma_f32_16x16x32_bf16 v[220:223], v[216:219], v[168:171], v[220:223]
    v_mfma_f32_16x16x32_bf16 v[220:223], v[216:219], v[172:175], v[220:223]
    v_mfma_f32_16x16x32_bf16 v[220:223], v[216:219], v[176:179], v[220:223]
    v_mfma_f32_16x16x32_bf16 v[220:223], v[216:219], v[180:183], v[220:223]
    s_nop 7
    v_add_f32_dpp v216, v220, v220 row_ror:8 row_mask:0xf bank_mask:0xf
    v_mul_f32 v216, 0x3ae38e39, v216
    v_cvt_pk_bf16_f32 v217, v216, v216
    v_and_b32 v218, 0xffff0000, v217
    v_sub_f32 v218, v216, v218
    v_cvt_pk_bf16_f32 v217, v216, v218
    buffer_store_short v217, v250, s[8:11], s48 offen sc1
    buffer_store_short_d16_hi v217, v250, s[8:11], s48 offen offset:64 sc1
    s_branch L_k2_sn
L_tp33:
    s_branch L_tret
.p2align 6
L_k2_P:
    v_exp_f32 v16, v16
    v_exp_f32 v32, v32
    v_cvt_pk_bf16_f32 v71, v96, v97
    v_mfma_f32_32x32x16_bf16 v[82:97], a[0:3], v[72:75], 0
    v_cvt_pk_bf16_f32 v137, v112, v113
    v_exp_f32 v17, v17
    v_exp_f32 v33, v33
    v_exp_f32 v18, v18
    v_exp_f32 v34, v34
    v_cvt_pk_bf16_f32 v64, v16, v17
    v_mfma_f32_32x32x16_bf16 v[98:113], a[0:3], v[138:141], 0
    s_waitcnt lgkmcnt(1)
    ds_read_b128 a[0:3], v4 offset:2048
    v_cvt_pk_bf16_f32 v130, v32, v33
    v_exp_f32 v19, v19
    v_exp_f32 v35, v35
    v_exp_f32 v20, v20
    v_exp_f32 v36, v36
    v_cvt_pk_bf16_f32 v65, v18, v19
    v_mfma_f32_32x32x16_bf16 v[48:63], a[12:15], v[68:71], v[48:63]
    v_cvt_pk_bf16_f32 v131, v34, v35
    v_exp_f32 v21, v21
    v_exp_f32 v37, v37
    v_exp_f32 v22, v22
    v_exp_f32 v38, v38
    v_cvt_pk_bf16_f32 v66, v20, v21
    v_mfma_f32_32x32x16_bf16 v[114:129], a[12:15], v[134:137], v[114:129]
    s_waitcnt lgkmcnt(1)
    ds_read_b128 a[12:15], v12 offset:5216
    v_cvt_pk_bf16_f32 v132, v36, v37
    v_exp_f32 v23, v23
    v_exp_f32 v39, v39
    v_exp_f32 v24, v24
    v_exp_f32 v40, v40
    v_cvt_pk_bf16_f32 v67, v22, v23
    v_mfma_f32_32x32x4_2b_bf16 v[82:113], a[4:5], v[76:77], v[82:113] cbsz:1 abid:1
    v_cvt_pk_bf16_f32 v133, v38, v39
    v_exp_f32 v25, v25
    v_exp_f32 v41, v41
    v_exp_f32 v26, v26
    v_exp_f32 v42, v42
    v_cvt_pk_bf16_f32 v68, v24, v25
    v_cvt_pk_bf16_f32 v134, v40, v41
    v_exp_f32 v27, v27
    v_exp_f32 v43, v43
    v_exp_f32 v28, v28
    v_mfma_f32_32x32x16_bf16 v[48:63], a[8:11], v[64:67], v[48:63]
    v_exp_f32 v44, v44
    v_cvt_pk_bf16_f32 v69, v26, v27
    v_cvt_pk_bf16_f32 v135, v42, v43
    v_exp_f32 v29, v29
    v_exp_f32 v45, v45
    v_exp_f32 v30, v30
    v_exp_f32 v46, v46
    v_mfma_f32_32x32x16_bf16 v[114:129], a[8:11], v[130:133], v[114:129]
    s_waitcnt lgkmcnt(1)
    ds_read_b128 a[8:11], v12 offset:5824
    v_cvt_pk_bf16_f32 v70, v28, v29
    v_cvt_pk_bf16_f32 v136, v44, v45
    v_exp_f32 v31, v31
    v_exp_f32 v47, v47
    v_exp_f32 v82, v82
    v_exp_f32 v98, v98
    v_cvt_pk_bf16_f32 v71, v30, v31
    v_mfma_f32_32x32x16_bf16 v[16:31], a[0:3], v[72:75], 0
    v_cvt_pk_bf16_f32 v137, v46, v47
    v_exp_f32 v83, v83
    v_exp_f32 v99, v99
    v_exp_f32 v84, v84
    v_exp_f32 v100, v100
    v_cvt_pk_bf16_f32 v64, v82, v83
    v_mfma_f32_32x32x16_bf16 v[32:47], a[0:3], v[138:141], 0
    s_waitcnt lgkmcnt(1)
    ds_read_b128 a[0:3], v4 offset:3072
    v_cvt_pk_bf16_f32 v130, v98, v99
    v_exp_f32 v85, v85
    v_exp_f32 v101, v101
    v_exp_f32 v86, v86
    v_exp_f32 v102, v102
    v_cvt_pk_bf16_f32 v65, v84, v85
    v_mfma_f32_32x32x16_bf16 v[48:63], a[12:15], v[68:71], v[48:63]
    v_cvt_pk_bf16_f32 v131, v100, v101
    v_exp_f32 v87, v87
    v_exp_f32 v103, v103
    v_exp_f32 v88, v88
    v_exp_f32 v104, v104
    v_cvt_pk_bf16_f32 v66, v86, v87
    v_mfma_f32_32x32x16_bf16 v[114:129], a[12:15], v[134:137], v[114:129]
    s_waitcnt lgkmcnt(1)
    ds_read_b128 a[12:15], v12 offset:6432
    v_cvt_pk_bf16_f32 v132, v102, v103
    v_exp_f32 v89, v89
    v_exp_f32 v105, v105
    v_exp_f32 v90, v90
    v_exp_f32 v106, v106
    v_cvt_pk_bf16_f32 v67, v88, v89
    v_mfma_f32_32x32x4_2b_bf16 v[16:47], a[6:7], v[76:77], v[16:47] cbsz:1 abid:0
    v_cvt_pk_bf16_f32 v133, v104, v105
    v_exp_f32 v91, v91
    v_exp_f32 v107, v107
    v_exp_f32 v92, v92
    v_exp_f32 v108, v108
    v_cvt_pk_bf16_f32 v68, v90, v91
    v_cvt_pk_bf16_f32 v134, v106, v107
    v_exp_f32 v93, v93
    v_exp_f32 v109, v109
    v_exp_f32 v94, v94
    v_mfma_f32_32x32x16_bf16 v[48:63], a[8:11], v[64:67], v[48:63]
    ds_read_b32 a4, v3 offset:9472
    v_exp_f32 v110, v110
    v_cvt_pk_bf16_f32 v69, v92, v93
    v_cvt_pk_bf16_f32 v135, v108, v109
    v_exp_f32 v95, v95
    v_exp_f32 v111, v111
    v_exp_f32 v96, v96
    v_exp_f32 v112, v112
    v_mfma_f32_32x32x16_bf16 v[114:129], a[8:11], v[130:133], v[114:129]
    s_waitcnt lgkmcnt(2)
    ds_read_b128 a[8:11], v12 offset:7040
    v_cvt_pk_bf16_f32 v70, v94, v95
    v_cvt_pk_bf16_f32 v136, v110, v111
    v_exp_f32 v97, v97
    v_exp_f32 v113, v113
    v_exp_f32 v16, v16
    v_exp_f32 v32, v32
    v_cvt_pk_bf16_f32 v71, v96, v97
    v_mfma_f32_32x32x16_bf16 v[82:97], a[0:3], v[72:75], 0
    v_cvt_pk_bf16_f32 v137, v112, v113
    v_exp_f32 v17, v17
    v_exp_f32 v33, v33
    v_exp_f32 v18, v18
    v_exp_f32 v34, v34
    v_cvt_pk_bf16_f32 v64, v16, v17
    v_mfma_f32_32x32x16_bf16 v[98:113], a[0:3], v[138:141], 0
    s_waitcnt lgkmcnt(2)
    ds_read_b128 a[0:3], v4 offset:9472
    v_cvt_pk_bf16_f32 v130, v32, v33
    v_exp_f32 v19, v19
    v_exp_f32 v35, v35
    v_exp_f32 v20, v20
    v_exp_f32 v36, v36
    v_cvt_pk_bf16_f32 v65, v18, v19
    v_mfma_f32_32x32x16_bf16 v[48:63], a[12:15], v[68:71], v[48:63]
    v_cvt_pk_bf16_f32 v131, v34, v35
    v_exp_f32 v21, v21
    v_exp_f32 v37, v37
    v_exp_f32 v22, v22
    v_exp_f32 v38, v38
    v_cvt_pk_bf16_f32 v66, v20, v21
    v_mfma_f32_32x32x16_bf16 v[114:129], a[12:15], v[134:137], v[114:129]
    s_waitcnt lgkmcnt(1)
    ds_read_b128 a[12:15], v12 offset:7648
    v_cvt_pk_bf16_f32 v132, v36, v37
    v_exp_f32 v23, v23
    v_exp_f32 v39, v39
    v_exp_f32 v24, v24
    v_exp_f32 v40, v40
    v_cvt_pk_bf16_f32 v67, v22, v23
    v_mfma_f32_32x32x4_2b_bf16 v[82:113], a[6:7], v[76:77], v[82:113] cbsz:1 abid:1
    v_cvt_pk_bf16_f32 v133, v38, v39
    v_exp_f32 v25, v25
    v_exp_f32 v41, v41
    v_exp_f32 v26, v26
    v_exp_f32 v42, v42
    v_cvt_pk_bf16_f32 v68, v24, v25
    v_cvt_pk_bf16_f32 v134, v40, v41
    v_exp_f32 v27, v27
    v_exp_f32 v43, v43
    v_exp_f32 v28, v28
    v_mfma_f32_32x32x16_bf16 v[48:63], a[8:11], v[64:67], v[48:63]
    ds_read_b32 a6, v3 offset:9480
    v_exp_f32 v44, v44
    v_cvt_pk_bf16_f32 v69, v26, v27
    v_cvt_pk_bf16_f32 v135, v42, v43
    v_exp_f32 v29, v29
    v_exp_f32 v45, v45
    v_exp_f32 v30, v30
    v_exp_f32 v46, v46
    v_mfma_f32_32x32x16_bf16 v[114:129], a[8:11], v[130:133], v[114:129]
    s_waitcnt lgkmcnt(2)
    ds_read_b128 a[8:11], v12 offset:8256
    v_cvt_pk_bf16_f32 v70, v28, v29
    v_cvt_pk_bf16_f32 v136, v44, v45
    v_exp_f32 v31, v31
    v_exp_f32 v47, v47
    v_exp_f32 v82, v82
    v_exp_f32 v98, v98
    v_cvt_pk_bf16_f32 v71, v30, v31
    v_mfma_f32_32x32x16_bf16 v[16:31], a[0:3], v[72:75], 0
    v_cvt_pk_bf16_f32 v137, v46, v47
    v_exp_f32 v83, v83
    v_exp_f32 v99, v99
    v_exp_f32 v84, v84
    v_exp_f32 v100, v100
    v_cvt_pk_bf16_f32 v64, v82, v83
    v_mfma_f32_32x32x16_bf16 v[32:47], a[0:3], v[138:141], 0
    s_waitcnt lgkmcnt(2)
    ds_read_b128 a[0:3], v4 offset:10496
    v_add_u32 v4, 9472, v4
    v_cvt_pk_bf16_f32 v130, v98, v99
    v_exp_f32 v85, v85
    v_exp_f32 v101, v101
    v_exp_f32 v86, v86
    v_exp_f32 v102, v102
    v_cvt_pk_bf16_f32 v65, v84, v85
    v_mfma_f32_32x32x16_bf16 v[48:63], a[12:15], v[68:71], v[48:63]
    s_add_u32 s37, s37, 1
    v_cvt_pk_bf16_f32 v131, v100, v101
    v_exp_f32 v87, v87
    v_exp_f32 v103, v103
    v_exp_f32 v88, v88
    v_exp_f32 v104, v104
    v_cvt_pk_bf16_f32 v66, v86, v87
    v_mfma_f32_32x32x16_bf16 v[114:129], a[12:15], v[134:137], v[114:129]
    s_waitcnt lgkmcnt(1)
    ds_read_b128 a[12:15], v12 offset:8864
    v_cvt_pk_bf16_f32 v132, v102, v103
    v_exp_f32 v89, v89
    v_exp_f32 v105, v105
    v_exp_f32 v90, v90
    v_exp_f32 v106, v106
    v_cvt_pk_bf16_f32 v67, v88, v89
    v_mfma_f32_32x32x4_2b_bf16 v[16:47], a[4:5], v[76:77], v[16:47] cbsz:1 abid:0
    v_cvt_pk_bf16_f32 v133, v104, v105
    v_exp_f32 v91, v91
    v_exp_f32 v107, v107
    v_exp_f32 v92, v92
    v_exp_f32 v108, v108
    v_cvt_pk_bf16_f32 v68, v90, v91
    v_cvt_pk_bf16_f32 v134, v106, v107
    v_exp_f32 v93, v93
    v_exp_f32 v109, v109
    v_exp_f32 v94, v94
    v_mfma_f32_32x32x16_bf16 v[48:63], a[8:11], v[64:67], v[48:63]
    s_cmp_lg_u32 s37, s38
    v_add_u32 v3, 9472, v3
    v_exp_f32 v110, v110
    v_cvt_pk_bf16_f32 v69, v92, v93
    v_cvt_pk_bf16_f32 v135, v108, v109
    v_exp_f32 v95, v95
    v_exp_f32 v111, v111
    v_exp_f32 v96, v96
    v_exp_f32 v112, v112
    v_mfma_f32_32x32x16_bf16 v[114:129], a[8:11], v[130:133], v[114:129]
    s_waitcnt lgkmcnt(1)
    ds_read_b128 a[8:11], v12 offset:14080
    v_cvt_pk_bf16_f32 v70, v94, v95
    v_cvt_pk_bf16_f32 v136, v110, v111
    v_exp_f32 v97, v97
    v_exp_f32 v113, v113
    v_add_u32 v12, 9472, v12
    s_cbranch_scc1 L_k2_P
    s_setpc_b64 s[70:71]
L_tp34:
    s_branch L_tret
.p2align 6
L_k2_S:
    v_exp_f32 v16, v16
    v_exp_f32 v32, v32
    v_cvt_pk_bf16_f32 v71, v96, v97
    v_mfma_f32_32x32x16_bf16 v[82:97], a[0:3], v[72:75], 0
    s_add_u32 s27, s27, s28
    buffer_store_dwordx4 v[216:219], v250, s[8:11], s27 offen offset:0 sc1
    v_cvt_pk_bf16_f32 v137, v112, v113
    v_exp_f32 v17, v17
    v_exp_f32 v33, v33
    v_exp_f32 v18, v18
    v_exp_f32 v34, v34
    v_cvt_pk_bf16_f32 v64, v16, v17
    v_mfma_f32_32x32x16_bf16 v[98:113], a[0:3], v[138:141], 0
    s_waitcnt lgkmcnt(1)
    ds_read_b128 a[0:3], v4 offset:2048
    v_cvt_pk_bf16_f32 v130, v32, v33
    v_exp_f32 v19, v19
    v_exp_f32 v35, v35
    v_exp_f32 v20, v20
    v_exp_f32 v36, v36
    v_cvt_pk_bf16_f32 v65, v18, v19
    v_mfma_f32_32x32x16_bf16 v[48:63], a[12:15], v[68:71], v[48:63]
    buffer_store_dwordx4 v[220:223], v250, s[8:11], s27 offen offset:128 sc1
    v_cvt_pk_bf16_f32 v131, v34, v35
    v_exp_f32 v21, v21
    v_exp_f32 v37, v37
    v_exp_f32 v22, v22
    v_exp_f32 v38, v38
    v_cvt_pk_bf16_f32 v66, v20, v21
    v_mfma_f32_32x32x16_bf16 v[114:129], a[12:15], v[134:137], v[114:129]
    s_waitcnt lgkmcnt(1)
    ds_read_b128 a[12:15], v12 offset:5216
    v_cvt_pk_bf16_f32 v132, v36, v37
    v_exp_f32 v23, v23
    v_exp_f32 v39, v39
    v_exp_f32 v24, v24
    v_exp_f32 v40, v40
    v_cvt_pk_bf16_f32 v67, v22, v23
    v_mfma_f32_32x32x4_2b_bf16 v[82:113], a[4:5], v[76:77], v[82:113] cbsz:1 abid:1
    v_cvt_pk_bf16_f32 v133, v38, v39
    v_exp_f32 v25, v25
    v_exp_f32 v41, v41
    v_exp_f32 v26, v26
    v_exp_f32 v42, v42
    v_cvt_pk_bf16_f32 v68, v24, v25
    v_cvt_pk_bf16_f32 v134, v40, v41
    v_exp_f32 v27, v27
    v_exp_f32 v43, v43
    v_exp_f32 v28, v28
    v_mfma_f32_32x32x16_bf16 v[48:63], a[8:11], v[64:67], v[48:63]
    v_exp_f32 v44, v44
    v_cvt_pk_bf16_f32 v69, v26, v27
    v_cvt_pk_bf16_f32 v135, v42, v43
    v_exp_f32 v29, v29
    v_exp_f32 v45, v45
    v_exp_f32 v30, v30
    v_exp_f32 v46, v46
    v_mfma_f32_32x32x16_bf16 v[114:129], a[8:11], v[130:133], v[114:129]
    s_waitcnt lgkmcnt(1)
    ds_read_b128 a[8:11], v12 offset:5824
    v_cvt_pk_bf16_f32 v70, v28, v29
    v_cvt_pk_bf16_f32 v136, v44, v45
    v_exp_f32 v31, v31
    v_exp_f32 v47, v47
    v_exp_f32 v82, v82
    v_exp_f32 v98, v98
    v_cvt_pk_bf16_f32 v71, v30, v31
    v_mfma_f32_32x32x16_bf16 v[16:31], a[0:3], v[72:75], 0
    s_add_u32 s27, s27, s28
    buffer_store_dwordx4 v[224:227], v250, s[8:11], s27 offen offset:0 sc1
    v_cvt_pk_bf16_f32 v137, v46, v47
    v_exp_f32 v83, v83
    v_exp_f32 v99, v99
    v_exp_f32 v84, v84
    v_exp_f32 v100, v100
    v_cvt_pk_bf16_f32 v64, v82, v83
    v_mfma_f32_32x32x16_bf16 v[32:47], a[0:3], v[138:141], 0
    s_waitcnt lgkmcnt(1)
    ds_read_b128 a[0:3], v4 offset:3072
    v_cvt_pk_bf16_f32 v130, v98, v99
    v_exp_f32 v85, v85
    v_exp_f32 v101, v101
    v_exp_f32 v86, v86
    v_exp_f32 v102, v102
    v_cvt_pk_bf16_f32 v65, v84, v85
    v_mfma_f32_32x32x16_bf16 v[48:63], a[12:15], v[68:71], v[48:63]
    buffer_store_dwordx4 v[228:231], v250, s[8:11], s27 offen offset:128 sc1
    v_cvt_pk_bf16_f32 v131, v100, v101
    v_exp_f32 v87, v87
    v_exp_f32 v103, v103
    v_exp_f32 v88, v88
    v_exp_f32 v104, v104
    v_cvt_pk_bf16_f32 v66, v86, v87
    v_mfma_f32_32x32x16_bf16 v[114:129], a[12:15], v[134:137], v[114:129]
    s_waitcnt lgkmcnt(1)
    ds_read_b128 a[12:15], v12 offset:6432
    v_cvt_pk_bf16_f32 v132, v102, v103
    v_exp_f32 v89, v89
    v_exp_f32 v105, v105
    v_exp_f32 v90, v90
    v_exp_f32 v106, v106
    v_cvt_pk_bf16_f32 v67, v88, v89
    v_mfma_f32_32x32x4_2b_bf16 v[16:47], a[6:7], v[76:77], v[16:47] cbsz:1 abid:0
    v_cvt_pk_bf16_f32 v133, v104, v105
    v_exp_f32 v91, v91
    v_exp_f32 v107, v107
    v_exp_f32 v92, v92
    v_exp_f32 v108, v108
    v_cvt_pk_bf16_f32 v68, v90, v91
    v_cvt_pk_bf16_f32 v134, v106, v107
    v_exp_f32 v93, v93
    v_exp_f32 v109, v109
    v_exp_f32 v94, v94
    v_mfma_f32_32x32x16_bf16 v[48:63], a[8:11], v[64:67], v[48:63]
    ds_read_b32 a4, v3 offset:9472
    v_exp_f32 v110, v110
    v_cvt_pk_bf16_f32 v69, v92, v93
    v_cvt_pk_bf16_f32 v135, v108, v109
    v_exp_f32 v95, v95
    v_exp_f32 v111, v111
    v_exp_f32 v96, v96
    v_exp_f32 v112, v112
    v_mfma_f32_32x32x16_bf16 v[114:129], a[8:11], v[130:133], v[114:129]
    s_waitcnt lgkmcnt(2)
    ds_read_b128 a[8:11], v12 offset:7040
    v_cvt_pk_bf16_f32 v70, v94, v95
    v_cvt_pk_bf16_f32 v136, v110, v111
    v_exp_f32 v97, v97
    v_exp_f32 v113, v113
    v_exp_f32 v16, v16
    v_exp_f32 v32, v32
    v_cvt_pk_bf16_f32 v71, v96, v97
    v_mfma_f32_32x32x16_bf16 v[82:97], a[0:3], v[72:75], 0
    s_add_u32 s27, s27, s28
    buffer_store_dwordx4 v[232:235], v250, s[8:11], s27 offen offset:0 sc1
    v_cvt_pk_bf16_f32 v137, v112, v113
    v_exp_f32 v17, v17
    v_exp_f32 v33, v33
    v_exp_f32 v18, v18
    v_exp_f32 v34, v34
    v_cvt_pk_bf16_f32 v64, v16, v17
    v_mfma_f32_32x32x16_bf16 v[98:113], a[0:3], v[138:141], 0
    s_waitcnt lgkmcnt(2)
    ds_read_b128 a[0:3], v4 offset:9472
    v_cvt_pk_bf16_f32 v130, v32, v33
    v_exp_f32 v19, v19
    v_exp_f32 v35, v35
    v_exp_f32 v20, v20
    v_exp_f32 v36, v36
    v_cvt_pk_bf16_f32 v65, v18, v19
    v_mfma_f32_32x32x16_bf16 v[48:63], a[12:15], v[68:71], v[48:63]
    buffer_store_dwordx4 v[236:239], v250, s[8:11], s27 offen offset:128 sc1
    v_cvt_pk_bf16_f32 v131, v34, v35
    v_exp_f32 v21, v21
    v_exp_f32 v37, v37
    v_exp_f32 v22, v22
    v_exp_f32 v38, v38
    v_cvt_pk_bf16_f32 v66, v20, v21
    v_mfma_f32_32x32x16_bf16 v[114:129], a[12:15], v[134:137], v[114:129]
    s_waitcnt lgkmcnt(1)
    ds_read_b128 a[12:15], v12 offset:7648
    v_cvt_pk_bf16_f32 v132, v36, v37
    v_exp_f32 v23, v23
    v_exp_f32 v39, v39
    v_exp_f32 v24, v24
    v_exp_f32 v40, v40
    v_cvt_pk_bf16_f32 v67, v22, v23
    v_mfma_f32_32x32x4_2b_bf16 v[82:113], a[6:7], v[76:77], v[82:113] cbsz:1 abid:1
    v_cvt_pk_bf16_f32 v133, v38, v39
    v_exp_f32 v25, v25
    v_exp_f32 v41, v41
    v_exp_f32 v26, v26
    v_exp_f32 v42, v42
    v_cvt_pk_bf16_f32 v68, v24, v25
    v_cvt_pk_bf16_f32 v134, v40, v41
    v_exp_f32 v27, v27
    v_exp_f32 v43, v43
    v_exp_f32 v28, v28
    v_mfma_f32_32x32x16_bf16 v[48:63], a[8:11], v[64:67], v[48:63]
    ds_read_b32 a6, v3 offset:9480
    v_exp_f32 v44, v44
    v_cvt_pk_bf16_f32 v69, v26, v27
    v_cvt_pk_bf16_f32 v135, v42, v43
    v_exp_f32 v29, v29
    v_exp_f32 v45, v45
    v_exp_f32 v30, v30
    v_exp_f32 v46, v46
    v_mfma_f32_32x32x16_bf16 v[114:129], a[8:11], v[130:133], v[114:129]
    s_waitcnt lgkmcnt(2)
    ds_read_b128 a[8:11], v12 offset:8256
    v_cvt_pk_bf16_f32 v70, v28, v29
    v_cvt_pk_bf16_f32 v136, v44, v45
    v_exp_f32 v31, v31
    v_exp_f32 v47, v47
    v_exp_f32 v82, v82
    v_exp_f32 v98, v98
    v_cvt_pk_bf16_f32 v71, v30, v31
    v_mfma_f32_32x32x16_bf16 v[16:31], a[0:3], v[72:75], 0
    s_add_u32 s27, s27, s28
    buffer_store_dwordx4 v[240:243], v250, s[8:11], s27 offen offset:0 sc1
    v_cvt_pk_bf16_f32 v137, v46, v47
    v_exp_f32 v83, v83
    v_exp_f32 v99, v99
    v_exp_f32 v84, v84
    v_exp_f32 v100, v100
    v_cvt_pk_bf16_f32 v64, v82, v83
    v_mfma_f32_32x32x16_bf16 v[32:47], a[0:3], v[138:141], 0
    s_waitcnt lgkmcnt(2)
    ds_read_b128 a[0:3], v4 offset:10496
    v_add_u32 v4, 9472, v4
    v_cvt_pk_bf16_f32 v130, v98, v99
    v_exp_f32 v85, v85
    v_exp_f32 v101, v101
    v_exp_f32 v86, v86
    v_exp_f32 v102, v102
    v_cvt_pk_bf16_f32 v65, v84, v85
    v_mfma_f32_32x32x16_bf16 v[48:63], a[12:15], v[68:71], v[48:63]
    s_add_u32 s37, s37, 1
    buffer_store_dwordx4 v[244:247], v250, s[8:11], s27 offen offset:128 sc1
    v_cvt_pk_bf16_f32 v131, v100, v101
    v_exp_f32 v87, v87
    v_exp_f32 v103, v103
    v_exp_f32 v88, v88
    v_exp_f32 v104, v104
    v_cvt_pk_bf16_f32 v66, v86, v87
    v_mfma_f32_32x32x16_bf16 v[114:129], a[12:15], v[134:137], v[114:129]
    s_waitcnt lgkmcnt(1)
    ds_read_b128 a[12:15], v12 offset:8864
    v_cvt_pk_bf16_f32 v132, v102, v103
    v_exp_f32 v89, v89
    v_exp_f32 v105, v105
    v_exp_f32 v90, v90
    v_exp_f32 v106, v106
    v_cvt_pk_bf16_f32 v67, v88, v89
    v_mfma_f32_32x32x4_2b_bf16 v[16:47], a[4:5], v[76:77], v[16:47] cbsz:1 abid:0
    v_cvt_pk_bf16_f32 v133, v104, v105
    v_exp_f32 v91, v91
    v_exp_f32 v107, v107
    v_exp_f32 v92, v92
    v_exp_f32 v108, v108
    v_cvt_pk_bf16_f32 v68, v90, v91
    v_cvt_pk_bf16_f32 v134, v106, v107
    v_exp_f32 v93, v93
    v_exp_f32 v109, v109
    v_exp_f32 v94, v94
    v_mfma_f32_32x32x16_bf16 v[48:63], a[8:11], v[64:67], v[48:63]
    s_cmp_lg_u32 s37, s38
    v_add_u32 v3, 9472, v3
    v_exp_f32 v110, v110
    v_cvt_pk_bf16_f32 v69, v92, v93
    v_cvt_pk_bf16_f32 v135, v108, v109
    v_exp_f32 v95, v95
    v_exp_f32 v111, v111
    v_exp_f32 v96, v96
    v_exp_f32 v112, v112
    v_mfma_f32_32x32x16_bf16 v[114:129], a[8:11], v[130:133], v[114:129]
    s_waitcnt lgkmcnt(1)
    ds_read_b128 a[8:11], v12 offset:14080
    v_cvt_pk_bf16_f32 v70, v94, v95
    v_cvt_pk_bf16_f32 v136, v110, v111
    v_exp_f32 v97, v97
    v_exp_f32 v113, v113
    v_add_u32 v12, 9472, v12
    s_cbranch_scc1 L_k2_S
    s_setpc_b64 s[70:71]
L_k4_re2:
    v_cmpx_ne_u32 vcc, s54, v208
    v_cmpx_ne_u32 vcc, s54, v209
    v_cmpx_ne_u32 vcc, s54, v210
    v_cmpx_ne_u32 vcc, s54, v211
    v_cmpx_ne_u32 vcc, s54, v212
    v_cmpx_ne_u32 vcc, s54, v213
    v_cmpx_ne_u32 vcc, s54, v214
    v_cmpx_ne_u32 vcc, s54, v215
    s_sub_u32 s52, s52, 1
    s_cmp_eq_u64 exec, -1
    s_mov_b64 exec, -1
    s_cbranch_scc1 L_k4_ok2
    s_cmp_lt_i32 s52, 0
    s_cbranch_scc1 L_k4_ok2
    buffer_load_dwordx4 v[208:211], v2, s[8:11], s62 offen offset:0 sc1
    buffer_load_dwordx4 v[212:215], v2, s[8:11], s62 offen offset:1024 sc1
    s_waitcnt vmcnt(0)
    v_mfma_f32_16x16x32_bf16 v[112:115], v[10:13], v[208:211], v[96:99]
    v_mfma_f32_16x16x32_bf16 v[116:119], v[8:11], v[208:211], v[100:103]
    v_mfma_f32_16x16x32_bf16 v[120:123], v[10:13], v[212:215], v[104:107]
    v_mfma_f32_16x16x32_bf16 v[124:127], v[8:11], v[212:215], v[108:111]
    s_nop 6
    v_cmp_u_f32 vcc, v112, v120
    s_cbranch_vccnz L_k4_re2
    s_branch L_k4_ok2
L_k2_fb:
    s_cmp_eq_u32 s39, 1
    s_cbranch_scc1 L_k2_out
    s_mov_b32 s39, 1
    v_subrev_u32 v4, 151552, v4
    v_subrev_u32 v3, 151552, v3
    v_subrev_u32 v12, 151552, v12
    v_cmp_gt_u32 vcc, 32, v1
    v_add_u32 v8, 3584, v4
    v_mov_b32 v9, 5184
    v_cndmask_b32 v3, v8, v9, vcc
    v_mov_b32 v76, v80
    v_mov_b32 v77, 0
    v_mov_b32 v78, 0
    v_mov_b32 v79, v80
    v_mov_b32 v81, 0xff7fffff
    v_mov_b32 v142, v146
    v_mov_b32 v143, 0
    v_mov_b32 v144, 0
    v_mov_b32 v145, v146
    v_mov_b32 v147, 0xff7fffff
    s_mov_b32 s42, 0x00240000
L_k2_fb1:
    buffer_load_dwordx4 a[16:19], v4, s[8:11], s42 offen offset:0
    buffer_load_dwordx4 a[20:23], v4, s[8:11], s42 offen offset:1024
    buffer_load_dwordx4 a[24:27], v4, s[8:11], s42 offen offset:2048
    buffer_load_dwordx4 a[28:31], v4, s[8:11], s42 offen offset:3072
    buffer_load_dwordx4 a[32:35], v3, s[8:11], s42 offen
    s_waitcnt vmcnt(0)
    v_mfma_f32_32x32x16_bf16 v[16:31], a[16:19], v[72:75], 0
    v_mfma_f32_32x32x16_bf16 v[32:47], a[16:19], v[138:141], 0
    v_mfma_f32_32x32x8_bf16 v[16:31], a[32:33], v[76:77], v[16:31]
    v_mfma_f32_32x32x8_bf16 v[32:47], a[32:33], v[142:143], v[32:47]
    s_nop 10
    v_max3_f32 v81, v81, v16, v17
    v_max3_f32 v81, v81, v18, v19
    v_max3_f32 v81, v81, v20, v21
    v_max3_f32 v81, v81, v22, v23
    v_max3_f32 v81, v81, v24, v25
    v_max3_f32 v81, v81, v26, v27
    v_max3_f32 v81, v81, v28, v29
    v_max3_f32 v81, v81, v30, v31
    v_max3_f32 v147, v147, v32, v33
    v_max3_f32 v147, v147, v34, v35
    v_max3_f32 v147, v147, v36, v37
    v_max3_f32 v147, v147, v38, v39
    v_max3_f32 v147, v147, v40, v41
    v_max3_f32 v147, v147, v42, v43
    v_max3_f32 v147, v147, v44, v45
    v_max3_f32 v147, v147, v46, v47
    v_mfma_f32_32x32x16_bf16 v[16:31], a[20:23], v[72:75], 0
    v_mfma_f32_32x32x16_bf16 v[32:47], a[20:23], v[138:141], 0
    v_mfma_f32_32x32x8_bf16 v[16:31], a[32:33], v[78:79], v[16:31]
    v_mfma_f32_32x32x8_bf16 v[32:47], a[32:33], v[144:145], v[32:47]
    s_nop 10
    v_max3_f32 v81, v81, v16, v17
    v_max3_f32 v81, v81, v18, v19
    v_max3_f32 v81, v81, v20, v21
    v_max3_f32 v81, v81, v22, v23
    v_max3_f32 v81, v81, v24, v25
    v_max3_f32 v81, v81, v26, v27
    v_max3_f32 v81, v81, v28, v29
    v_max3_f32 v81, v81, v30, v31
    v_max3_f32 v147, v147, v32, v33
    v_max3_f32 v147, v147, v34, v35
    v_max3_f32 v147, v147, v36, v37
    v_max3_f32 v147, v147, v38, v39
    v_max3_f32 v147, v147, v40, v41
    v_max3_f32 v147, v147, v42, v43
    v_max3_f32 v147, v147, v44, v45
    v_max3_f32 v147, v147, v46, v47
    v_mfma_f32_32x32x16_bf16 v[16:31], a[24:27], v[72:75], 0
    v_mfma_f32_32x32x16_bf16 v[32:47], a[24:27], v[138:141], 0
    v_mfma_f32_32x32x8_bf16 v[16:31], a[34:35], v[76:77], v[16:31]
    v_mfma_f32_32x32x8_bf16 v[32:47], a[34:35], v[142:143], v[32:47]
    s_nop 10
    v_max3_f32 v81, v81, v16, v17
    v_max3_f32 v81, v81, v18, v19
    v_max3_f32 v81, v81, v20, v21
    v_max3_f32 v81, v81, v22, v23
    v_max3_f32 v81, v81, v24, v25
    v_max3_f32 v81, v81, v26, v27
    v_max3_f32 v81, v81, v28, v29
    v_max3_f32 v81, v81, v30, v31
    v_max3_f32 v147, v147, v32, v33
    v_max3_f32 v147, v147, v34, v35
    v_max3_f32 v147, v147, v36, v37
    v_max3_f32 v147, v147, v38, v39
    v_max3_f32 v147, v147, v40, v41
    v_max3_f32 v147, v147, v42, v43
    v_max3_f32 v147, v147, v44, v45
    v_max3_f32 v147, v147, v46, v47
    v_mfma_f32_32x32x16_bf16 v[16:31], a[28:31], v[72:75], 0
    v_mfma_f32_32x32x16_bf16 v[32:47], a[28:31], v[138:141], 0
    v_mfma_f32_32x32x8_bf16 v[16:31], a[34:35], v[78:79], v[16:31]
    v_mfma_f32_32x32x8_bf16 v[32:47], a[34:35], v[144:145], v[32:47]
    s_nop 10
    v_max3_f32 v81, v81, v16, v17
    v_max3_f32 v81, v81, v18, v19
    v_max3_f32 v81, v81, v20, v21
    v_max3_f32 v81, v81, v22, v23
    v_max3_f32 v81, v81, v24, v25
    v_max3_f32 v81, v81, v26, v27
    v_max3_f32 v81, v81, v28, v29
    v_max3_f32 v81, v81, v30, v31
    v_max3_f32 v147, v147, v32, v33
    v_max3_f32 v147, v147, v34, v35
    v_max3_f32 v147, v147, v36, v37
    v_max3_f32 v147, v147, v38, v39
    v_max3_f32 v147, v147, v40, v41
    v_max3_f32 v147, v147, v42, v43
    v_max3_f32 v147, v147, v44, v45
    v_max3_f32 v147, v147, v46, v47
    s_add_u32 s42, s42, 9472
    s_cmp_lg_u32 s42, 0x00265000
    s_cbranch_scc1 L_k2_fb1
    v_cmp_gt_u32 vcc, 32, v1
    v_mov_b32 v8, v81
    v_mov_b32 v68, 0
    s_nop 0
    v_permlane32_swap_b32 v8, v81
    v_max_f32 v8, v8, v81
    v_mul_f32 v8, -1.0, v8
    v_and_b32 v9, 0xffff0000, v8
    v_sub_f32 v8, v8, v9
    v_and_b32 v10, 0xffff0000, v8
    v_sub_f32 v8, v8, v10
    v_lshrrev_b32 v9, 16, v9
    v_or_b32 v9, v9, v10
    v_lshrrev_b32 v8, 16, v8
    v_cndmask_b32 v76, v80, v9, vcc
    v_cndmask_b32 v77, 0, v8, vcc
    v_cndmask_b32 v78, 0, v9, vcc
    v_cndmask_b32 v79, v80, v8, vcc
    v_mov_b32 v48, 0
    v_mov_b32 v49, 0
    v_mov_b32 v50, 0
    v_mov_b32 v51, 0
    v_mov_b32 v52, 0
    v_mov_b32 v53, 0
    v_mov_b32 v54, 0
    v_mov_b32 v55, 0
    v_mov_b32 v56, 0
    v_mov_b32 v57, 0
    v_mov_b32 v58, 0
    v_mov_b32 v59, 0
    v_mov_b32 v60, 0
    v_mov_b32 v61, 0
    v_mov_b32 v62, 0
    v_mov_b32 v63, 0
    v_mov_b32 v8, v147
    v_mov_b32 v134, 0
    s_nop 0
    v_permlane32_swap_b32 v8, v147
    v_max_f32 v8, v8, v147
    v_mul_f32 v8, -1.0, v8
    v_and_b32 v9, 0xffff0000, v8
    v_sub_f32 v8, v8, v9
    v_and_b32 v10, 0xffff0000, v8
    v_sub_f32 v8, v8, v10
    v_lshrrev_b32 v9, 16, v9
    v_or_b32 v9, v9, v10
    v_lshrrev_b32 v8, 16, v8
    v_cndmask_b32 v142, v146, v9, vcc
    v_cndmask_b32 v143, 0, v8, vcc
    v_cndmask_b32 v144, 0, v9, vcc
    v_cndmask_b32 v145, v146, v8, vcc
    v_mov_b32 v114, 0
    v_mov_b32 v115, 0
    v_mov_b32 v116, 0
    v_mov_b32 v117, 0
    v_mov_b32 v118, 0
    v_mov_b32 v119, 0
    v_mov_b32 v120, 0
    v_mov_b32 v121, 0
    v_mov_b32 v122, 0
    v_mov_b32 v123, 0
    v_mov_b32 v124, 0
    v_mov_b32 v125, 0
    v_mov_b32 v126, 0
    v_mov_b32 v127, 0
    v_mov_b32 v128, 0
    v_mov_b32 v129, 0
    s_mov_b32 s42, 0x00240000
L_k2_fb2:
    buffer_load_dwordx4 a[16:19], v4, s[8:11], s42 offen offset:0
    buffer_load_dwordx4 a[20:23], v4, s[8:11], s42 offen offset:1024
    buffer_load_dwordx4 a[24:27], v4, s[8:11], s42 offen offset:2048
    buffer_load_dwordx4 a[28:31], v4, s[8:11], s42 offen offset:3072
    buffer_load_dwordx4 a[32:35], v3, s[8:11], s42 offen
    s_add_u32 s43, s42, 4608
    buffer_load_dwordx4 a[36:39], v12, s[8:11], s43 offen offset:0
    buffer_load_dwordx4 a[40:43], v12, s[8:11], s43 offen offset:608
    buffer_load_dwordx4 a[44:47], v12, s[8:11], s43 offen offset:1216
    buffer_load_dwordx4 a[48:51], v12, s[8:11], s43 offen offset:1824
    s_add_u32 s43, s42, 7040
    buffer_load_dwordx4 a[52:55], v12, s[8:11], s43 offen offset:0
    buffer_load_dwordx4 a[56:59], v12, s[8:11], s43 offen offset:608
    buffer_load_dwordx4 a[60:63], v12, s[8:11], s43 offen offset:1216
    buffer_load_dwordx4 a[64:67], v12, s[8:11], s43 offen offset:1824
    s_waitcnt vmcnt(0)
    v_mfma_f32_32x32x16_bf16 v[16:31], a[16:19], v[72:75], 0
    v_mfma_f32_32x32x16_bf16 v[32:47], a[16:19], v[138:141], 0
    v_mfma_f32_32x32x8_bf16 v[16:31], a[32:33], v[76:77], v[16:31]
    v_mfma_f32_32x32x8_bf16 v[32:47], a[32:33], v[142:143], v[32:47]
    s_nop 10
    v_exp_f32 v16, v16
    v_exp_f32 v17, v17
    v_exp_f32 v18, v18
    v_exp_f32 v19, v19
    v_exp_f32 v20, v20
    v_exp_f32 v21, v21
    v_exp_f32 v22, v22
    v_exp_f32 v23, v23
    v_exp_f32 v24, v24
    v_exp_f32 v25, v25
    v_exp_f32 v26, v26
    v_exp_f32 v27, v27
    v_exp_f32 v28, v28
    v_exp_f32 v29, v29
    v_exp_f32 v30, v30
    v_exp_f32 v31, v31
    v_cvt_pk_bf16_f32 v64, v16, v17
    v_cvt_pk_bf16_f32 v65, v18, v19
    v_cvt_pk_bf16_f32 v66, v20, v21
    v_cvt_pk_bf16_f32 v67, v22, v23
    v_cvt_pk_bf16_f32 v68, v24, v25
    v_cvt_pk_bf16_f32 v69, v26, v27
    v_cvt_pk_bf16_f32 v70, v28, v29
    v_cvt_pk_bf16_f32 v71, v30, v31
    v_mfma_f32_32x32x16_bf16 v[48:63], a[36:39], v[64:67], v[48:63]
    s_nop 0
    v_mfma_f32_32x32x16_bf16 v[48:63], a[40:43], v[68:71], v[48:63]
    v_exp_f32 v32, v32
    v_exp_f32 v33, v33
    v_exp_f32 v34, v34
    v_exp_f32 v35, v35
    v_exp_f32 v36, v36
    v_exp_f32 v37, v37
    v_exp_f32 v38, v38
    v_exp_f32 v39, v39
    v_exp_f32 v40, v40
    v_exp_f32 v41, v41
    v_exp_f32 v42, v42
    v_exp_f32 v43, v43
    v_exp_f32 v44, v44
    v_exp_f32 v45, v45
    v_exp_f32 v46, v46
    v_exp_f32 v47, v47
    v_cvt_pk_bf16_f32 v130, v32, v33
    v_cvt_pk_bf16_f32 v131, v34, v35
    v_cvt_pk_bf16_f32 v132, v36, v37
    v_cvt_pk_bf16_f32 v133, v38, v39
    v_cvt_pk_bf16_f32 v134, v40, v41
    v_cvt_pk_bf16_f32 v135, v42, v43
    v_cvt_pk_bf16_f32 v136, v44, v45
    v_cvt_pk_bf16_f32 v137, v46, v47
    v_mfma_f32_32x32x16_bf16 v[114:129], a[36:39], v[130:133], v[114:129]
    s_nop 0
    v_mfma_f32_32x32x16_bf16 v[114:129], a[40:43], v[134:137], v[114:129]
    v_mfma_f32_32x32x16_bf16 v[16:31], a[20:23], v[72:75], 0
    v_mfma_f32_32x32x16_bf16 v[32:47], a[20:23], v[138:141], 0
    v_mfma_f32_32x32x8_bf16 v[16:31], a[32:33], v[78:79], v[16:31]
    v_mfma_f32_32x32x8_bf16 v[32:47], a[32:33], v[144:145], v[32:47]
    s_nop 10
    v_exp_f32 v16, v16
    v_exp_f32 v17, v17
    v_exp_f32 v18, v18
    v_exp_f32 v19, v19
    v_exp_f32 v20, v20
    v_exp_f32 v21, v21
    v_exp_f32 v22, v22
    v_exp_f32 v23, v23
    v_exp_f32 v24, v24
    v_exp_f32 v25, v25
    v_exp_f32 v26, v26
    v_exp_f32 v27, v27
    v_exp_f32 v28, v28
    v_exp_f32 v29, v29
    v_exp_f32 v30, v30
    v_exp_f32 v31, v31
    v_cvt_pk_bf16_f32 v64, v16, v17
    v_cvt_pk_bf16_f32 v65, v18, v19
    v_cvt_pk_bf16_f32 v66, v20, v21
    v_cvt_pk_bf16_f32 v67, v22, v23
    v_cvt_pk_bf16_f32 v68, v24, v25
    v_cvt_pk_bf16_f32 v69, v26, v27
    v_cvt_pk_bf16_f32 v70, v28, v29
    v_cvt_pk_bf16_f32 v71, v30, v31
    v_mfma_f32_32x32x16_bf16 v[48:63], a[44:47], v[64:67], v[48:63]
    s_nop 0
    v_mfma_f32_32x32x16_bf16 v[48:63], a[48:51], v[68:71], v[48:63]
    v_exp_f32 v32, v32
    v_exp_f32 v33, v33
    v_exp_f32 v34, v34
    v_exp_f32 v35, v35
    v_exp_f32 v36, v36
    v_exp_f32 v37, v37
    v_exp_f32 v38, v38
    v_exp_f32 v39, v39
    v_exp_f32 v40, v40
    v_exp_f32 v41, v41
    v_exp_f32 v42, v42
    v_exp_f32 v43, v43
    v_exp_f32 v44, v44
    v_exp_f32 v45, v45
    v_exp_f32 v46, v46
    v_exp_f32 v47, v47
    v_cvt_pk_bf16_f32 v130, v32, v33
    v_cvt_pk_bf16_f32 v131, v34, v35
    v_cvt_pk_bf16_f32 v132, v36, v37
    v_cvt_pk_bf16_f32 v133, v38, v39
    v_cvt_pk_bf16_f32 v134, v40, v41
    v_cvt_pk_bf16_f32 v135, v42, v43
    v_cvt_pk_bf16_f32 v136, v44, v45
    v_cvt_pk_bf16_f32 v137, v46, v47
    v_mfma_f32_32x32x16_bf16 v[114:129], a[44:47], v[130:133], v[114:129]
    s_nop 0
    v_mfma_f32_32x32x16_bf16 v[114:129], a[48:51], v[134:137], v[114:129]
    v_mfma_f32_32x32x16_bf16 v[16:31], a[24:27], v[72:75], 0
    v_mfma_f32_32x32x16_bf16 v[32:47], a[24:27], v[138:141], 0
    v_mfma_f32_32x32x8_bf16 v[16:31], a[34:35], v[76:77], v[16:31]
    v_mfma_f32_32x32x8_bf16 v[32:47], a[34:35], v[142:143], v[32:47]
    s_nop 10
    v_exp_f32 v16, v16
    v_exp_f32 v17, v17
    v_exp_f32 v18, v18
    v_exp_f32 v19, v19
    v_exp_f32 v20, v20
    v_exp_f32 v21, v21
    v_exp_f32 v22, v22
    v_exp_f32 v23, v23
    v_exp_f32 v24, v24
    v_exp_f32 v25, v25
    v_exp_f32 v26, v26
    v_exp_f32 v27, v27
    v_exp_f32 v28, v28
    v_exp_f32 v29, v29
    v_exp_f32 v30, v30
    v_exp_f32 v31, v31
    v_cvt_pk_bf16_f32 v64, v16, v17
    v_cvt_pk_bf16_f32 v65, v18, v19
    v_cvt_pk_bf16_f32 v66, v20, v21
    v_cvt_pk_bf16_f32 v67, v22, v23
    v_cvt_pk_bf16_f32 v68, v24, v25
    v_cvt_pk_bf16_f32 v69, v26, v27
    v_cvt_pk_bf16_f32 v70, v28, v29
    v_cvt_pk_bf16_f32 v71, v30, v31
    v_mfma_f32_32x32x16_bf16 v[48:63], a[52:55], v[64:67], v[48:63]
    s_nop 0
    v_mfma_f32_32x32x16_bf16 v[48:63], a[56:59], v[68:71], v[48:63]
    v_exp_f32 v32, v32
    v_exp_f32 v33, v33
    v_exp_f32 v34, v34
    v_exp_f32 v35, v35
    v_exp_f32 v36, v36
    v_exp_f32 v37, v37
    v_exp_f32 v38, v38
    v_exp_f32 v39, v39
    v_exp_f32 v40, v40
    v_exp_f32 v41, v41
    v_exp_f32 v42, v42
    v_exp_f32 v43, v43
    v_exp_f32 v44, v44
    v_exp_f32 v45, v45
    v_exp_f32 v46, v46
    v_exp_f32 v47, v47
    v_cvt_pk_bf16_f32 v130, v32, v33
    v_cvt_pk_bf16_f32 v131, v34, v35
    v_cvt_pk_bf16_f32 v132, v36, v37
    v_cvt_pk_bf16_f32 v133, v38, v39
    v_cvt_pk_bf16_f32 v134, v40, v41
    v_cvt_pk_bf16_f32 v135, v42, v43
    v_cvt_pk_bf16_f32 v136, v44, v45
    v_cvt_pk_bf16_f32 v137, v46, v47
    v_mfma_f32_32x32x16_bf16 v[114:129], a[52:55], v[130:133], v[114:129]
    s_nop 0
    v_mfma_f32_32x32x16_bf16 v[114:129], a[56:59], v[134:137], v[114:129]
    v_mfma_f32_32x32x16_bf16 v[16:31], a[28:31], v[72:75], 0
    v_mfma_f32_32x32x16_bf16 v[32:47], a[28:31], v[138:141], 0
    v_mfma_f32_32x32x8_bf16 v[16:31], a[34:35], v[78:79], v[16:31]
    v_mfma_f32_32x32x8_bf16 v[32:47], a[34:35], v[144:145], v[32:47]
    s_nop 10
    v_exp_f32 v16, v16
    v_exp_f32 v17, v17
    v_exp_f32 v18, v18
    v_exp_f32 v19, v19
    v_exp_f32 v20, v20
    v_exp_f32 v21, v21
    v_exp_f32 v22, v22
    v_exp_f32 v23, v23
    v_exp_f32 v24, v24
    v_exp_f32 v25, v25
    v_exp_f32 v26, v26
    v_exp_f32 v27, v27
    v_exp_f32 v28, v28
    v_exp_f32 v29, v29
    v_exp_f32 v30, v30
    v_exp_f32 v31, v31
    v_cvt_pk_bf16_f32 v64, v16, v17
    v_cvt_pk_bf16_f32 v65, v18, v19
    v_cvt_pk_bf16_f32 v66, v20, v21
    v_cvt_pk_bf16_f32 v67, v22, v23
    v_cvt_pk_bf16_f32 v68, v24, v25
    v_cvt_pk_bf16_f32 v69, v26, v27
    v_cvt_pk_bf16_f32 v70, v28, v29
    v_cvt_pk_bf16_f32 v71, v30, v31
    v_mfma_f32_32x32x16_bf16 v[48:63], a[60:63], v[64:67], v[48:63]
    s_nop 0
    v_mfma_f32_32x32x16_bf16 v[48:63], a[64:67], v[68:71], v[48:63]
    v_exp_f32 v32, v32
    v_exp_f32 v33, v33
    v_exp_f32 v34, v34
    v_exp_f32 v35, v35
    v_exp_f32 v36, v36
    v_exp_f32 v37, v37
    v_exp_f32 v38, v38
    v_exp_f32 v39, v39
    v_exp_f32 v40, v40
    v_exp_f32 v41, v41
    v_exp_f32 v42, v42
    v_exp_f32 v43, v43
    v_exp_f32 v44, v44
    v_exp_f32 v45, v45
    v_exp_f32 v46, v46
    v_exp_f32 v47, v47
    v_cvt_pk_bf16_f32 v130, v32, v33
    v_cvt_pk_bf16_f32 v131, v34, v35
    v_cvt_pk_bf16_f32 v132, v36, v37
    v_cvt_pk_bf16_f32 v133, v38, v39
    v_cvt_pk_bf16_f32 v134, v40, v41
    v_cvt_pk_bf16_f32 v135, v42, v43
    v_cvt_pk_bf16_f32 v136, v44, v45
    v_cvt_pk_bf16_f32 v137, v46, v47
    v_mfma_f32_32x32x16_bf16 v[114:129], a[60:63], v[130:133], v[114:129]
    s_nop 0
    v_mfma_f32_32x32x16_bf16 v[114:129], a[64:67], v[134:137], v[114:129]
    s_add_u32 s42, s42, 9472
    s_cmp_lg_u32 s42, 0x00265000
    s_cbranch_scc1 L_k2_fb2
    s_branch L_k2_e17
L_k4_done:
    s_endpgm
.section .rodata,"a"
.p2align 6
.amdhsa_kernel k3_kernel
  .amdhsa_next_free_vgpr 512
  .amdhsa_next_free_sgpr 102
  .amdhsa_accum_offset 256
  .amdhsa_group_segment_fixed_size 0
  .amdhsa_kernarg_size 88
  .amdhsa_user_sgpr_count 2
  .amdhsa_user_sgpr_kernarg_segment_ptr 1
  .amdhsa_system_sgpr_workgroup_id_x 1
.end_amdhsa_kernel
```
